```python
import torch

def _softmax(x, axis=-1):
    return torch.softmax(x, dim=axis)
def _gelu(x):
    return torch.nn.functional.gelu(x, approximate="tanh")
def _silu(x):
    return torch.nn.functional.silu(x)
def _sigmoid(x):
    return torch.sigmoid(x)
def _layernorm(x, axis=-1, eps=1e-5):
    m = x.mean(dim=axis, keepdim=True)
    v = x.var(dim=axis, keepdim=True, unbiased=False)
    return (x - m) / torch.sqrt(v + eps)
def _scatter_add(tgt, idx, src, axis=0):
    return tgt.clone().index_add_(axis, idx, src)
def _segment_sum(src, seg, n):
    out = torch.zeros((n,) + src.shape[1:], dtype=src.dtype)
    return out.index_add_(0, seg, src)
def _pad(x, pw):
    flat = tuple(v for pair in reversed(pw) for v in pair)
    return torch.nn.functional.pad(x, flat)

kernel_name = 'parallel_sum__linear_attn_block__dense_activation_gelu__prompt'

def setup_inputs():

    _w = (lambda a: (lambda t: t.to(torch.bfloat16) if t.is_floating_point() else t)(torch.as_tensor(a)))
    def _A_setup():
        B, S, D = 1, 2048, 640
        return {
            "x": _w((lambda *s: torch.randn(*s, dtype=torch.bfloat16) * 0.05)(B, S, D)),
            "wqkv": _w((lambda *s: torch.randn(*s, dtype=torch.bfloat16) * 0.05)(D, 3 * D)),
            "wo": _w((lambda *s: torch.randn(*s, dtype=torch.bfloat16) * 0.05)(D, D)),
        }
    _A_in = _A_setup()

    def _B_setup():
        B, S, D, F = 1, 2048, 640, 1536
        return {
            "x": _w((lambda *s: torch.randn(*s, dtype=torch.bfloat16) * 0.05)(B, S, D)),
            "w1": _w((lambda *s: torch.randn(*s, dtype=torch.bfloat16) * 0.4)(D, F) * (D ** -0.5)),
            "b1": _w((lambda *s: torch.randn(*s, dtype=torch.bfloat16) * 12.8)(F) * 0.01),
            "w2": _w((lambda *s: torch.randn(*s, dtype=torch.bfloat16) * 0.1)(F, D) * (F ** -0.5)),
            "b2": _w((lambda *s: torch.randn(*s, dtype=torch.bfloat16) * 1.6)(D) * 0.01),
        }
    _B_in = _B_setup()

    return {
        "A_x": _A_in["x"],
        "A_wqkv": _A_in["wqkv"],
        "A_wo": _A_in["wo"],
        "B_x": _B_in["x"],
        "B_w1": _B_in["w1"],
        "B_b1": _B_in["b1"],
        "B_w2": _B_in["w2"],
        "B_b2": _B_in["b2"],
    }

def reference(A_x, A_wqkv, A_wo, B_x, B_w1, B_b1, B_w2, B_b2):
    def _A_ref(x, wqkv, wo):
        B, S, D = x.shape
        H = 32; Dh = D // H
        qkv = (lambda x, *d: x.permute(*d))((x @ wqkv).reshape(B, S, 3, H, Dh), 2, 0, 3, 1, 4)
        q, k, v = qkv[0], qkv[1], qkv[2]
        phi = lambda t: torch.where(t > 0, t + 1, torch.exp(t)) + 1e-6
        pq, pk = phi(q), phi(k)
        kv = torch.einsum("bhsd,bhse->bhde", pk, v)
        z = torch.einsum("bhsd->bhd", pk)
        num = torch.einsum("bhqd,bhde->bhqe", pq, kv)
        den = torch.einsum("bhqd,bhd->bhq", pq, z)[..., None] + 1e-6
        o = num / den
        return (lambda x, *d: x.permute(*d))(o, 0, 2, 1, 3).reshape(B, S, D) @ wo

    def _B_ref(x, w1, b1, w2, b2):
        h = torch.einsum("bsd,df->bsf", x, w1) + b1
        h = _gelu(h)
        return torch.einsum("bsf,fd->bsd", h, w2) + b2

    x = A_x
    xn = _layernorm(x, axis=-1)
    return x + _A_ref(xn, A_wqkv, A_wo) + _B_ref(xn, B_w1, B_b1, B_w2, B_b2)
```

```asm
; @launch grid=(256,1,1) block=(512,1,1) lds=163840
.amdgcn_target "amdgcn-amd-amdhsa--gfx950"
.text
.globl parallel_sum__linear_attn_block__dense_activation_gelu__prompt_kernel
.p2align 8
.type parallel_sum__linear_attn_block__dense_activation_gelu__prompt_kernel,@function
parallel_sum__linear_attn_block__dense_activation_gelu__prompt_kernel:
    s_cmp_ge_u32 s2, 256
    s_cbranch_scc1 L_end
    s_load_dwordx16 s[4:19], s[0:1], 0
    s_load_dwordx4 s[20:23], s[0:1], 64
    s_load_dwordx2 s[24:25], s[0:1], 80
    v_lshrrev_b32 v1, 6, v0
    v_and_b32 v255, 63, v0
    v_readfirstlane_b32 s26, v1
    s_getpc_b64 s[94:95]
    s_lshr_b32 s92, s2, 3
    s_mulk_i32 s92, 11
    v_add_u32 v2, s92, v0
    v_lshlrev_b32 v2, 7, v2
    v_cmp_gt_u32 vcc, 11, v0
    s_nop 0
    s_and_saveexec_b64 s[92:93], vcc
    s_cbranch_execz L_nopf
    global_load_dword v252, v2, s[94:95]
L_nopf:
    s_mov_b64 exec, -1
    s_and_b32 s60, s2, 1
    s_lshl_b32 s60, s60, 3
    s_bfe_u32 s48, s2, 0x30003
    s_add_u32 s48, s48, s60
    v_lshrrev_b32 v3, 3, v255
    v_and_b32 v4, 7, v255
    v_lshrrev_b32 v5, 1, v3
    v_xor_b32 v4, v4, v5
    v_mul_u32_u24 v3, 1280, v3
    v_lshl_add_u32 v12, v4, 4, v3
    v_xor_b32 v13, 64, v12
    s_lshl_b32 s60, s48, 3
    s_add_u32 s60, s60, s26
    s_mulk_i32 s60, 20480
    s_add_u32 s61, s60, 10240
    s_lshl_b32 s62, s26, 11
    s_mov_b32 s30, 2621440
    s_mov_b32 s31, 0x20000
    s_add_u32 m0, s62, 86016
    s_waitcnt lgkmcnt(0)
    s_mov_b64 s[28:29], s[4:5]
    buffer_load_dwordx4 v12, s[28:31], s60 offen lds
    s_add_u32 m0, s62, 87040
    s_and_b32 s60, s2, 6
    buffer_load_dwordx4 v13, s[28:31], s61 offen lds
    s_bfe_u32 s61, s2, 0x10006
    s_add_u32 s60, s60, s61
    v_mul_u32_u24 v3, 2341, v0
    v_lshrrev_b32 v3, 16, v3
    v_mul_u32_u24 v4, 28, v3
    v_sub_u32 v4, v0, v4
    v_bfe_u32 v5, v3, 3, 1
    v_lshlrev_b32 v5, 1, v5
    v_xor_b32 v4, v4, v5
    s_cmp_ge_u32 s2, 128
    s_cbranch_scc1 L_t_f
    s_mov_b32 s50, 0
    s_mov_b32 s49, s60
    s_mul_i32 s52, s60, 160
    s_add_u32 s52, s52, 1280
    s_movk_i32 s53, 1120
    s_lshl_b32 s54, s60, 5
    s_sub_u32 s54, 0xfffff560, s54
    s_movk_i32 s51, 3840
    s_mov_b32 s55, 28
    s_branch L_t_done
L_t_f:
    s_add_u32 s49, s60, 8
    s_mov_b32 s53, 0
    s_mov_b32 s54, 0
    s_mul_i32 s52, s60, 448
    s_movk_i32 s51, 3072
    s_cmp_eq_u32 s60, 6
    s_cselect_b32 s55, 24, 28
    s_cmp_eq_u32 s60, 7
    s_cselect_b32 s50, 2, 1
    s_cselect_b32 s55, 16, s55
    s_cselect_b32 s52, 1024, s52
    s_cselect_b32 s51, 3840, s51
L_t_done:
    v_mul_u32_u24 v3, s51, v3
    v_lshl_add_u32 v3, v4, 4, v3
    v_cmp_le_u32 s[62:63], 10, v4
    v_cmp_le_u32 s[64:65], 20, v4
    v_cmp_le_u32 vcc, s55, v4
    v_mov_b32 v5, s53
    v_mov_b32 v6, s54
    v_cndmask_b32 v5, 0, v5, s[62:63]
    v_cndmask_b32 v6, 0, v6, s[64:65]
    v_add3_u32 v3, v3, v5, v6
    v_mov_b32 v5, 0x40000000
    v_add_u32 v3, s52, v3
    v_cndmask_b32 v3, v3, v5, vcc
    s_lshl_b32 s74, s26, 10
    s_lshl_b32 s75, s51, 4
    s_mul_i32 s34, s51, 640
    s_mov_b32 s35, 0x20000
    s_mov_b32 m0, s74
    s_cmp_eq_u32 s50, 1
    s_cselect_b64 s[32:33], s[12:13], s[6:7]
    buffer_load_dwordx4 v3, s[32:35], 0 offen lds
    s_add_u32 m0, s74, 7168
    v_lshlrev_b32 v254, 4, v255
    buffer_load_dwordx4 v3, s[32:35], s75 offen lds
    s_mov_b32 s36, s24
    s_mov_b32 s37, s25
    s_mov_b32 s38, 0x1000000
    s_mov_b32 s39, 0x20000
    s_mov_b32 s96, 12976128
    s_buffer_load_dword s101, s[36:39], s96
    v_lshlrev_b32 v4, 2, v0
    v_add_u32 v4, 155136, v4
    ds_write_b32 v4, v3
    s_and_b32 s27, s26, 3
    s_mov_b32 s97, 0xffff0000
    s_and_b32 s58, s2, 6
    s_lshl_b32 s58, s58, 2
    s_bfe_u32 s60, s2, 0x30003
    s_add_u32 s58, s58, s60
    s_and_b32 s59, s2, 1
    s_lshl_b32 s59, s59, 2
    s_lshr_b32 s60, s2, 6
    s_add_u32 s59, s59, s60
    s_barrier
    s_add_u32 m0, s74, 14336
    s_mul_i32 s60, s75, 2
    buffer_load_dwordx4 v3, s[32:35], s60 offen lds
    s_add_u32 m0, s74, 21504
    s_mul_i32 s60, s75, 3
    buffer_load_dwordx4 v3, s[32:35], s60 offen lds
    s_cmp_lt_u32 s26, 4
    s_cbranch_scc1 L_M
    s_cmp_ge_u32 s26, 6
    s_cbranch_scc1 L_AUX
    s_movk_i32 s62, 128
    s_lshl_b32 s67, s51, 5
    s_lshl_b32 s60, s27, 4
    s_add_u32 s60, s60, 64
    s_mul_i32 s63, s60, s51
    s_lshl_b32 s64, s48, 1
    s_add_u32 s64, s64, s27
    s_mul_i32 s64, s64, 81920
    s_mul_i32 s65, s27, 7168
    s_lshl_b32 s66, s27, 13
    s_add_u32 s66, s66, 86016
    v_lshlrev_b32 v16, 2, v255
    v_add_u32 v16, 155136, v16
    s_add_u32 s69, s64, s62
    s_add_u32 m0, s66, 16384
    s_add_u32 s60, s69, 0
    buffer_load_dwordx4 v12, s[28:31], s60 offen lds
    s_add_u32 m0, s66, 17408
    s_add_u32 s60, s69, 10240
    buffer_load_dwordx4 v13, s[28:31], s60 offen lds
    s_add_u32 m0, s66, 18432
    s_add_u32 s60, s69, 20480
    buffer_load_dwordx4 v12, s[28:31], s60 offen lds
    s_add_u32 m0, s66, 19456
    s_add_u32 s60, s69, 30720
    buffer_load_dwordx4 v13, s[28:31], s60 offen lds
    s_add_u32 s62, s62, 128
    s_add_u32 m0, s66, 20480
    s_add_u32 s60, s69, 40960
    buffer_load_dwordx4 v12, s[28:31], s60 offen lds
    s_add_u32 m0, s66, 21504
    s_add_u32 s60, s69, 51200
    buffer_load_dwordx4 v13, s[28:31], s60 offen lds
    s_add_u32 m0, s66, 22528
    s_add_u32 s60, s69, 61440
    buffer_load_dwordx4 v12, s[28:31], s60 offen lds
    s_add_u32 m0, s66, 23552
    s_add_u32 s60, s69, 71680
    buffer_load_dwordx4 v13, s[28:31], s60 offen lds
    s_waitcnt lgkmcnt(0)
    s_mul_i32 s101, s101, 0x9e3779b1
    s_add_u32 s101, s101, 0x7f4a7c15
    s_waitcnt vmcnt(10)
    s_barrier
    ds_read_b32 v4, v16 offset:0
    ds_read_b32 v5, v16 offset:256
    ds_read_b32 v6, v16 offset:512
    ds_read_b32 v7, v16 offset:768
    ds_read_b32 v8, v16 offset:1024
    ds_read_b32 v9, v16 offset:1280
    ds_read_b32 v10, v16 offset:1536
    s_waitcnt lgkmcnt(0)
    s_waitcnt vmcnt(8)
    s_barrier
    s_add_u32 m0, s65, 28672
    s_nop 0
    buffer_load_dwordx4 v4, s[32:35], s63 offen lds
    s_add_u32 m0, s65, 29696
    s_nop 0
    buffer_load_dwordx4 v5, s[32:35], s63 offen lds
    s_add_u32 m0, s65, 30720
    s_nop 0
    buffer_load_dwordx4 v6, s[32:35], s63 offen lds
    s_add_u32 m0, s65, 31744
    s_nop 0
    buffer_load_dwordx4 v7, s[32:35], s63 offen lds
    s_add_u32 m0, s65, 32768
    s_nop 0
    buffer_load_dwordx4 v8, s[32:35], s63 offen lds
    s_add_u32 m0, s65, 33792
    s_nop 0
    buffer_load_dwordx4 v9, s[32:35], s63 offen lds
    s_add_u32 m0, s65, 34816
    s_nop 0
    buffer_load_dwordx4 v10, s[32:35], s63 offen lds
    s_add_u32 s63, s63, s67
    s_add_u32 m0, s65, 43008
    s_nop 0
    buffer_load_dwordx4 v4, s[32:35], s63 offen lds
    s_add_u32 m0, s65, 44032
    s_nop 0
    buffer_load_dwordx4 v5, s[32:35], s63 offen lds
    s_add_u32 m0, s65, 45056
    s_nop 0
    buffer_load_dwordx4 v6, s[32:35], s63 offen lds
    s_add_u32 m0, s65, 46080
    s_nop 0
    buffer_load_dwordx4 v7, s[32:35], s63 offen lds
    s_add_u32 m0, s65, 47104
    s_nop 0
    buffer_load_dwordx4 v8, s[32:35], s63 offen lds
    s_add_u32 m0, s65, 48128
    s_nop 0
    buffer_load_dwordx4 v9, s[32:35], s63 offen lds
    s_add_u32 m0, s65, 49152
    s_nop 0
    buffer_load_dwordx4 v10, s[32:35], s63 offen lds
    s_add_u32 s63, s63, s67
    s_waitcnt vmcnt(7)
    s_barrier
    s_add_u32 s69, s64, s62
    s_add_u32 m0, s66, 32768
    s_add_u32 s60, s69, 0
    buffer_load_dwordx4 v12, s[28:31], s60 offen lds
    s_add_u32 m0, s66, 33792
    s_add_u32 s60, s69, 10240
    buffer_load_dwordx4 v13, s[28:31], s60 offen lds
    s_add_u32 m0, s66, 34816
    s_add_u32 s60, s69, 20480
    buffer_load_dwordx4 v12, s[28:31], s60 offen lds
    s_add_u32 m0, s66, 35840
    s_add_u32 s60, s69, 30720
    buffer_load_dwordx4 v13, s[28:31], s60 offen lds
    s_add_u32 s62, s62, 128
    s_add_u32 m0, s66, 36864
    s_add_u32 s60, s69, 40960
    buffer_load_dwordx4 v12, s[28:31], s60 offen lds
    s_add_u32 m0, s66, 37888
    s_add_u32 s60, s69, 51200
    buffer_load_dwordx4 v13, s[28:31], s60 offen lds
    s_add_u32 m0, s66, 38912
    s_add_u32 s60, s69, 61440
    buffer_load_dwordx4 v12, s[28:31], s60 offen lds
    s_add_u32 m0, s66, 39936
    s_add_u32 s60, s69, 71680
    buffer_load_dwordx4 v13, s[28:31], s60 offen lds
    s_add_u32 m0, s65, 57344
    s_nop 0
    buffer_load_dwordx4 v4, s[32:35], s63 offen lds
    s_add_u32 m0, s65, 58368
    s_nop 0
    buffer_load_dwordx4 v5, s[32:35], s63 offen lds
    s_add_u32 m0, s65, 59392
    s_nop 0
    buffer_load_dwordx4 v6, s[32:35], s63 offen lds
    s_add_u32 m0, s65, 60416
    s_nop 0
    buffer_load_dwordx4 v7, s[32:35], s63 offen lds
    s_add_u32 m0, s65, 61440
    s_nop 0
    buffer_load_dwordx4 v8, s[32:35], s63 offen lds
    s_add_u32 m0, s65, 62464
    s_nop 0
    buffer_load_dwordx4 v9, s[32:35], s63 offen lds
    s_add_u32 m0, s65, 63488
    s_nop 0
    buffer_load_dwordx4 v10, s[32:35], s63 offen lds
    s_add_u32 s63, s63, s67
    s_waitcnt vmcnt(15)
    s_barrier
    s_add_u32 m0, s65, 71680
    s_nop 0
    buffer_load_dwordx4 v4, s[32:35], s63 offen lds
    s_add_u32 m0, s65, 72704
    s_nop 0
    buffer_load_dwordx4 v5, s[32:35], s63 offen lds
    s_add_u32 m0, s65, 73728
    s_nop 0
    buffer_load_dwordx4 v6, s[32:35], s63 offen lds
    s_add_u32 m0, s65, 74752
    s_nop 0
    buffer_load_dwordx4 v7, s[32:35], s63 offen lds
    s_add_u32 m0, s65, 75776
    s_nop 0
    buffer_load_dwordx4 v8, s[32:35], s63 offen lds
    s_add_u32 m0, s65, 76800
    s_nop 0
    buffer_load_dwordx4 v9, s[32:35], s63 offen lds
    s_add_u32 m0, s65, 77824
    s_nop 0
    buffer_load_dwordx4 v10, s[32:35], s63 offen lds
    s_add_u32 s63, s63, s67
    s_add_u32 s69, s64, s62
    s_add_u32 m0, s66, 0
    s_add_u32 s60, s69, 0
    buffer_load_dwordx4 v12, s[28:31], s60 offen lds
    s_add_u32 m0, s66, 1024
    s_add_u32 s60, s69, 10240
    buffer_load_dwordx4 v13, s[28:31], s60 offen lds
    s_add_u32 m0, s66, 2048
    s_add_u32 s60, s69, 20480
    buffer_load_dwordx4 v12, s[28:31], s60 offen lds
    s_add_u32 m0, s66, 3072
    s_add_u32 s60, s69, 30720
    buffer_load_dwordx4 v13, s[28:31], s60 offen lds
    s_add_u32 s62, s62, 128
    s_add_u32 m0, s66, 4096
    s_add_u32 s60, s69, 40960
    buffer_load_dwordx4 v12, s[28:31], s60 offen lds
    s_add_u32 m0, s66, 5120
    s_add_u32 s60, s69, 51200
    buffer_load_dwordx4 v13, s[28:31], s60 offen lds
    s_add_u32 m0, s66, 6144
    s_add_u32 s60, s69, 61440
    buffer_load_dwordx4 v12, s[28:31], s60 offen lds
    s_add_u32 m0, s66, 7168
    s_add_u32 s60, s69, 71680
    buffer_load_dwordx4 v13, s[28:31], s60 offen lds
    s_add_u32 m0, s65, 0
    s_nop 0
    buffer_load_dwordx4 v4, s[32:35], s63 offen lds
    s_add_u32 m0, s65, 1024
    s_nop 0
    buffer_load_dwordx4 v5, s[32:35], s63 offen lds
    s_add_u32 m0, s65, 2048
    s_nop 0
    buffer_load_dwordx4 v6, s[32:35], s63 offen lds
    s_add_u32 m0, s65, 3072
    s_nop 0
    buffer_load_dwordx4 v7, s[32:35], s63 offen lds
    s_add_u32 m0, s65, 4096
    s_nop 0
    buffer_load_dwordx4 v8, s[32:35], s63 offen lds
    s_add_u32 m0, s65, 5120
    s_nop 0
    buffer_load_dwordx4 v9, s[32:35], s63 offen lds
    s_add_u32 m0, s65, 6144
    s_nop 0
    buffer_load_dwordx4 v10, s[32:35], s63 offen lds
    s_add_u32 s63, s63, s67
    s_waitcnt vmcnt(22)
    s_barrier
    s_add_u32 m0, s65, 14336
    s_nop 0
    buffer_load_dwordx4 v4, s[32:35], s63 offen lds
    s_add_u32 m0, s65, 15360
    s_nop 0
    buffer_load_dwordx4 v5, s[32:35], s63 offen lds
    s_add_u32 m0, s65, 16384
    s_nop 0
    buffer_load_dwordx4 v6, s[32:35], s63 offen lds
    s_add_u32 m0, s65, 17408
    s_nop 0
    buffer_load_dwordx4 v7, s[32:35], s63 offen lds
    s_add_u32 m0, s65, 18432
    s_nop 0
    buffer_load_dwordx4 v8, s[32:35], s63 offen lds
    s_add_u32 m0, s65, 19456
    s_nop 0
    buffer_load_dwordx4 v9, s[32:35], s63 offen lds
    s_add_u32 m0, s65, 20480
    s_nop 0
    buffer_load_dwordx4 v10, s[32:35], s63 offen lds
    s_add_u32 s63, s63, s67
    s_waitcnt vmcnt(22)
    s_barrier
    s_add_u32 s69, s64, s62
    s_add_u32 m0, s66, 16384
    s_add_u32 s60, s69, 0
    buffer_load_dwordx4 v12, s[28:31], s60 offen lds
    s_add_u32 m0, s66, 17408
    s_add_u32 s60, s69, 10240
    buffer_load_dwordx4 v13, s[28:31], s60 offen lds
    s_add_u32 m0, s66, 18432
    s_add_u32 s60, s69, 20480
    buffer_load_dwordx4 v12, s[28:31], s60 offen lds
    s_add_u32 m0, s66, 19456
    s_add_u32 s60, s69, 30720
    buffer_load_dwordx4 v13, s[28:31], s60 offen lds
    s_add_u32 s62, s62, 128
    s_add_u32 m0, s66, 20480
    s_add_u32 s60, s69, 40960
    buffer_load_dwordx4 v12, s[28:31], s60 offen lds
    s_add_u32 m0, s66, 21504
    s_add_u32 s60, s69, 51200
    buffer_load_dwordx4 v13, s[28:31], s60 offen lds
    s_add_u32 m0, s66, 22528
    s_add_u32 s60, s69, 61440
    buffer_load_dwordx4 v12, s[28:31], s60 offen lds
    s_add_u32 m0, s66, 23552
    s_add_u32 s60, s69, 71680
    buffer_load_dwordx4 v13, s[28:31], s60 offen lds
    s_add_u32 m0, s65, 28672
    s_nop 0
    buffer_load_dwordx4 v4, s[32:35], s63 offen lds
    s_add_u32 m0, s65, 29696
    s_nop 0
    buffer_load_dwordx4 v5, s[32:35], s63 offen lds
    s_add_u32 m0, s65, 30720
    s_nop 0
    buffer_load_dwordx4 v6, s[32:35], s63 offen lds
    s_add_u32 m0, s65, 31744
    s_nop 0
    buffer_load_dwordx4 v7, s[32:35], s63 offen lds
    s_add_u32 m0, s65, 32768
    s_nop 0
    buffer_load_dwordx4 v8, s[32:35], s63 offen lds
    s_add_u32 m0, s65, 33792
    s_nop 0
    buffer_load_dwordx4 v9, s[32:35], s63 offen lds
    s_add_u32 m0, s65, 34816
    s_nop 0
    buffer_load_dwordx4 v10, s[32:35], s63 offen lds
    s_add_u32 s63, s63, s67
    s_waitcnt vmcnt(22)
    s_barrier
    s_add_u32 m0, s65, 43008
    s_nop 0
    buffer_load_dwordx4 v4, s[32:35], s63 offen lds
    s_add_u32 m0, s65, 44032
    s_nop 0
    buffer_load_dwordx4 v5, s[32:35], s63 offen lds
    s_add_u32 m0, s65, 45056
    s_nop 0
    buffer_load_dwordx4 v6, s[32:35], s63 offen lds
    s_add_u32 m0, s65, 46080
    s_nop 0
    buffer_load_dwordx4 v7, s[32:35], s63 offen lds
    s_add_u32 m0, s65, 47104
    s_nop 0
    buffer_load_dwordx4 v8, s[32:35], s63 offen lds
    s_add_u32 m0, s65, 48128
    s_nop 0
    buffer_load_dwordx4 v9, s[32:35], s63 offen lds
    s_add_u32 m0, s65, 49152
    s_nop 0
    buffer_load_dwordx4 v10, s[32:35], s63 offen lds
    s_add_u32 s63, s63, s67
    s_add_u32 s60, s27, 0
    s_and_b32 s60, s60, 3
    s_lshl_b32 s61, s58, 2
    s_add_u32 s60, s60, s61
    s_mul_i32 s88, s60, 69632
    s_mul_i32 s98, s60, 20480
    s_mul_i32 s99, s59, 160
    s_add_u32 s98, s98, s99
    s_add_u32 s60, s27, 1
    s_and_b32 s60, s60, 3
    s_lshl_b32 s61, s58, 2
    s_add_u32 s60, s60, s61
    s_mul_i32 s89, s60, 69632
    s_add_u32 s60, s27, 2
    s_and_b32 s60, s60, 3
    s_lshl_b32 s61, s58, 2
    s_add_u32 s60, s60, s61
    s_mul_i32 s90, s60, 69632
    s_add_u32 s60, s27, 3
    s_and_b32 s60, s60, 3
    s_lshl_b32 s61, s58, 2
    s_add_u32 s60, s60, s61
    s_mul_i32 s91, s60, 69632
    s_mov_b32 s60, 0
    s_mul_i32 s61, s27, 12
    s_add_u32 s76, s60, s61
    s_lshl_b32 s76, s76, 10
    s_add_u32 s60, s60, 1
    s_cmp_eq_u32 s60, 12
    s_cselect_b32 s60, 0, s60
    s_add_u32 s77, s60, s61
    s_lshl_b32 s77, s77, 10
    s_add_u32 s60, s60, 1
    s_cmp_eq_u32 s60, 12
    s_cselect_b32 s60, 0, s60
    s_add_u32 s78, s60, s61
    s_lshl_b32 s78, s78, 10
    s_add_u32 s60, s60, 1
    s_cmp_eq_u32 s60, 12
    s_cselect_b32 s60, 0, s60
    s_add_u32 s79, s60, s61
    s_lshl_b32 s79, s79, 10
    s_add_u32 s60, s60, 1
    s_cmp_eq_u32 s60, 12
    s_cselect_b32 s60, 0, s60
    s_add_u32 s80, s60, s61
    s_lshl_b32 s80, s80, 10
    s_add_u32 s60, s60, 1
    s_cmp_eq_u32 s60, 12
    s_cselect_b32 s60, 0, s60
    s_add_u32 s81, s60, s61
    s_lshl_b32 s81, s81, 10
    s_add_u32 s60, s60, 1
    s_cmp_eq_u32 s60, 12
    s_cselect_b32 s60, 0, s60
    s_add_u32 s82, s60, s61
    s_lshl_b32 s82, s82, 10
    s_add_u32 s60, s60, 1
    s_cmp_eq_u32 s60, 12
    s_cselect_b32 s60, 0, s60
    s_add_u32 s83, s60, s61
    s_lshl_b32 s83, s83, 10
    s_add_u32 s60, s60, 1
    s_cmp_eq_u32 s60, 12
    s_cselect_b32 s60, 0, s60
    s_add_u32 s84, s60, s61
    s_lshl_b32 s84, s84, 10
    s_add_u32 s60, s60, 1
    s_cmp_eq_u32 s60, 12
    s_cselect_b32 s60, 0, s60
    s_add_u32 s85, s60, s61
    s_lshl_b32 s85, s85, 10
    s_add_u32 s60, s60, 1
    s_cmp_eq_u32 s60, 12
    s_cselect_b32 s60, 0, s60
    s_add_u32 s86, s60, s61
    s_lshl_b32 s86, s86, 10
    s_add_u32 s60, s60, 1
    s_cmp_eq_u32 s60, 12
    s_cselect_b32 s60, 0, s60
    s_add_u32 s87, s60, s61
    s_lshl_b32 s87, s87, 10
    s_mul_i32 s100, s59, 348160
    s_add_u32 s100, s100, 9437184
    s_waitcnt vmcnt(22)
    s_barrier
    s_add_u32 s69, s64, s62
    s_add_u32 m0, s66, 32768
    s_add_u32 s60, s69, 0
    buffer_load_dwordx4 v12, s[28:31], s60 offen lds
    s_add_u32 m0, s66, 33792
    s_add_u32 s60, s69, 10240
    buffer_load_dwordx4 v13, s[28:31], s60 offen lds
    s_add_u32 m0, s66, 34816
    s_add_u32 s60, s69, 20480
    buffer_load_dwordx4 v12, s[28:31], s60 offen lds
    s_add_u32 m0, s66, 35840
    s_add_u32 s60, s69, 30720
    buffer_load_dwordx4 v13, s[28:31], s60 offen lds
    s_add_u32 s62, s62, 128
    s_add_u32 m0, s66, 36864
    s_add_u32 s60, s69, 40960
    buffer_load_dwordx4 v12, s[28:31], s60 offen lds
    s_add_u32 m0, s66, 37888
    s_add_u32 s60, s69, 51200
    buffer_load_dwordx4 v13, s[28:31], s60 offen lds
    s_add_u32 m0, s66, 38912
    s_add_u32 s60, s69, 61440
    buffer_load_dwordx4 v12, s[28:31], s60 offen lds
    s_add_u32 m0, s66, 39936
    s_add_u32 s60, s69, 71680
    buffer_load_dwordx4 v13, s[28:31], s60 offen lds
    s_add_u32 m0, s65, 57344
    s_nop 0
    buffer_load_dwordx4 v4, s[32:35], s63 offen lds
    s_add_u32 m0, s65, 58368
    s_nop 0
    buffer_load_dwordx4 v5, s[32:35], s63 offen lds
    s_add_u32 m0, s65, 59392
    s_nop 0
    buffer_load_dwordx4 v6, s[32:35], s63 offen lds
    s_add_u32 m0, s65, 60416
    s_nop 0
    buffer_load_dwordx4 v7, s[32:35], s63 offen lds
    s_add_u32 m0, s65, 61440
    s_nop 0
    buffer_load_dwordx4 v8, s[32:35], s63 offen lds
    s_add_u32 m0, s65, 62464
    s_nop 0
    buffer_load_dwordx4 v9, s[32:35], s63 offen lds
    s_add_u32 m0, s65, 63488
    s_nop 0
    buffer_load_dwordx4 v10, s[32:35], s63 offen lds
    s_add_u32 s63, s63, s67
    s_waitcnt vmcnt(22)
    s_barrier
    s_add_u32 m0, s65, 71680
    s_nop 0
    buffer_load_dwordx4 v4, s[32:35], s63 offen lds
    s_add_u32 m0, s65, 72704
    s_nop 0
    buffer_load_dwordx4 v5, s[32:35], s63 offen lds
    s_add_u32 m0, s65, 73728
    s_nop 0
    buffer_load_dwordx4 v6, s[32:35], s63 offen lds
    s_add_u32 m0, s65, 74752
    s_nop 0
    buffer_load_dwordx4 v7, s[32:35], s63 offen lds
    s_add_u32 m0, s65, 75776
    s_nop 0
    buffer_load_dwordx4 v8, s[32:35], s63 offen lds
    s_add_u32 m0, s65, 76800
    s_nop 0
    buffer_load_dwordx4 v9, s[32:35], s63 offen lds
    s_add_u32 m0, s65, 77824
    s_nop 0
    buffer_load_dwordx4 v10, s[32:35], s63 offen lds
    s_add_u32 s63, s63, s67
    s_waitcnt vmcnt(22)
    s_barrier
    s_add_u32 s69, s64, s62
    s_add_u32 m0, s66, 0
    s_add_u32 s60, s69, 0
    buffer_load_dwordx4 v12, s[28:31], s60 offen lds
    s_add_u32 m0, s66, 1024
    s_add_u32 s60, s69, 10240
    buffer_load_dwordx4 v13, s[28:31], s60 offen lds
    s_add_u32 m0, s66, 2048
    s_add_u32 s60, s69, 20480
    buffer_load_dwordx4 v12, s[28:31], s60 offen lds
    s_add_u32 m0, s66, 3072
    s_add_u32 s60, s69, 30720
    buffer_load_dwordx4 v13, s[28:31], s60 offen lds
    s_add_u32 s62, s62, 128
    s_add_u32 m0, s66, 4096
    s_add_u32 s60, s69, 40960
    buffer_load_dwordx4 v12, s[28:31], s60 offen lds
    s_add_u32 m0, s66, 5120
    s_add_u32 s60, s69, 51200
    buffer_load_dwordx4 v13, s[28:31], s60 offen lds
    s_add_u32 m0, s66, 6144
    s_add_u32 s60, s69, 61440
    buffer_load_dwordx4 v12, s[28:31], s60 offen lds
    s_add_u32 m0, s66, 7168
    s_add_u32 s60, s69, 71680
    buffer_load_dwordx4 v13, s[28:31], s60 offen lds
    s_add_u32 m0, s65, 0
    s_nop 0
    buffer_load_dwordx4 v4, s[32:35], s63 offen lds
    s_add_u32 m0, s65, 1024
    s_nop 0
    buffer_load_dwordx4 v5, s[32:35], s63 offen lds
    s_add_u32 m0, s65, 2048
    s_nop 0
    buffer_load_dwordx4 v6, s[32:35], s63 offen lds
    s_add_u32 m0, s65, 3072
    s_nop 0
    buffer_load_dwordx4 v7, s[32:35], s63 offen lds
    s_add_u32 m0, s65, 4096
    s_nop 0
    buffer_load_dwordx4 v8, s[32:35], s63 offen lds
    s_add_u32 m0, s65, 5120
    s_nop 0
    buffer_load_dwordx4 v9, s[32:35], s63 offen lds
    s_add_u32 m0, s65, 6144
    s_nop 0
    buffer_load_dwordx4 v10, s[32:35], s63 offen lds
    s_add_u32 s63, s63, s67
    s_waitcnt vmcnt(22)
    s_barrier
    s_add_u32 m0, s65, 14336
    s_nop 0
    buffer_load_dwordx4 v4, s[32:35], s63 offen lds
    s_add_u32 m0, s65, 15360
    s_nop 0
    buffer_load_dwordx4 v5, s[32:35], s63 offen lds
    s_add_u32 m0, s65, 16384
    s_nop 0
    buffer_load_dwordx4 v6, s[32:35], s63 offen lds
    s_add_u32 m0, s65, 17408
    s_nop 0
    buffer_load_dwordx4 v7, s[32:35], s63 offen lds
    s_add_u32 m0, s65, 18432
    s_nop 0
    buffer_load_dwordx4 v8, s[32:35], s63 offen lds
    s_add_u32 m0, s65, 19456
    s_nop 0
    buffer_load_dwordx4 v9, s[32:35], s63 offen lds
    s_add_u32 m0, s65, 20480
    s_nop 0
    buffer_load_dwordx4 v10, s[32:35], s63 offen lds
    s_add_u32 s63, s63, s67
    s_waitcnt vmcnt(22)
    s_barrier
    s_add_u32 s69, s64, s62
    s_add_u32 m0, s66, 16384
    s_add_u32 s60, s69, 0
    buffer_load_dwordx4 v12, s[28:31], s60 offen lds
    s_add_u32 m0, s66, 17408
    s_add_u32 s60, s69, 10240
    buffer_load_dwordx4 v13, s[28:31], s60 offen lds
    s_add_u32 m0, s66, 18432
    s_add_u32 s60, s69, 20480
    buffer_load_dwordx4 v12, s[28:31], s60 offen lds
    s_add_u32 m0, s66, 19456
    s_add_u32 s60, s69, 30720
    buffer_load_dwordx4 v13, s[28:31], s60 offen lds
    s_add_u32 s62, s62, 128
    s_add_u32 m0, s66, 20480
    s_add_u32 s60, s69, 40960
    buffer_load_dwordx4 v12, s[28:31], s60 offen lds
    s_add_u32 m0, s66, 21504
    s_add_u32 s60, s69, 51200
    buffer_load_dwordx4 v13, s[28:31], s60 offen lds
    s_add_u32 m0, s66, 22528
    s_add_u32 s60, s69, 61440
    buffer_load_dwordx4 v12, s[28:31], s60 offen lds
    s_add_u32 m0, s66, 23552
    s_add_u32 s60, s69, 71680
    buffer_load_dwordx4 v13, s[28:31], s60 offen lds
    s_add_u32 m0, s65, 28672
    s_nop 0
    buffer_load_dwordx4 v4, s[32:35], s63 offen lds
    s_add_u32 m0, s65, 29696
    s_nop 0
    buffer_load_dwordx4 v5, s[32:35], s63 offen lds
    s_add_u32 m0, s65, 30720
    s_nop 0
    buffer_load_dwordx4 v6, s[32:35], s63 offen lds
    s_add_u32 m0, s65, 31744
    s_nop 0
    buffer_load_dwordx4 v7, s[32:35], s63 offen lds
    s_add_u32 m0, s65, 32768
    s_nop 0
    buffer_load_dwordx4 v8, s[32:35], s63 offen lds
    s_add_u32 m0, s65, 33792
    s_nop 0
    buffer_load_dwordx4 v9, s[32:35], s63 offen lds
    s_add_u32 m0, s65, 34816
    s_nop 0
    buffer_load_dwordx4 v10, s[32:35], s63 offen lds
    s_add_u32 s63, s63, s67
    s_waitcnt vmcnt(22)
    s_barrier
    s_add_u32 m0, s65, 43008
    s_nop 0
    buffer_load_dwordx4 v4, s[32:35], s63 offen lds
    s_add_u32 m0, s65, 44032
    s_nop 0
    buffer_load_dwordx4 v5, s[32:35], s63 offen lds
    s_add_u32 m0, s65, 45056
    s_nop 0
    buffer_load_dwordx4 v6, s[32:35], s63 offen lds
    s_add_u32 m0, s65, 46080
    s_nop 0
    buffer_load_dwordx4 v7, s[32:35], s63 offen lds
    s_add_u32 m0, s65, 47104
    s_nop 0
    buffer_load_dwordx4 v8, s[32:35], s63 offen lds
    s_add_u32 m0, s65, 48128
    s_nop 0
    buffer_load_dwordx4 v9, s[32:35], s63 offen lds
    s_add_u32 m0, s65, 49152
    s_nop 0
    buffer_load_dwordx4 v10, s[32:35], s63 offen lds
    s_add_u32 s63, s63, s67
    s_waitcnt vmcnt(22)
    s_barrier
    s_add_u32 s69, s64, s62
    s_add_u32 m0, s66, 32768
    s_add_u32 s60, s69, 0
    buffer_load_dwordx4 v12, s[28:31], s60 offen lds
    s_add_u32 m0, s66, 33792
    s_add_u32 s60, s69, 10240
    buffer_load_dwordx4 v13, s[28:31], s60 offen lds
    s_add_u32 m0, s66, 34816
    s_add_u32 s60, s69, 20480
    buffer_load_dwordx4 v12, s[28:31], s60 offen lds
    s_add_u32 m0, s66, 35840
    s_add_u32 s60, s69, 30720
    buffer_load_dwordx4 v13, s[28:31], s60 offen lds
    s_add_u32 s62, s62, 128
    s_add_u32 m0, s66, 36864
    s_add_u32 s60, s69, 40960
    buffer_load_dwordx4 v12, s[28:31], s60 offen lds
    s_add_u32 m0, s66, 37888
    s_add_u32 s60, s69, 51200
    buffer_load_dwordx4 v13, s[28:31], s60 offen lds
    s_add_u32 m0, s66, 38912
    s_add_u32 s60, s69, 61440
    buffer_load_dwordx4 v12, s[28:31], s60 offen lds
    s_add_u32 m0, s66, 39936
    s_add_u32 s60, s69, 71680
    buffer_load_dwordx4 v13, s[28:31], s60 offen lds
    s_add_u32 m0, s65, 57344
    s_nop 0
    buffer_load_dwordx4 v4, s[32:35], s63 offen lds
    s_add_u32 m0, s65, 58368
    s_nop 0
    buffer_load_dwordx4 v5, s[32:35], s63 offen lds
    s_add_u32 m0, s65, 59392
    s_nop 0
    buffer_load_dwordx4 v6, s[32:35], s63 offen lds
    s_add_u32 m0, s65, 60416
    s_nop 0
    buffer_load_dwordx4 v7, s[32:35], s63 offen lds
    s_add_u32 m0, s65, 61440
    s_nop 0
    buffer_load_dwordx4 v8, s[32:35], s63 offen lds
    s_add_u32 m0, s65, 62464
    s_nop 0
    buffer_load_dwordx4 v9, s[32:35], s63 offen lds
    s_add_u32 m0, s65, 63488
    s_nop 0
    buffer_load_dwordx4 v10, s[32:35], s63 offen lds
    s_add_u32 s63, s63, s67
    s_waitcnt vmcnt(22)
    s_barrier
    s_add_u32 m0, s65, 71680
    s_nop 0
    buffer_load_dwordx4 v4, s[32:35], s63 offen lds
    s_add_u32 m0, s65, 72704
    s_nop 0
    buffer_load_dwordx4 v5, s[32:35], s63 offen lds
    s_add_u32 m0, s65, 73728
    s_nop 0
    buffer_load_dwordx4 v6, s[32:35], s63 offen lds
    s_add_u32 m0, s65, 74752
    s_nop 0
    buffer_load_dwordx4 v7, s[32:35], s63 offen lds
    s_add_u32 m0, s65, 75776
    s_nop 0
    buffer_load_dwordx4 v8, s[32:35], s63 offen lds
    s_add_u32 m0, s65, 76800
    s_nop 0
    buffer_load_dwordx4 v9, s[32:35], s63 offen lds
    s_add_u32 m0, s65, 77824
    s_nop 0
    buffer_load_dwordx4 v10, s[32:35], s63 offen lds
    s_add_u32 s63, s63, s67
    s_waitcnt vmcnt(22)
    s_barrier
    s_add_u32 s69, s64, s62
    s_add_u32 m0, s66, 0
    s_add_u32 s60, s69, 0
    buffer_load_dwordx4 v12, s[28:31], s60 offen lds
    s_add_u32 m0, s66, 1024
    s_add_u32 s60, s69, 10240
    buffer_load_dwordx4 v13, s[28:31], s60 offen lds
    s_add_u32 m0, s66, 2048
    s_add_u32 s60, s69, 20480
    buffer_load_dwordx4 v12, s[28:31], s60 offen lds
    s_add_u32 m0, s66, 3072
    s_add_u32 s60, s69, 30720
    buffer_load_dwordx4 v13, s[28:31], s60 offen lds
    s_add_u32 s62, s62, 128
    s_add_u32 m0, s66, 4096
    s_add_u32 s60, s69, 40960
    buffer_load_dwordx4 v12, s[28:31], s60 offen lds
    s_add_u32 m0, s66, 5120
    s_add_u32 s60, s69, 51200
    buffer_load_dwordx4 v13, s[28:31], s60 offen lds
    s_add_u32 m0, s66, 6144
    s_add_u32 s60, s69, 61440
    buffer_load_dwordx4 v12, s[28:31], s60 offen lds
    s_add_u32 m0, s66, 7168
    s_add_u32 s60, s69, 71680
    buffer_load_dwordx4 v13, s[28:31], s60 offen lds
    s_add_u32 m0, s65, 0
    s_nop 0
    buffer_load_dwordx4 v4, s[32:35], s63 offen lds
    s_add_u32 m0, s65, 1024
    s_nop 0
    buffer_load_dwordx4 v5, s[32:35], s63 offen lds
    s_add_u32 m0, s65, 2048
    s_nop 0
    buffer_load_dwordx4 v6, s[32:35], s63 offen lds
    s_add_u32 m0, s65, 3072
    s_nop 0
    buffer_load_dwordx4 v7, s[32:35], s63 offen lds
    s_add_u32 m0, s65, 4096
    s_nop 0
    buffer_load_dwordx4 v8, s[32:35], s63 offen lds
    s_add_u32 m0, s65, 5120
    s_nop 0
    buffer_load_dwordx4 v9, s[32:35], s63 offen lds
    s_add_u32 m0, s65, 6144
    s_nop 0
    buffer_load_dwordx4 v10, s[32:35], s63 offen lds
    s_add_u32 s63, s63, s67
    s_waitcnt vmcnt(22)
    s_barrier
    s_add_u32 m0, s65, 14336
    s_nop 0
    buffer_load_dwordx4 v4, s[32:35], s63 offen lds
    s_add_u32 m0, s65, 15360
    s_nop 0
    buffer_load_dwordx4 v5, s[32:35], s63 offen lds
    s_add_u32 m0, s65, 16384
    s_nop 0
    buffer_load_dwordx4 v6, s[32:35], s63 offen lds
    s_add_u32 m0, s65, 17408
    s_nop 0
    buffer_load_dwordx4 v7, s[32:35], s63 offen lds
    s_add_u32 m0, s65, 18432
    s_nop 0
    buffer_load_dwordx4 v8, s[32:35], s63 offen lds
    s_add_u32 m0, s65, 19456
    s_nop 0
    buffer_load_dwordx4 v9, s[32:35], s63 offen lds
    s_add_u32 m0, s65, 20480
    s_nop 0
    buffer_load_dwordx4 v10, s[32:35], s63 offen lds
    s_add_u32 s63, s63, s67
    s_waitcnt vmcnt(22)
    s_barrier
    v_and_b32 v36, 15, v255
    v_mul_u32_u24 v36, 1280, v36
    v_lshrrev_b32 v37, 4, v255
    v_lshlrev_b32 v37, 3, v37
    v_bfe_u32 v38, v255, 4, 1
    v_lshrrev_b32 v39, 5, v255
    v_lshlrev_b32 v38, 5, v38
    v_lshl_add_u32 v38, v39, 4, v38
    v_add_u32 v39, v36, v38
    v_add_u32 v36, v36, v37
    buffer_load_dwordx4 v[40:43], v39, s[28:31], s98 offen
    buffer_load_dwordx4 v[44:47], v39, s[28:31], s98 offen offset:64
    buffer_load_dwordx2 v[48:49], v36, s[28:31], s98 offen offset:128
    s_waitcnt vmcnt(3)
    s_barrier
    s_mul_i32 s60, s76, 5
    s_add_u32 s60, s60, s100
    buffer_load_dwordx4 v[80:83], v254, s[36:39], s60 offen offset:0 sc1
    s_mul_i32 s60, s76, 5
    s_add_u32 s60, s60, s100
    buffer_load_dwordx4 v[84:87], v254, s[36:39], s60 offen offset:1024 sc1
    s_mul_i32 s60, s76, 5
    s_add_u32 s60, s60, s100
    buffer_load_dwordx4 v[88:91], v254, s[36:39], s60 offen offset:2048 sc1
    s_mul_i32 s60, s76, 5
    s_add_u32 s60, s60, s100
    buffer_load_dwordx4 v[92:95], v254, s[36:39], s60 offen offset:3072 sc1
    s_mul_i32 s60, s76, 5
    s_add_u32 s60, s60, s100
    s_add_u32 s60, s60, 4096
    buffer_load_dwordx4 v[96:99], v254, s[36:39], s60 offen offset:0 sc1
    s_mul_i32 s60, s77, 5
    s_add_u32 s60, s60, s100
    buffer_load_dwordx4 v[100:103], v254, s[36:39], s60 offen offset:0 sc1
    s_mul_i32 s60, s77, 5
    s_add_u32 s60, s60, s100
    buffer_load_dwordx4 v[104:107], v254, s[36:39], s60 offen offset:1024 sc1
    s_mul_i32 s60, s77, 5
    s_add_u32 s60, s60, s100
    buffer_load_dwordx4 v[108:111], v254, s[36:39], s60 offen offset:2048 sc1
    s_mul_i32 s60, s77, 5
    s_add_u32 s60, s60, s100
    buffer_load_dwordx4 v[112:115], v254, s[36:39], s60 offen offset:3072 sc1
    s_mul_i32 s60, s77, 5
    s_add_u32 s60, s60, s100
    s_add_u32 s60, s60, 4096
    buffer_load_dwordx4 v[116:119], v254, s[36:39], s60 offen offset:0 sc1
    s_mul_i32 s60, s78, 5
    s_add_u32 s60, s60, s100
    buffer_load_dwordx4 v[120:123], v254, s[36:39], s60 offen offset:0 sc1
    s_mul_i32 s60, s78, 5
    s_add_u32 s60, s60, s100
    buffer_load_dwordx4 v[124:127], v254, s[36:39], s60 offen offset:1024 sc1
    s_mul_i32 s60, s78, 5
    s_add_u32 s60, s60, s100
    buffer_load_dwordx4 v[128:131], v254, s[36:39], s60 offen offset:2048 sc1
    s_mul_i32 s60, s78, 5
    s_add_u32 s60, s60, s100
    buffer_load_dwordx4 v[132:135], v254, s[36:39], s60 offen offset:3072 sc1
    s_mul_i32 s60, s78, 5
    s_add_u32 s60, s60, s100
    s_add_u32 s60, s60, 4096
    buffer_load_dwordx4 v[136:139], v254, s[36:39], s60 offen offset:0 sc1
    s_mul_i32 s60, s79, 5
    s_add_u32 s60, s60, s100
    buffer_load_dwordx4 v[140:143], v254, s[36:39], s60 offen offset:0 sc1
    s_mul_i32 s60, s79, 5
    s_add_u32 s60, s60, s100
    buffer_load_dwordx4 v[144:147], v254, s[36:39], s60 offen offset:1024 sc1
    s_mul_i32 s60, s79, 5
    s_add_u32 s60, s60, s100
    buffer_load_dwordx4 v[148:151], v254, s[36:39], s60 offen offset:2048 sc1
    s_mul_i32 s60, s79, 5
    s_add_u32 s60, s60, s100
    buffer_load_dwordx4 v[152:155], v254, s[36:39], s60 offen offset:3072 sc1
    s_mul_i32 s60, s79, 5
    s_add_u32 s60, s60, s100
    s_add_u32 s60, s60, 4096
    buffer_load_dwordx4 v[156:159], v254, s[36:39], s60 offen offset:0 sc1
    s_mul_i32 s60, s80, 5
    s_add_u32 s60, s60, s100
    buffer_load_dwordx4 v[160:163], v254, s[36:39], s60 offen offset:0 sc1
    s_mul_i32 s60, s80, 5
    s_add_u32 s60, s60, s100
    buffer_load_dwordx4 v[164:167], v254, s[36:39], s60 offen offset:1024 sc1
    s_mul_i32 s60, s80, 5
    s_add_u32 s60, s60, s100
    buffer_load_dwordx4 v[168:171], v254, s[36:39], s60 offen offset:2048 sc1
    s_mul_i32 s60, s80, 5
    s_add_u32 s60, s60, s100
    buffer_load_dwordx4 v[172:175], v254, s[36:39], s60 offen offset:3072 sc1
    s_mul_i32 s60, s80, 5
    s_add_u32 s60, s60, s100
    s_add_u32 s60, s60, 4096
    buffer_load_dwordx4 v[176:179], v254, s[36:39], s60 offen offset:0 sc1
    s_mul_i32 s60, s81, 5
    s_add_u32 s60, s60, s100
    buffer_load_dwordx4 v[180:183], v254, s[36:39], s60 offen offset:0 sc1
    s_mul_i32 s60, s81, 5
    s_add_u32 s60, s60, s100
    buffer_load_dwordx4 v[184:187], v254, s[36:39], s60 offen offset:1024 sc1
    s_mul_i32 s60, s81, 5
    s_add_u32 s60, s60, s100
    buffer_load_dwordx4 v[188:191], v254, s[36:39], s60 offen offset:2048 sc1
    s_mul_i32 s60, s81, 5
    s_add_u32 s60, s60, s100
    buffer_load_dwordx4 v[192:195], v254, s[36:39], s60 offen offset:3072 sc1
    s_mul_i32 s60, s81, 5
    s_add_u32 s60, s60, s100
    s_add_u32 s60, s60, 4096
    buffer_load_dwordx4 v[196:199], v254, s[36:39], s60 offen offset:0 sc1
    s_branch L_H2
L_AUX:
    s_sub_u32 s62, s26, 6
    v_mov_b32 v62, 0
    v_lshlrev_b32 v63, 2, v255
    v_add_u32 v63, 163328, v63
    ds_write_b32 v63, v62
    v_mov_b32 v76, 0
    v_mov_b32 v77, 0
    v_mov_b32 v78, 0
    v_mov_b32 v79, 0
    s_cmp_eq_u32 s50, 1
    s_cselect_b32 s57, 1920, 0
    s_lshr_b32 s74, s2, 4
    s_xor_b32 s74, s74, 15
    s_bfe_u32 s75, s2, 0x20001
    s_and_b32 s65, s2, 1
    s_lshl_b32 s65, s65, 1
    s_bfe_u32 s60, s2, 0x10003
    s_add_u32 s65, s65, s60
    s_lshr_b32 s60, s75, 1
    s_mul_i32 s60, s60, 5
    s_and_b32 s61, s75, 1
    s_mul_i32 s64, s61, 3
    s_add_u32 s64, s64, s60
    s_add_u32 s64, s64, s74
    s_add_u32 s64, s64, 10
    s_add_u32 s61, s61, s74
    s_cmp_ge_u32 s61, 3
    s_cselect_b32 s60, 7, 0
    s_add_u32 s64, s64, s60
    s_lshl_b32 s60, s75, 1
    s_add_u32 s60, s60, s74
    s_sub_u32 s60, s60, 5
    s_cmp_ge_u32 s74, 5
    s_cselect_b32 s64, s60, s64
    s_mul_i32 s60, s75, 7
    s_add_u32 s60, s60, s74
    s_add_u32 s60, s60, 23
    s_cmp_ge_u32 s74, 7
    s_cselect_b32 s64, s60, s64
    s_cmp_ge_u32 s74, 14
    s_cselect_b32 s64, 64, s64
    s_sub_u32 s60, s64, 46
    s_cmp_ge_u32 s64, 54
    s_cselect_b32 s61, s60, s64
    s_cmp_ge_u32 s64, 56
    s_cselect_b32 s64, 64, s61
    s_cmp_ge_u32 s64, 30
    s_cselect_b32 s40, s12, s6
    s_cselect_b32 s41, s13, s7
    s_mov_b32 s67, 3840
    s_cselect_b32 s67, 3072, s67
    s_cselect_b32 s66, 30, 0
    s_mul_i32 s42, s67, 640
    s_mov_b32 s43, 0x20000
    s_cmp_ge_u32 s64, 54
    s_cselect_b32 s42, 0, s42
    s_sub_u32 s66, s64, s66
    s_lshl_b32 s66, s66, 7
    s_lshl_b32 s60, s62, 6
    s_add_u32 s66, s66, s60
    s_mul_i32 s68, s65, 16
    s_mul_i32 s68, s68, s67
    s_add_u32 s68, s68, s66
    v_lshrrev_b32 v61, 2, v255
    v_mul_lo_u32 v61, v61, s67
    v_and_b32 v62, 3, v255
    v_lshl_add_u32 v69, v62, 4, v61
    s_lshl_b32 s67, s67, 6
    s_waitcnt lgkmcnt(0)
    s_mul_i32 s101, s101, 0x9e3779b1
    s_add_u32 s101, s101, 0x7f4a7c15
    s_waitcnt vmcnt(2)
    s_barrier
    buffer_load_dwordx4 v[20:23], v69, s[40:43], s68 offen
    s_add_u32 s68, s68, s67
    buffer_load_dwordx4 v[24:27], v69, s[40:43], s68 offen
    s_add_u32 s68, s68, s67
    buffer_load_dwordx4 v[28:31], v69, s[40:43], s68 offen
    s_add_u32 s68, s68, s67
    buffer_load_dwordx4 v[32:35], v69, s[40:43], s68 offen
    s_add_u32 s68, s68, s67
    buffer_load_dwordx4 v[36:39], v69, s[40:43], s68 offen
    s_add_u32 s68, s68, s67
    buffer_load_dwordx4 v[40:43], v69, s[40:43], s68 offen
    s_add_u32 s68, s68, s67
    buffer_load_dwordx4 v[44:47], v69, s[40:43], s68 offen
    s_add_u32 s68, s68, s67
    buffer_load_dwordx4 v[48:51], v69, s[40:43], s68 offen
    s_add_u32 s68, s68, s67
    buffer_load_dwordx4 v[52:55], v69, s[40:43], s68 offen
    s_add_u32 s68, s68, s67
    buffer_load_dwordx4 v[56:59], v69, s[40:43], s68 offen
    s_add_u32 s68, s68, s67
    v_lshlrev_b32 v61, 2, v255
    s_mov_b32 s44, s14
    s_mov_b32 s45, s15
    s_cmp_eq_u32 s50, 1
    s_cselect_b32 s46, 3072, 0
    s_mov_b32 s47, 0x20000
    s_mul_i32 s60, s62, 224
    s_add_u32 s60, s60, s52
    buffer_load_dword v239, v61, s[44:47], s60 offen
    s_mov_b32 s44, s18
    s_mov_b32 s45, s19
    s_mov_b32 s46, 0x500
    s_mov_b32 s47, 0x20000
    s_cmp_eq_u32 s62, 0
    s_cbranch_scc1 L_sk1
    s_mul_i32 s60, s59, 160
    s_mov_b32 exec_hi, 0xff
    buffer_load_dword v238, v61, s[44:47], s60 offen
    s_mov_b32 exec_hi, -1
L_sk1:
    s_waitcnt vmcnt(11)
    s_barrier
    s_and_b32 s72, s2, 127
    s_lshl_b32 s60, s62, 7
    s_add_u32 s72, s72, s60
    s_cmp_ge_u32 s2, 128
    s_cbranch_scc1 L_un_done
    s_lshr_b32 s60, s2, 3
    s_and_b32 s61, s2, 7
    s_mul_i32 s72, s60, 6
    s_add_u32 s72, s72, s61
    s_mul_i32 s73, s62, 96
    s_add_u32 s72, s72, s73
    s_add_u32 s72, s72, 320
    s_cmp_lt_u32 s61, 6
    s_cbranch_scc1 L_un_done
    s_lshl_b32 s72, s60, 1
    s_add_u32 s72, s72, s61
    s_lshl_b32 s72, s72, 1
    s_add_u32 s72, s72, s62
    s_add_u32 s72, s72, 244
L_un_done:
    s_mul_hi_u32 s69, s72, 0x33333334
    s_mul_i32 s70, s69, 5
    s_sub_u32 s70, s72, s70
    v_lshrrev_b32 v60, 3, v255
    v_and_b32 v61, 7, v255
    s_cmp_ge_u32 s69, 48
    s_cbranch_scc1 L_p0_att
    v_lshrrev_b32 v62, 2, v60
    v_and_b32 v63, 3, v60
    v_lshl_add_u32 v70, v62, 4, v63
    v_mov_b32 v71, 5120
    s_lshl_b32 s73, s69, 5
    s_branch L_p0_cgo
L_p0_att:
    s_sub_u32 s60, s69, 48
    s_mul_i32 s61, s60, 205
    s_lshr_b32 s61, s61, 10
    s_mul_i32 s73, s61, 5
    s_sub_u32 s60, s60, s73
    s_lshl_b32 s60, s60, 3
    s_mul_i32 s73, s61, 160
    v_add_u32 v62, s60, v60
    v_mul_u32_u24 v63, 205, v62
    v_lshrrev_b32 v63, 10, v63
    v_mul_u32_u24 v70, 5, v63
    v_sub_u32 v62, v62, v70
    v_cmp_eq_u32 vcc, 4, v62
    v_mov_b32 v70, 16
    v_mov_b32 v71, 1280
    v_cndmask_b32 v62, v62, v70, vcc
    v_mov_b32 v70, 5120
    v_cndmask_b32 v71, v70, v71, vcc
    v_mad_u32_u24 v70, v63, 20, v62
L_p0_cgo:
    v_mul_u32_u24 v70, 1280, v70
    v_lshl_add_u32 v70, v61, 4, v70
    s_mul_i32 s73, s73, 1280
    s_lshl_b32 s60, s70, 8
    s_add_u32 s73, s73, s60
    s_lshl_b32 s71, s62, 13
    s_add_u32 s71, s71, 135168
    s_cmp_ge_u32 s69, 48
    s_cselect_b32 s32, s8, s16
    s_cselect_b32 s33, s9, s17
    s_mov_b32 s34, 1966080
    s_cselect_b32 s34, 819200, s34
    s_mov_b32 s35, 0x20000
    s_cmp_ge_u32 s72, 340
    s_cselect_b32 s34, 0, s34
    s_sub_u32 s60, s72, 340
    s_lshl_b32 s61, s60, 10
    s_add_u32 s61, s61, 12845056
    s_cmp_ge_u32 s60, 118
    s_cbranch_scc1 L_sk2
    buffer_store_dwordx4 v[76:79], v254, s[36:39], s61 offen sc1
L_sk2:
    v_lshrrev_b32 v60, 4, v255
    v_bfe_u32 v61, v255, 2, 2
    v_and_b32 v62, 3, v255
    v_lshl_add_u32 v60, v60, 3, v61
    v_lshlrev_b32 v60, 7, v60
    v_lshl_add_u32 v60, v62, 3, v60
    v_add_u32 v72, s71, v60
    s_lshl_b32 s70, s70, 3
    s_mul_i32 s69, s69, 5
    s_cmp_ge_u32 s72, 340
    s_cselect_b32 s69, 0x4000, s69
    s_barrier
    s_add_u32 s60, s27, 0
    s_and_b32 s60, s60, 3
    s_lshl_b32 s61, s58, 2
    s_add_u32 s60, s60, s61
    s_mul_i32 s88, s60, 69632
    s_mul_i32 s98, s60, 20480
    s_mul_i32 s99, s59, 160
    s_add_u32 s98, s98, s99
    s_add_u32 s60, s27, 1
    s_and_b32 s60, s60, 3
    s_lshl_b32 s61, s58, 2
    s_add_u32 s60, s60, s61
    s_mul_i32 s89, s60, 69632
    s_add_u32 s60, s27, 2
    s_and_b32 s60, s60, 3
    s_lshl_b32 s61, s58, 2
    s_add_u32 s60, s60, s61
    s_mul_i32 s90, s60, 69632
    s_add_u32 s60, s27, 3
    s_and_b32 s60, s60, 3
    s_lshl_b32 s61, s58, 2
    s_add_u32 s60, s60, s61
    s_mul_i32 s91, s60, 69632
    s_mov_b32 s60, 0
    s_mul_i32 s61, s27, 12
    s_add_u32 s76, s60, s61
    s_lshl_b32 s76, s76, 10
    s_add_u32 s60, s60, 1
    s_cmp_eq_u32 s60, 12
    s_cselect_b32 s60, 0, s60
    s_add_u32 s77, s60, s61
    s_lshl_b32 s77, s77, 10
    s_add_u32 s60, s60, 1
    s_cmp_eq_u32 s60, 12
    s_cselect_b32 s60, 0, s60
    s_add_u32 s78, s60, s61
    s_lshl_b32 s78, s78, 10
    s_add_u32 s60, s60, 1
    s_cmp_eq_u32 s60, 12
    s_cselect_b32 s60, 0, s60
    s_add_u32 s79, s60, s61
    s_lshl_b32 s79, s79, 10
    s_add_u32 s60, s60, 1
    s_cmp_eq_u32 s60, 12
    s_cselect_b32 s60, 0, s60
    s_add_u32 s80, s60, s61
    s_lshl_b32 s80, s80, 10
    s_add_u32 s60, s60, 1
    s_cmp_eq_u32 s60, 12
    s_cselect_b32 s60, 0, s60
    s_add_u32 s81, s60, s61
    s_lshl_b32 s81, s81, 10
    s_add_u32 s60, s60, 1
    s_cmp_eq_u32 s60, 12
    s_cselect_b32 s60, 0, s60
    s_add_u32 s82, s60, s61
    s_lshl_b32 s82, s82, 10
    s_add_u32 s60, s60, 1
    s_cmp_eq_u32 s60, 12
    s_cselect_b32 s60, 0, s60
    s_add_u32 s83, s60, s61
    s_lshl_b32 s83, s83, 10
    s_add_u32 s60, s60, 1
    s_cmp_eq_u32 s60, 12
    s_cselect_b32 s60, 0, s60
    s_add_u32 s84, s60, s61
    s_lshl_b32 s84, s84, 10
    s_add_u32 s60, s60, 1
    s_cmp_eq_u32 s60, 12
    s_cselect_b32 s60, 0, s60
    s_add_u32 s85, s60, s61
    s_lshl_b32 s85, s85, 10
    s_add_u32 s60, s60, 1
    s_cmp_eq_u32 s60, 12
    s_cselect_b32 s60, 0, s60
    s_add_u32 s86, s60, s61
    s_lshl_b32 s86, s86, 10
    s_add_u32 s60, s60, 1
    s_cmp_eq_u32 s60, 12
    s_cselect_b32 s60, 0, s60
    s_add_u32 s87, s60, s61
    s_lshl_b32 s87, s87, 10
    s_mul_i32 s100, s59, 348160
    s_add_u32 s100, s100, 9437184
    s_lshl_b32 s63, s62, 8
    s_add_u32 s63, s63, s2
    s_lshl_b32 s60, s48, 11
    s_add_u32 s60, s60, 12984320
    s_sub_u32 s61, s49, s62
    s_cmp_lg_u32 s61, 15
    s_cselect_b32 s60, 16777216, s60
    s_cmp_lg_u32 s62, 0
    s_cselect_b32 s61, 16777216, 0
    s_add_u32 s61, s61, 12980224
    v_lshlrev_b32 v241, 7, v255
    v_add_u32 v240, s60, v241
    v_add_u32 v241, s61, v241
    v_mov_b32 v247, s101
    s_cmp_ge_u32 s72, 340
    s_cbranch_scc1 L_sk3
    s_add_u32 s61, s73, 128
    s_add_u32 m0, s71, 0
    s_nop 0
    buffer_load_dwordx4 v70, s[32:35], s73 offen lds
    s_add_u32 m0, s71, 4096
    s_nop 0
    buffer_load_dwordx4 v70, s[32:35], s61 offen lds
    v_add_u32 v70, v70, v71
    s_add_u32 m0, s71, 1024
    s_nop 0
    buffer_load_dwordx4 v70, s[32:35], s73 offen lds
    s_add_u32 m0, s71, 5120
    s_nop 0
    buffer_load_dwordx4 v70, s[32:35], s61 offen lds
    v_add_u32 v70, v70, v71
    s_add_u32 m0, s71, 2048
    s_nop 0
    buffer_load_dwordx4 v70, s[32:35], s73 offen lds
    s_add_u32 m0, s71, 6144
    s_nop 0
    buffer_load_dwordx4 v70, s[32:35], s61 offen lds
    v_add_u32 v70, v70, v71
    s_add_u32 m0, s71, 3072
    s_nop 0
    buffer_load_dwordx4 v70, s[32:35], s73 offen lds
    s_add_u32 m0, s71, 7168
    s_nop 0
    buffer_load_dwordx4 v70, s[32:35], s61 offen lds
L_sk3:
    s_barrier
    s_barrier
    s_waitcnt vmcnt(0)
    s_cmp_ge_u32 s72, 340
    s_cbranch_scc1 L_sk4
    ds_read_b64_tr_b16 v[200:201], v72 offset:0
    ds_read_b64_tr_b16 v[202:203], v72 offset:512
    ds_read_b64_tr_b16 v[204:205], v72 offset:32
    ds_read_b64_tr_b16 v[206:207], v72 offset:544
    ds_read_b64_tr_b16 v[208:209], v72 offset:64
    ds_read_b64_tr_b16 v[210:211], v72 offset:576
    ds_read_b64_tr_b16 v[212:213], v72 offset:96
    ds_read_b64_tr_b16 v[214:215], v72 offset:608
    s_mul_i32 s60, s70, 205
    s_lshr_b32 s60, s60, 10
    s_mul_i32 s60, s60, 335
    s_add_u32 s60, s60, s70
    s_add_u32 s60, s60, s69
    s_lshl_b32 s60, s60, 10
    s_add_u32 s60, s60, 9437184
    s_add_u32 s70, s70, 1
    s_waitcnt lgkmcnt(6)
    buffer_store_dwordx4 v[200:203], v254, s[36:39], s60 offen sc1
    s_mul_i32 s60, s70, 205
    s_lshr_b32 s60, s60, 10
    s_mul_i32 s60, s60, 335
    s_add_u32 s60, s60, s70
    s_add_u32 s60, s60, s69
    s_lshl_b32 s60, s60, 10
    s_add_u32 s60, s60, 9437184
    s_add_u32 s70, s70, 1
    s_waitcnt lgkmcnt(4)
    buffer_store_dwordx4 v[204:207], v254, s[36:39], s60 offen sc1
    s_mul_i32 s60, s70, 205
    s_lshr_b32 s60, s60, 10
    s_mul_i32 s60, s60, 335
    s_add_u32 s60, s60, s70
    s_add_u32 s60, s60, s69
    s_lshl_b32 s60, s60, 10
    s_add_u32 s60, s60, 9437184
    s_add_u32 s70, s70, 1
    s_waitcnt lgkmcnt(2)
    buffer_store_dwordx4 v[208:211], v254, s[36:39], s60 offen sc1
    s_mul_i32 s60, s70, 205
    s_lshr_b32 s60, s60, 10
    s_mul_i32 s60, s60, 335
    s_add_u32 s60, s60, s70
    s_add_u32 s60, s60, s69
    s_lshl_b32 s60, s60, 10
    s_add_u32 s60, s60, 9437184
    s_add_u32 s70, s70, 1
    s_waitcnt lgkmcnt(0)
    buffer_store_dwordx4 v[212:215], v254, s[36:39], s60 offen sc1
L_sk4:
    s_barrier
    s_cmp_ge_u32 s72, 340
    s_cbranch_scc1 L_sk5
    ds_read_b64_tr_b16 v[216:217], v72 offset:4096
    ds_read_b64_tr_b16 v[218:219], v72 offset:4608
    ds_read_b64_tr_b16 v[220:221], v72 offset:4128
    ds_read_b64_tr_b16 v[222:223], v72 offset:4640
    ds_read_b64_tr_b16 v[224:225], v72 offset:4160
    ds_read_b64_tr_b16 v[226:227], v72 offset:4672
    ds_read_b64_tr_b16 v[228:229], v72 offset:4192
    ds_read_b64_tr_b16 v[230:231], v72 offset:4704
    s_mul_i32 s60, s70, 205
    s_lshr_b32 s60, s60, 10
    s_mul_i32 s60, s60, 335
    s_add_u32 s60, s60, s70
    s_add_u32 s60, s60, s69
    s_lshl_b32 s60, s60, 10
    s_add_u32 s60, s60, 9437184
    s_add_u32 s70, s70, 1
    s_waitcnt lgkmcnt(6)
    buffer_store_dwordx4 v[216:219], v254, s[36:39], s60 offen sc1
    s_mul_i32 s60, s70, 205
    s_lshr_b32 s60, s60, 10
    s_mul_i32 s60, s60, 335
    s_add_u32 s60, s60, s70
    s_add_u32 s60, s60, s69
    s_lshl_b32 s60, s60, 10
    s_add_u32 s60, s60, 9437184
    s_add_u32 s70, s70, 1
    s_waitcnt lgkmcnt(4)
    buffer_store_dwordx4 v[220:223], v254, s[36:39], s60 offen sc1
    s_mul_i32 s60, s70, 205
    s_lshr_b32 s60, s60, 10
    s_mul_i32 s60, s60, 335
    s_add_u32 s60, s60, s70
    s_add_u32 s60, s60, s69
    s_lshl_b32 s60, s60, 10
    s_add_u32 s60, s60, 9437184
    s_add_u32 s70, s70, 1
    s_waitcnt lgkmcnt(2)
    buffer_store_dwordx4 v[224:227], v254, s[36:39], s60 offen sc1
    s_mul_i32 s60, s70, 205
    s_lshr_b32 s60, s60, 10
    s_mul_i32 s60, s60, 335
    s_add_u32 s60, s60, s70
    s_add_u32 s60, s60, s69
    s_lshl_b32 s60, s60, 10
    s_add_u32 s60, s60, 9437184
    s_add_u32 s70, s70, 1
    s_waitcnt lgkmcnt(0)
    buffer_store_dwordx4 v[228:231], v254, s[36:39], s60 offen sc1
L_sk5:
    s_barrier
    s_cmp_eq_u32 s62, 0
    s_cbranch_scc1 L_sk6
    v_add_u32 v244, 163584, v254
    s_mov_b64 exec, 15
    ds_read_b128 v[76:79], v244
    s_mov_b64 exec, -1
    s_and_b32 s60, s2, 1
    s_lshl_b32 s60, s60, 7
    s_and_b32 s61, s2, 6
    s_lshl_b32 s61, s61, 4
    s_add_u32 s60, s60, s61
    s_lshr_b32 s61, s2, 3
    s_add_u32 s60, s60, s61
    s_lshl_b32 s60, s60, 7
    s_add_u32 s60, s60, 12582912
    s_waitcnt lgkmcnt(0)
    s_mov_b64 exec, 15
    buffer_store_dwordx4 v[76:79], v254, s[36:39], s60 offen sc1
    s_mov_b64 exec, -1
L_sk6:
    v_lshlrev_b32 v0, 16, v20
    v_and_b32 v1, s97, v20
    v_lshlrev_b32 v2, 16, v21
    v_and_b32 v3, s97, v21
    v_lshlrev_b32 v4, 16, v22
    v_and_b32 v5, s97, v22
    v_lshlrev_b32 v6, 16, v23
    v_and_b32 v7, s97, v23
    v_lshlrev_b32 v8, 16, v24
    v_and_b32 v9, s97, v24
    v_lshlrev_b32 v10, 16, v25
    v_and_b32 v11, s97, v25
    v_lshlrev_b32 v12, 16, v26
    v_and_b32 v13, s97, v26
    v_lshlrev_b32 v14, 16, v27
    v_and_b32 v15, s97, v27
    v_add_f32 v0, v0, v8
    v_add_f32 v1, v1, v9
    v_add_f32 v2, v2, v10
    v_add_f32 v3, v3, v11
    v_add_f32 v4, v4, v12
    v_add_f32 v5, v5, v13
    v_add_f32 v6, v6, v14
    v_add_f32 v7, v7, v15
    v_lshlrev_b32 v8, 16, v28
    v_and_b32 v9, s97, v28
    v_lshlrev_b32 v10, 16, v29
    v_and_b32 v11, s97, v29
    v_lshlrev_b32 v12, 16, v30
    v_and_b32 v13, s97, v30
    v_lshlrev_b32 v14, 16, v31
    v_and_b32 v15, s97, v31
    v_add_f32 v0, v0, v8
    v_add_f32 v1, v1, v9
    v_add_f32 v2, v2, v10
    v_add_f32 v3, v3, v11
    v_add_f32 v4, v4, v12
    v_add_f32 v5, v5, v13
    v_add_f32 v6, v6, v14
    v_add_f32 v7, v7, v15
    s_barrier
    v_lshlrev_b32 v8, 16, v32
    v_and_b32 v9, s97, v32
    v_lshlrev_b32 v10, 16, v33
    v_and_b32 v11, s97, v33
    v_lshlrev_b32 v12, 16, v34
    v_and_b32 v13, s97, v34
    v_lshlrev_b32 v14, 16, v35
    v_and_b32 v15, s97, v35
    v_add_f32 v0, v0, v8
    v_add_f32 v1, v1, v9
    v_add_f32 v2, v2, v10
    v_add_f32 v3, v3, v11
    v_add_f32 v4, v4, v12
    v_add_f32 v5, v5, v13
    v_add_f32 v6, v6, v14
    v_add_f32 v7, v7, v15
    v_lshlrev_b32 v8, 16, v36
    v_and_b32 v9, s97, v36
    v_lshlrev_b32 v10, 16, v37
    v_and_b32 v11, s97, v37
    v_lshlrev_b32 v12, 16, v38
    v_and_b32 v13, s97, v38
    v_lshlrev_b32 v14, 16, v39
    v_and_b32 v15, s97, v39
    v_add_f32 v0, v0, v8
    v_add_f32 v1, v1, v9
    v_add_f32 v2, v2, v10
    v_add_f32 v3, v3, v11
    v_add_f32 v4, v4, v12
    v_add_f32 v5, v5, v13
    v_add_f32 v6, v6, v14
    v_add_f32 v7, v7, v15
    v_lshlrev_b32 v8, 16, v40
    v_and_b32 v9, s97, v40
    v_lshlrev_b32 v10, 16, v41
    v_and_b32 v11, s97, v41
    v_lshlrev_b32 v12, 16, v42
    v_and_b32 v13, s97, v42
    v_lshlrev_b32 v14, 16, v43
    v_and_b32 v15, s97, v43
    v_add_f32 v0, v0, v8
    v_add_f32 v1, v1, v9
    v_add_f32 v2, v2, v10
    v_add_f32 v3, v3, v11
    v_add_f32 v4, v4, v12
    v_add_f32 v5, v5, v13
    v_add_f32 v6, v6, v14
    v_add_f32 v7, v7, v15
    s_waitcnt vmcnt(0)
    s_barrier
    s_cmp_lg_u32 s62, 0
    s_cbranch_scc1 L_dbg_s
    s_and_b32 s60, s2, 3
    s_lshl_b32 s60, s60, 6
    s_add_u32 s10, s22, s60
    s_addc_u32 s11, s23, 0
    s_mov_b32 s63, 1
    s_atomic_add s63, s[10:11], 0
L_dbg_s:
    v_lshlrev_b32 v8, 16, v44
    v_and_b32 v9, s97, v44
    v_lshlrev_b32 v10, 16, v45
    v_and_b32 v11, s97, v45
    v_lshlrev_b32 v12, 16, v46
    v_and_b32 v13, s97, v46
    v_lshlrev_b32 v14, 16, v47
    v_and_b32 v15, s97, v47
    v_add_f32 v0, v0, v8
    v_add_f32 v1, v1, v9
    v_add_f32 v2, v2, v10
    v_add_f32 v3, v3, v11
    v_add_f32 v4, v4, v12
    v_add_f32 v5, v5, v13
    v_add_f32 v6, v6, v14
    v_add_f32 v7, v7, v15
    v_lshlrev_b32 v8, 16, v48
    v_and_b32 v9, s97, v48
    v_lshlrev_b32 v10, 16, v49
    v_and_b32 v11, s97, v49
    v_lshlrev_b32 v12, 16, v50
    v_and_b32 v13, s97, v50
    v_lshlrev_b32 v14, 16, v51
    v_and_b32 v15, s97, v51
    v_add_f32 v0, v0, v8
    v_add_f32 v1, v1, v9
    v_add_f32 v2, v2, v10
    v_add_f32 v3, v3, v11
    v_add_f32 v4, v4, v12
    v_add_f32 v5, v5, v13
    v_add_f32 v6, v6, v14
    v_add_f32 v7, v7, v15
    v_lshlrev_b32 v8, 16, v52
    v_and_b32 v9, s97, v52
    v_lshlrev_b32 v10, 16, v53
    v_and_b32 v11, s97, v53
    v_lshlrev_b32 v12, 16, v54
    v_and_b32 v13, s97, v54
    v_lshlrev_b32 v14, 16, v55
    v_and_b32 v15, s97, v55
    v_add_f32 v0, v0, v8
    v_add_f32 v1, v1, v9
    v_add_f32 v2, v2, v10
    v_add_f32 v3, v3, v11
    v_add_f32 v4, v4, v12
    v_add_f32 v5, v5, v13
    v_add_f32 v6, v6, v14
    v_add_f32 v7, v7, v15
    s_barrier
    v_lshlrev_b32 v8, 16, v56
    v_and_b32 v9, s97, v56
    v_lshlrev_b32 v10, 16, v57
    v_and_b32 v11, s97, v57
    v_lshlrev_b32 v12, 16, v58
    v_and_b32 v13, s97, v58
    v_lshlrev_b32 v14, 16, v59
    v_and_b32 v15, s97, v59
    v_add_f32 v0, v0, v8
    v_add_f32 v1, v1, v9
    v_add_f32 v2, v2, v10
    v_add_f32 v3, v3, v11
    v_add_f32 v4, v4, v12
    v_add_f32 v5, v5, v13
    v_add_f32 v6, v6, v14
    v_add_f32 v7, v7, v15
    v_permlane32_swap_b32 v0, v4
    v_permlane32_swap_b32 v1, v5
    v_permlane32_swap_b32 v2, v6
    v_permlane32_swap_b32 v3, v7
    v_add_f32 v0, v0, v4
    v_add_f32 v1, v1, v5
    v_add_f32 v2, v2, v6
    v_add_f32 v3, v3, v7
    s_nop 0
    v_permlane16_swap_b32 v0, v2
    v_permlane16_swap_b32 v1, v3
    v_add_f32 v0, v0, v2
    v_add_f32 v1, v1, v3
    s_nop 0
    v_add_f32_dpp v0, v0, v0 row_ror:8 row_mask:0xf bank_mask:0xf
    v_add_f32_dpp v1, v1, v1 row_ror:8 row_mask:0xf bank_mask:0xf
    s_nop 0
    v_add_f32_dpp v0, v0, v0 row_ror:4 row_mask:0xf bank_mask:0xf
    v_add_f32_dpp v1, v1, v1 row_ror:4 row_mask:0xf bank_mask:0xf
    v_bfe_u32 v60, v255, 2, 1
    v_cmp_eq_u32 vcc, 1, v60
    v_and_b32 v61, 3, v255
    v_lshl_add_u32 v60, v61, 3, v60
    v_cndmask_b32 v0, v0, v1, vcc
    v_lshrrev_b32 v61, 4, v255
    v_lshl_add_u32 v60, v61, 1, v60
    v_lshlrev_b32 v60, 3, v60
    v_cvt_pk_bf16_f32 v62, v0, v0
    v_and_b32 v62, s97, v62
    v_sub_f32 v62, v0, v62
    v_cvt_pk_bf16_f32 v62, v0, v62
    s_lshl_b32 s60, s64, 11
    s_lshl_b32 s61, s62, 10
    s_add_u32 s60, s60, s61
    s_add_u32 s60, s60, 12648448
    s_cmp_ge_u32 s64, 54
    s_cselect_b32 s60, 16777216, s60
    s_lshl_b32 s61, s65, 8
    s_add_u32 s61, s61, s60
    v_mov_b32 v63, s101
    s_mov_b32 exec_lo, 0x00ff00ff
    s_mov_b32 exec_hi, 0x00ff00ff
    buffer_store_dwordx2 v[62:63], v60, s[36:39], s61 offen sc1
    s_mov_b64 exec, -1
    s_barrier
    s_lshl_b32 s60, s62, 8
    s_add_u32 s60, s60, 151552
    v_lshlrev_b32 v61, 2, v255
    v_add_u32 v60, s60, v61
    ds_write_b32 v60, v239
    s_cmp_eq_u32 s62, 0
    s_cbranch_scc1 L_nob2
    v_add_u32 v60, 163648, v61
    s_mov_b32 exec_hi, 0xff
    ds_write_b32 v60, v238
    s_mov_b32 exec_hi, -1
L_nob2:
    v_and_b32 v60, 15, v255
    v_lshl_add_u32 v60, v60, 1, s60
    s_waitcnt lgkmcnt(0)
    ds_read_u16 v232, v60 offset:0
    ds_read_u16 v233, v60 offset:32
    ds_read_u16 v234, v60 offset:64
    ds_read_u16 v235, v60 offset:96
    ds_read_u16 v236, v60 offset:128
    ds_read_u16 v237, v60 offset:160
    ds_read_u16 v238, v60 offset:192
    s_waitcnt lgkmcnt(0)
    v_and_b32 v60, 15, v255
    v_lshrrev_b32 v61, 4, v255
    v_lshlrev_b32 v60, 3, v60
    v_lshl_add_u32 v68, v61, 8, v60
    v_and_b32 v60, 7, v255
    v_lshrrev_b32 v61, 3, v255
    v_lshlrev_b32 v60, 3, v60
    v_lshl_add_u32 v69, v61, 7, v60
    s_mul_i32 s60, s62, 7
    s_add_u32 s60, s60, 0
    s_lshl_b32 s4, s60, 5
    s_add_u32 s4, s4, s52
    s_cmp_ge_u32 s60, 5
    s_cselect_b32 s61, s53, 0
    s_add_u32 s4, s4, s61
    s_cmp_ge_u32 s60, 10
    s_cselect_b32 s61, s54, 0
    s_add_u32 s4, s4, s61
    s_lshr_b32 s4, s4, 1
    s_add_u32 s4, s4, s57
    s_min_u32 s4, s4, 3440
    s_and_b32 s60, s4, 16
    s_lshl_b32 s60, s60, 3
    s_lshr_b32 s4, s4, 5
    s_lshl_b32 s4, s4, 10
    s_add_u32 s4, s4, s60
    s_add_u32 s4, s4, 12648448
    s_mul_i32 s60, s62, 7
    s_add_u32 s60, s60, 1
    s_lshl_b32 s5, s60, 5
    s_add_u32 s5, s5, s52
    s_cmp_ge_u32 s60, 5
    s_cselect_b32 s61, s53, 0
    s_add_u32 s5, s5, s61
    s_cmp_ge_u32 s60, 10
    s_cselect_b32 s61, s54, 0
    s_add_u32 s5, s5, s61
    s_lshr_b32 s5, s5, 1
    s_add_u32 s5, s5, s57
    s_min_u32 s5, s5, 3440
    s_and_b32 s60, s5, 16
    s_lshl_b32 s60, s60, 3
    s_lshr_b32 s5, s5, 5
    s_lshl_b32 s5, s5, 10
    s_add_u32 s5, s5, s60
    s_add_u32 s5, s5, 12648448
    s_mul_i32 s60, s62, 7
    s_add_u32 s60, s60, 2
    s_lshl_b32 s6, s60, 5
    s_add_u32 s6, s6, s52
    s_cmp_ge_u32 s60, 5
    s_cselect_b32 s61, s53, 0
    s_add_u32 s6, s6, s61
    s_cmp_ge_u32 s60, 10
    s_cselect_b32 s61, s54, 0
    s_add_u32 s6, s6, s61
    s_lshr_b32 s6, s6, 1
    s_add_u32 s6, s6, s57
    s_min_u32 s6, s6, 3440
    s_and_b32 s60, s6, 16
    s_lshl_b32 s60, s60, 3
    s_lshr_b32 s6, s6, 5
    s_lshl_b32 s6, s6, 10
    s_add_u32 s6, s6, s60
    s_add_u32 s6, s6, 12648448
    s_barrier
    s_mul_i32 s60, s62, 7
    s_add_u32 s60, s60, 3
    s_lshl_b32 s7, s60, 5
    s_add_u32 s7, s7, s52
    s_cmp_ge_u32 s60, 5
    s_cselect_b32 s61, s53, 0
    s_add_u32 s7, s7, s61
    s_cmp_ge_u32 s60, 10
    s_cselect_b32 s61, s54, 0
    s_add_u32 s7, s7, s61
    s_lshr_b32 s7, s7, 1
    s_add_u32 s7, s7, s57
    s_min_u32 s7, s7, 3440
    s_and_b32 s60, s7, 16
    s_lshl_b32 s60, s60, 3
    s_lshr_b32 s7, s7, 5
    s_lshl_b32 s7, s7, 10
    s_add_u32 s7, s7, s60
    s_add_u32 s7, s7, 12648448
    s_mul_i32 s60, s62, 7
    s_add_u32 s60, s60, 4
    s_lshl_b32 s8, s60, 5
    s_add_u32 s8, s8, s52
    s_cmp_ge_u32 s60, 5
    s_cselect_b32 s61, s53, 0
    s_add_u32 s8, s8, s61
    s_cmp_ge_u32 s60, 10
    s_cselect_b32 s61, s54, 0
    s_add_u32 s8, s8, s61
    s_lshr_b32 s8, s8, 1
    s_add_u32 s8, s8, s57
    s_min_u32 s8, s8, 3440
    s_and_b32 s60, s8, 16
    s_lshl_b32 s60, s60, 3
    s_lshr_b32 s8, s8, 5
    s_lshl_b32 s8, s8, 10
    s_add_u32 s8, s8, s60
    s_add_u32 s8, s8, 12648448
    s_mul_i32 s60, s62, 7
    s_add_u32 s60, s60, 5
    s_lshl_b32 s9, s60, 5
    s_add_u32 s9, s9, s52
    s_cmp_ge_u32 s60, 5
    s_cselect_b32 s61, s53, 0
    s_add_u32 s9, s9, s61
    s_cmp_ge_u32 s60, 10
    s_cselect_b32 s61, s54, 0
    s_add_u32 s9, s9, s61
    s_lshr_b32 s9, s9, 1
    s_add_u32 s9, s9, s57
    s_min_u32 s9, s9, 3440
    s_and_b32 s60, s9, 16
    s_lshl_b32 s60, s60, 3
    s_lshr_b32 s9, s9, 5
    s_lshl_b32 s9, s9, 10
    s_add_u32 s9, s9, s60
    s_add_u32 s9, s9, 12648448
    s_mul_i32 s60, s62, 7
    s_add_u32 s60, s60, 6
    s_lshl_b32 s10, s60, 5
    s_add_u32 s10, s10, s52
    s_cmp_ge_u32 s60, 5
    s_cselect_b32 s61, s53, 0
    s_add_u32 s10, s10, s61
    s_cmp_ge_u32 s60, 10
    s_cselect_b32 s61, s54, 0
    s_add_u32 s10, s10, s61
    s_lshr_b32 s10, s10, 1
    s_add_u32 s10, s10, s57
    s_min_u32 s10, s10, 3440
    s_and_b32 s60, s10, 16
    s_lshl_b32 s60, s60, 3
    s_lshr_b32 s10, s10, 5
    s_lshl_b32 s10, s10, 10
    s_add_u32 s10, s10, s60
    s_add_u32 s10, s10, 12648448
    s_lshl_b32 s60, s48, 1
    s_add_u32 s60, s60, s62
    s_lshl_b32 s60, s60, 10
    s_add_u32 s11, s60, 12582912
    s_mul_i32 s60, s62, 3584
    s_add_u32 s60, s60, 155136
    v_lshlrev_b32 v61, 3, v255
    v_add_u32 v60, s60, v61
    s_lshl_b32 s60, s62, 9
    s_add_u32 s60, s60, 162304
    v_add_u32 v61, s60, v61
    s_barrier
    s_barrier
    s_barrier
    buffer_load_dwordx2 v[0:1], v68, s[36:39], s4 offen sc1
    buffer_load_dwordx2 v[2:3], v68, s[36:39], s5 offen sc1
    buffer_load_dwordx2 v[4:5], v68, s[36:39], s6 offen sc1
    buffer_load_dwordx2 v[6:7], v68, s[36:39], s7 offen sc1
    buffer_load_dwordx2 v[8:9], v68, s[36:39], s8 offen sc1
    buffer_load_dwordx2 v[10:11], v68, s[36:39], s9 offen sc1
    buffer_load_dwordx2 v[12:13], v68, s[36:39], s10 offen sc1
    buffer_load_dwordx2 v[14:15], v69, s[36:39], s11 offen sc1
    s_barrier
    s_cmp_lg_u32 s62, 0
    s_cbranch_scc1 L_sk7
    v_lshlrev_b32 v240, 6, v255
    s_mov_b64 exec, 15
    global_load_dword v243, v240, s[22:23] sc1
    s_mov_b64 exec, -1
L_sk7:
    s_barrier
    s_waitcnt vmcnt(0)
    s_mov_b32 s96, 100000
L_ext_retry:
    v_cmp_ne_u32 vcc, s101, v1
    s_nop 0
    s_mov_b64 s[94:95], vcc
    v_cmp_ne_u32 vcc, s101, v3
    s_nop 0
    s_or_b64 s[94:95], s[94:95], vcc
    v_cmp_ne_u32 vcc, s101, v5
    s_nop 0
    s_or_b64 s[94:95], s[94:95], vcc
    v_cmp_ne_u32 vcc, s101, v7
    s_nop 0
    s_or_b64 s[94:95], s[94:95], vcc
    v_cmp_ne_u32 vcc, s101, v9
    s_nop 0
    s_or_b64 s[94:95], s[94:95], vcc
    v_cmp_ne_u32 vcc, s101, v11
    s_nop 0
    s_or_b64 s[94:95], s[94:95], vcc
    v_cmp_ne_u32 vcc, s101, v13
    s_nop 0
    s_or_b64 s[94:95], s[94:95], vcc
    v_cmp_ne_u32 vcc, s101, v15
    s_nop 0
    s_or_b64 s[94:95], s[94:95], vcc
    s_cmp_lg_u64 s[94:95], 0
    s_cbranch_scc0 L_ext_ok
    s_sleep 8
    buffer_load_dwordx2 v[0:1], v68, s[36:39], s4 offen sc1
    buffer_load_dwordx2 v[2:3], v68, s[36:39], s5 offen sc1
    buffer_load_dwordx2 v[4:5], v68, s[36:39], s6 offen sc1
    buffer_load_dwordx2 v[6:7], v68, s[36:39], s7 offen sc1
    buffer_load_dwordx2 v[8:9], v68, s[36:39], s8 offen sc1
    buffer_load_dwordx2 v[10:11], v68, s[36:39], s9 offen sc1
    buffer_load_dwordx2 v[12:13], v68, s[36:39], s10 offen sc1
    buffer_load_dwordx2 v[14:15], v69, s[36:39], s11 offen sc1
    s_waitcnt vmcnt(0)
    s_sub_u32 s96, s96, 1
    s_cmp_lg_u32 s96, 0
    s_cbranch_scc1 L_ext_retry
L_ext_ok:
    s_barrier
    v_and_b32 v36, 15, v255
    v_mul_u32_u24 v36, 1280, v36
    v_lshrrev_b32 v37, 4, v255
    v_lshlrev_b32 v37, 3, v37
    v_bfe_u32 v38, v255, 4, 1
    v_lshrrev_b32 v39, 5, v255
    v_lshlrev_b32 v38, 5, v38
    v_lshl_add_u32 v38, v39, 4, v38
    v_add_u32 v39, v36, v38
    v_add_u32 v36, v36, v37
    buffer_load_dwordx4 v[40:43], v39, s[28:31], s98 offen
    buffer_load_dwordx4 v[44:47], v39, s[28:31], s98 offen offset:64
    buffer_load_dwordx2 v[48:49], v36, s[28:31], s98 offen offset:128
    v_mov_b32 v1, v232
    ds_write_b64 v60, v[0:1] offset:0
    v_mov_b32 v3, v233
    ds_write_b64 v60, v[2:3] offset:512
    v_mov_b32 v5, v234
    ds_write_b64 v60, v[4:5] offset:1024
    v_mov_b32 v7, v235
    ds_write_b64 v60, v[6:7] offset:1536
    v_mov_b32 v9, v236
    ds_write_b64 v60, v[8:9] offset:2048
    v_mov_b32 v11, v237
    ds_write_b64 v60, v[10:11] offset:2560
    v_mov_b32 v13, v238
    ds_write_b64 v60, v[12:13] offset:3072
    ds_write_b64 v61, v[14:15]
    s_waitcnt lgkmcnt(0)
    s_cmp_lg_u32 s62, 0
    s_cbranch_scc1 L_nochk
    s_waitcnt vmcnt(3)
    s_mov_b32 s96, 100000
    s_mov_b64 exec, 15
L_dbg_l:
    v_cmp_gt_u32 vcc, 64, v243
    s_nop 4
    s_cbranch_vccz L_dbg_e
    s_sleep 16
    global_load_dword v243, v240, s[22:23] sc1
    s_waitcnt vmcnt(0)
    s_sub_u32 s96, s96, 1
    s_cmp_lg_u32 s96, 0
    s_cbranch_scc1 L_dbg_l
L_dbg_e:
    s_mov_b64 exec, -1
L_nochk:
    s_barrier
    s_mul_i32 s60, s76, 5
    s_add_u32 s60, s60, s100
    buffer_load_dwordx4 v[80:83], v254, s[36:39], s60 offen offset:0 sc1
    s_mul_i32 s60, s76, 5
    s_add_u32 s60, s60, s100
    buffer_load_dwordx4 v[84:87], v254, s[36:39], s60 offen offset:1024 sc1
    s_mul_i32 s60, s76, 5
    s_add_u32 s60, s60, s100
    buffer_load_dwordx4 v[88:91], v254, s[36:39], s60 offen offset:2048 sc1
    s_mul_i32 s60, s76, 5
    s_add_u32 s60, s60, s100
    buffer_load_dwordx4 v[92:95], v254, s[36:39], s60 offen offset:3072 sc1
    s_mul_i32 s60, s76, 5
    s_add_u32 s60, s60, s100
    s_add_u32 s60, s60, 4096
    buffer_load_dwordx4 v[96:99], v254, s[36:39], s60 offen offset:0 sc1
    s_mul_i32 s60, s77, 5
    s_add_u32 s60, s60, s100
    buffer_load_dwordx4 v[100:103], v254, s[36:39], s60 offen offset:0 sc1
    s_mul_i32 s60, s77, 5
    s_add_u32 s60, s60, s100
    buffer_load_dwordx4 v[104:107], v254, s[36:39], s60 offen offset:1024 sc1
    s_mul_i32 s60, s77, 5
    s_add_u32 s60, s60, s100
    buffer_load_dwordx4 v[108:111], v254, s[36:39], s60 offen offset:2048 sc1
    s_mul_i32 s60, s77, 5
    s_add_u32 s60, s60, s100
    buffer_load_dwordx4 v[112:115], v254, s[36:39], s60 offen offset:3072 sc1
    s_mul_i32 s60, s77, 5
    s_add_u32 s60, s60, s100
    s_add_u32 s60, s60, 4096
    buffer_load_dwordx4 v[116:119], v254, s[36:39], s60 offen offset:0 sc1
    s_mul_i32 s60, s78, 5
    s_add_u32 s60, s60, s100
    buffer_load_dwordx4 v[120:123], v254, s[36:39], s60 offen offset:0 sc1
    s_mul_i32 s60, s78, 5
    s_add_u32 s60, s60, s100
    buffer_load_dwordx4 v[124:127], v254, s[36:39], s60 offen offset:1024 sc1
    s_mul_i32 s60, s78, 5
    s_add_u32 s60, s60, s100
    buffer_load_dwordx4 v[128:131], v254, s[36:39], s60 offen offset:2048 sc1
    s_mul_i32 s60, s78, 5
    s_add_u32 s60, s60, s100
    buffer_load_dwordx4 v[132:135], v254, s[36:39], s60 offen offset:3072 sc1
    s_mul_i32 s60, s78, 5
    s_add_u32 s60, s60, s100
    s_add_u32 s60, s60, 4096
    buffer_load_dwordx4 v[136:139], v254, s[36:39], s60 offen offset:0 sc1
    s_mul_i32 s60, s79, 5
    s_add_u32 s60, s60, s100
    buffer_load_dwordx4 v[140:143], v254, s[36:39], s60 offen offset:0 sc1
    s_mul_i32 s60, s79, 5
    s_add_u32 s60, s60, s100
    buffer_load_dwordx4 v[144:147], v254, s[36:39], s60 offen offset:1024 sc1
    s_mul_i32 s60, s79, 5
    s_add_u32 s60, s60, s100
    buffer_load_dwordx4 v[148:151], v254, s[36:39], s60 offen offset:2048 sc1
    s_mul_i32 s60, s79, 5
    s_add_u32 s60, s60, s100
    buffer_load_dwordx4 v[152:155], v254, s[36:39], s60 offen offset:3072 sc1
    s_mul_i32 s60, s79, 5
    s_add_u32 s60, s60, s100
    s_add_u32 s60, s60, 4096
    buffer_load_dwordx4 v[156:159], v254, s[36:39], s60 offen offset:0 sc1
    s_mul_i32 s60, s80, 5
    s_add_u32 s60, s60, s100
    buffer_load_dwordx4 v[160:163], v254, s[36:39], s60 offen offset:0 sc1
    s_mul_i32 s60, s80, 5
    s_add_u32 s60, s60, s100
    buffer_load_dwordx4 v[164:167], v254, s[36:39], s60 offen offset:1024 sc1
    s_mul_i32 s60, s80, 5
    s_add_u32 s60, s60, s100
    buffer_load_dwordx4 v[168:171], v254, s[36:39], s60 offen offset:2048 sc1
    s_mul_i32 s60, s80, 5
    s_add_u32 s60, s60, s100
    buffer_load_dwordx4 v[172:175], v254, s[36:39], s60 offen offset:3072 sc1
    s_mul_i32 s60, s80, 5
    s_add_u32 s60, s60, s100
    s_add_u32 s60, s60, 4096
    buffer_load_dwordx4 v[176:179], v254, s[36:39], s60 offen offset:0 sc1
    s_mul_i32 s60, s81, 5
    s_add_u32 s60, s60, s100
    buffer_load_dwordx4 v[180:183], v254, s[36:39], s60 offen offset:0 sc1
    s_mul_i32 s60, s81, 5
    s_add_u32 s60, s60, s100
    buffer_load_dwordx4 v[184:187], v254, s[36:39], s60 offen offset:1024 sc1
    s_mul_i32 s60, s81, 5
    s_add_u32 s60, s60, s100
    buffer_load_dwordx4 v[188:191], v254, s[36:39], s60 offen offset:2048 sc1
    s_mul_i32 s60, s81, 5
    s_add_u32 s60, s60, s100
    buffer_load_dwordx4 v[192:195], v254, s[36:39], s60 offen offset:3072 sc1
    s_mul_i32 s60, s81, 5
    s_add_u32 s60, s60, s100
    s_add_u32 s60, s60, 4096
    buffer_load_dwordx4 v[196:199], v254, s[36:39], s60 offen offset:0 sc1
L_H2:
    s_mul_i32 s60, s85, 5
    s_add_u32 s60, s60, s100
    s_add_u32 s61, s60, 4096
    buffer_load_dwordx4 v[0:3], v254, s[36:39], s60 offen offset:0 sc1
    s_waitcnt vmcnt(8)
    buffer_load_dwordx4 v[4:7], v254, s[36:39], s60 offen offset:1024 sc1
    s_waitcnt vmcnt(8)
    buffer_load_dwordx4 v[8:11], v254, s[36:39], s60 offen offset:2048 sc1
    s_waitcnt vmcnt(8)
    buffer_load_dwordx4 v[12:15], v254, s[36:39], s60 offen offset:3072 sc1
    s_waitcnt vmcnt(8)
    buffer_load_dwordx4 v[16:19], v254, s[36:39], s61 offen offset:0 sc1
    s_waitcnt vmcnt(8)
    s_mul_i32 s60, s86, 5
    s_add_u32 s60, s60, s100
    s_add_u32 s61, s60, 4096
    buffer_load_dwordx4 v[20:23], v254, s[36:39], s60 offen offset:0 sc1
    s_waitcnt vmcnt(8)
    buffer_load_dwordx4 v[24:27], v254, s[36:39], s60 offen offset:1024 sc1
    s_waitcnt vmcnt(8)
    buffer_load_dwordx4 v[28:31], v254, s[36:39], s60 offen offset:2048 sc1
    s_waitcnt vmcnt(8)
    buffer_load_dwordx4 v[32:35], v254, s[36:39], s60 offen offset:3072 sc1
    s_waitcnt vmcnt(8)
    buffer_load_dwordx4 v[36:39], v254, s[36:39], s61 offen offset:0 sc1
    s_waitcnt vmcnt(8)
    s_mul_i32 s60, s87, 5
    s_add_u32 s60, s60, s100
    s_add_u32 s61, s60, 4096
    buffer_load_dwordx4 v[60:63], v254, s[36:39], s60 offen offset:0 sc1
    s_waitcnt vmcnt(8)
    buffer_load_dwordx4 v[64:67], v254, s[36:39], s60 offen offset:1024 sc1
    s_waitcnt vmcnt(8)
    buffer_load_dwordx4 v[68:71], v254, s[36:39], s60 offen offset:2048 sc1
    s_waitcnt vmcnt(8)
    buffer_load_dwordx4 v[72:75], v254, s[36:39], s60 offen offset:3072 sc1
    s_waitcnt vmcnt(8)
    buffer_load_dwordx4 v[76:79], v254, s[36:39], s61 offen offset:0 sc1
    s_waitcnt vmcnt(8)
    s_mul_i32 s60, s82, 5
    s_add_u32 s60, s60, s100
    s_add_u32 s61, s60, 4096
    buffer_load_dwordx4 v[200:203], v254, s[36:39], s60 offen offset:0 sc1
    s_waitcnt vmcnt(8)
    buffer_load_dwordx4 v[204:207], v254, s[36:39], s60 offen offset:1024 sc1
    s_waitcnt vmcnt(8)
    buffer_load_dwordx4 v[208:211], v254, s[36:39], s60 offen offset:2048 sc1
    s_waitcnt vmcnt(8)
    buffer_load_dwordx4 v[212:215], v254, s[36:39], s60 offen offset:3072 sc1
    s_waitcnt vmcnt(8)
    buffer_load_dwordx4 v[216:219], v254, s[36:39], s61 offen offset:0 sc1
    s_waitcnt vmcnt(8)
    s_mul_i32 s60, s83, 5
    s_add_u32 s60, s60, s100
    s_add_u32 s61, s60, 4096
    buffer_load_dwordx4 v[220:223], v254, s[36:39], s60 offen offset:0 sc1
    s_waitcnt vmcnt(8)
    buffer_load_dwordx4 v[224:227], v254, s[36:39], s60 offen offset:1024 sc1
    s_waitcnt vmcnt(8)
    buffer_load_dwordx4 v[228:231], v254, s[36:39], s60 offen offset:2048 sc1
    s_waitcnt vmcnt(8)
    buffer_load_dwordx4 v[232:235], v254, s[36:39], s60 offen offset:3072 sc1
    s_waitcnt vmcnt(8)
    buffer_load_dwordx4 v[236:239], v254, s[36:39], s61 offen offset:0 sc1
    s_waitcnt vmcnt(8)
    s_mov_b32 s96, 800000
    v_mov_b32 v248, 163328
L_lw8:
    ds_read_b32 v249, v248
    s_waitcnt lgkmcnt(0)
    v_readfirstlane_b32 s60, v249
    s_nop 0
    s_cmp_ge_u32 s60, 4
    s_cbranch_scc1 L_lwe9
    s_sleep 1
    s_sub_u32 s96, s96, 1
    s_cmp_lg_u32 s96, 0
    s_cbranch_scc1 L_lw8
L_lwe9:
    s_sub_u32 s60, s27, 1
    s_mul_i32 s60, s60, 30720
    s_add_u32 s60, s60, 62976
    s_cmp_eq_u32 s27, 0
    s_cselect_b32 s60, 0, s60
    v_add_u32 v252, s60, v254
    s_waitcnt vmcnt(20)
    ds_write_b128 v252, v[0:3] offset:15360
    ds_write_b128 v252, v[4:7] offset:16384
    ds_write_b128 v252, v[8:11] offset:17408
    ds_write_b128 v252, v[12:15] offset:18432
    ds_write_b128 v252, v[16:19] offset:19456
    s_waitcnt lgkmcnt(0)
    s_mul_i32 s60, s84, 5
    s_add_u32 s60, s60, s100
    s_add_u32 s61, s60, 4096
    buffer_load_dwordx4 v[0:3], v254, s[36:39], s60 offen offset:0 sc1
    s_waitcnt vmcnt(8)
    buffer_load_dwordx4 v[4:7], v254, s[36:39], s60 offen offset:1024 sc1
    s_waitcnt vmcnt(8)
    buffer_load_dwordx4 v[8:11], v254, s[36:39], s60 offen offset:2048 sc1
    s_waitcnt vmcnt(8)
    buffer_load_dwordx4 v[12:15], v254, s[36:39], s60 offen offset:3072 sc1
    s_waitcnt vmcnt(8)
    buffer_load_dwordx4 v[16:19], v254, s[36:39], s61 offen offset:0 sc1
    s_waitcnt vmcnt(8)
    s_waitcnt lgkmcnt(5)
    s_waitcnt vmcnt(20)
    ds_write_b128 v252, v[20:23] offset:20480
    ds_write_b128 v252, v[24:27] offset:21504
    ds_write_b128 v252, v[28:31] offset:22528
    ds_write_b128 v252, v[32:35] offset:23552
    ds_write_b128 v252, v[36:39] offset:24576
    s_waitcnt lgkmcnt(5)
    s_waitcnt vmcnt(15)
    ds_write_b128 v252, v[60:63] offset:25600
    ds_write_b128 v252, v[64:67] offset:26624
    ds_write_b128 v252, v[68:71] offset:27648
    ds_write_b128 v252, v[72:75] offset:28672
    ds_write_b128 v252, v[76:79] offset:29696
    s_waitcnt lgkmcnt(5)
    s_mov_b32 s96, 800000
    v_mov_b32 v248, 163360
L_lw10:
    ds_read_b32 v249, v248
    s_waitcnt lgkmcnt(0)
    v_readfirstlane_b32 s60, v249
    s_nop 0
    s_cmp_ge_u32 s60, 4
    s_cbranch_scc1 L_lwe11
    s_sleep 1
    s_sub_u32 s96, s96, 1
    s_cmp_lg_u32 s96, 0
    s_cbranch_scc1 L_lw10
L_lwe11:
    s_waitcnt vmcnt(10)
    ds_write_b128 v252, v[200:203] offset:0
    ds_write_b128 v252, v[204:207] offset:1024
    ds_write_b128 v252, v[208:211] offset:2048
    ds_write_b128 v252, v[212:215] offset:3072
    ds_write_b128 v252, v[216:219] offset:4096
    s_waitcnt lgkmcnt(5)
    s_waitcnt vmcnt(5)
    ds_write_b128 v252, v[220:223] offset:5120
    ds_write_b128 v252, v[224:227] offset:6144
    ds_write_b128 v252, v[228:231] offset:7168
    ds_write_b128 v252, v[232:235] offset:8192
    ds_write_b128 v252, v[236:239] offset:9216
    s_waitcnt lgkmcnt(5)
    s_waitcnt vmcnt(0)
    ds_write_b128 v252, v[0:3] offset:10240
    ds_write_b128 v252, v[4:7] offset:11264
    ds_write_b128 v252, v[8:11] offset:12288
    ds_write_b128 v252, v[12:15] offset:13312
    ds_write_b128 v252, v[16:19] offset:14336
    s_waitcnt lgkmcnt(5)
    s_waitcnt lgkmcnt(0)
    s_sub_u32 s62, s27, 1
    s_and_b32 s62, s62, 3
    s_sub_u32 s5, s62, 1
    s_mul_i32 s5, s5, 30720
    s_add_u32 s5, s5, 62976
    s_cmp_eq_u32 s62, 0
    s_cselect_b32 s5, 0, s5
    s_sub_u32 s62, s27, 2
    s_and_b32 s62, s62, 3
    s_sub_u32 s6, s62, 1
    s_mul_i32 s6, s6, 30720
    s_add_u32 s6, s6, 62976
    s_cmp_eq_u32 s62, 0
    s_cselect_b32 s6, 0, s6
    s_sub_u32 s62, s27, 3
    s_and_b32 s62, s62, 3
    s_sub_u32 s7, s62, 1
    s_mul_i32 s7, s7, 30720
    s_add_u32 s7, s7, 62976
    s_cmp_eq_u32 s62, 0
    s_cselect_b32 s7, 0, s7
    s_mul_i32 s4, s27, 5120
    s_add_u32 s4, s4, 30720
    s_mov_b32 s44, s20
    s_mov_b32 s45, s21
    s_mov_b32 s46, 0x280000
    s_mov_b32 s47, 0x20000
    v_and_b32 v248, 15, v255
    v_mul_u32_u24 v248, 1280, v248
    v_bfe_u32 v250, v255, 4, 1
    v_lshl_add_u32 v248, v250, 5, v248
    v_lshrrev_b32 v250, 5, v255
    v_lshl_add_u32 v248, v250, 4, v248
    v_and_b32 v60, 63, v248
    v_add_u32 v60, 163648, v60
    v_lshrrev_b32 v61, 4, v255
    v_lshlrev_b32 v61, 3, v61
    v_add_u32 v61, 163648, v61
    ds_read_b128 v[50:53], v60
    ds_read_b128 v[54:57], v60 offset:64
    ds_read_b64 v[58:59], v61 offset:128
    s_waitcnt lgkmcnt(0)
    s_waitcnt vmcnt(0)
    v_lshlrev_b32 v0, 16, v40
    v_and_b32 v1, s97, v40
    v_lshlrev_b32 v20, 16, v50
    v_and_b32 v21, s97, v50
    v_lshlrev_b32 v2, 16, v41
    v_and_b32 v3, s97, v41
    v_lshlrev_b32 v22, 16, v51
    v_and_b32 v23, s97, v51
    v_lshlrev_b32 v4, 16, v42
    v_and_b32 v5, s97, v42
    v_lshlrev_b32 v24, 16, v52
    v_and_b32 v25, s97, v52
    v_lshlrev_b32 v6, 16, v43
    v_and_b32 v7, s97, v43
    v_lshlrev_b32 v26, 16, v53
    v_and_b32 v27, s97, v53
    v_lshlrev_b32 v8, 16, v44
    v_and_b32 v9, s97, v44
    v_lshlrev_b32 v28, 16, v54
    v_and_b32 v29, s97, v54
    v_lshlrev_b32 v10, 16, v45
    v_and_b32 v11, s97, v45
    v_lshlrev_b32 v30, 16, v55
    v_and_b32 v31, s97, v55
    v_lshlrev_b32 v12, 16, v46
    v_and_b32 v13, s97, v46
    v_lshlrev_b32 v32, 16, v56
    v_and_b32 v33, s97, v56
    v_lshlrev_b32 v14, 16, v47
    v_and_b32 v15, s97, v47
    v_lshlrev_b32 v34, 16, v57
    v_and_b32 v35, s97, v57
    v_lshlrev_b32 v16, 16, v48
    v_and_b32 v17, s97, v48
    v_lshlrev_b32 v36, 16, v58
    v_and_b32 v37, s97, v58
    v_lshlrev_b32 v18, 16, v49
    v_and_b32 v19, s97, v49
    v_lshlrev_b32 v38, 16, v59
    v_and_b32 v39, s97, v59
    v_add_f32 v0, v0, v20
    v_add_f32 v1, v1, v21
    v_add_f32 v2, v2, v22
    v_add_f32 v3, v3, v23
    v_add_f32 v4, v4, v24
    v_add_f32 v5, v5, v25
    v_add_f32 v6, v6, v26
    v_add_f32 v7, v7, v27
    v_add_f32 v8, v8, v28
    v_add_f32 v9, v9, v29
    v_add_f32 v10, v10, v30
    v_add_f32 v11, v11, v31
    v_add_f32 v12, v12, v32
    v_add_f32 v13, v13, v33
    v_add_f32 v14, v14, v34
    v_add_f32 v15, v15, v35
    v_add_f32 v16, v16, v36
    v_add_f32 v17, v17, v37
    v_add_f32 v18, v18, v38
    v_add_f32 v19, v19, v39
    v_permlane16_swap_b32 v0, v4
    v_permlane16_swap_b32 v1, v5
    v_permlane16_swap_b32 v2, v6
    v_permlane16_swap_b32 v3, v7
    v_permlane16_swap_b32 v8, v12
    v_permlane16_swap_b32 v9, v13
    v_permlane16_swap_b32 v10, v14
    v_permlane16_swap_b32 v11, v15
    s_lshl_b32 s71, s58, 3
    s_add_u32 s71, s71, s59
    s_lshl_b32 s71, s71, 8
    s_add_u32 s71, s71, 12900352
    s_add_u32 s72, s71, 0
    s_mov_b32 s96, 100000
    s_add_u32 s64, s24, s72
    s_addc_u32 s65, s25, 0
L_cp12:
    s_load_dword s66, s[64:65], 0 glc
    s_waitcnt lgkmcnt(0)
    s_cmp_ge_u32 s66, 7
    s_cbranch_scc1 L_cpe13
    s_sleep 1
    s_sub_u32 s96, s96, 1
    s_cmp_lg_u32 s96, 0
    s_cbranch_scc1 L_cp12
L_cpe13:
    s_setprio 2
    s_add_u32 s60, s88, s76
    buffer_load_dwordx4 v[200:203], v254, s[36:39], s60 offen sc1
    s_add_u32 s60, s89, s76
    buffer_load_dwordx4 v[204:207], v254, s[36:39], s60 offen sc1
    s_add_u32 s60, s90, s76
    buffer_load_dwordx4 v[208:211], v254, s[36:39], s60 offen sc1
    s_add_u32 s60, s91, s76
    buffer_load_dwordx4 v[212:215], v254, s[36:39], s60 offen sc1
    s_add_u32 s60, s88, s77
    buffer_load_dwordx4 v[216:219], v254, s[36:39], s60 offen sc1
    s_add_u32 s60, s89, s77
    buffer_load_dwordx4 v[220:223], v254, s[36:39], s60 offen sc1
    s_add_u32 s60, s90, s77
    buffer_load_dwordx4 v[224:227], v254, s[36:39], s60 offen sc1
    s_add_u32 s60, s91, s77
    buffer_load_dwordx4 v[228:231], v254, s[36:39], s60 offen sc1
    s_add_u32 s60, s88, s78
    buffer_load_dwordx4 v[232:235], v254, s[36:39], s60 offen sc1
    s_add_u32 s60, s89, s78
    buffer_load_dwordx4 v[236:239], v254, s[36:39], s60 offen sc1
    s_waitcnt vmcnt(9)
    s_add_u32 s60, s90, s78
    buffer_load_dwordx4 v[240:243], v254, s[36:39], s60 offen sc1
    v_mfma_f32_16x16x32_bf16 v[0:3], v[80:83], v[200:203], v[0:3]
    v_mfma_f32_16x16x32_bf16 v[4:7], v[84:87], v[200:203], v[4:7]
    v_mfma_f32_16x16x32_bf16 v[8:11], v[88:91], v[200:203], v[8:11]
    v_mfma_f32_16x16x32_bf16 v[12:15], v[92:95], v[200:203], v[12:15]
    v_mfma_f32_16x16x32_bf16 v[16:19], v[96:99], v[200:203], v[16:19]
    s_waitcnt vmcnt(9)
    s_add_u32 s60, s91, s78
    buffer_load_dwordx4 v[244:247], v254, s[36:39], s60 offen sc1
    v_mfma_f32_16x16x32_bf16 v[36:39], v[96:99], v[204:207], 0
    v_mfma_f32_16x16x32_bf16 v[32:35], v[92:95], v[204:207], 0
    v_mfma_f32_16x16x32_bf16 v[28:31], v[88:91], v[204:207], 0
    v_mfma_f32_16x16x32_bf16 v[24:27], v[84:87], v[204:207], 0
    v_mfma_f32_16x16x32_bf16 v[20:23], v[80:83], v[204:207], 0
    s_waitcnt vmcnt(9)
    s_add_u32 s60, s88, s79
    buffer_load_dwordx4 v[200:203], v254, s[36:39], s60 offen sc1
    v_mfma_f32_16x16x32_bf16 v[40:43], v[80:83], v[208:211], 0
    v_mfma_f32_16x16x32_bf16 v[44:47], v[84:87], v[208:211], 0
    v_mfma_f32_16x16x32_bf16 v[48:51], v[88:91], v[208:211], 0
    v_mfma_f32_16x16x32_bf16 v[52:55], v[92:95], v[208:211], 0
    v_mfma_f32_16x16x32_bf16 v[56:59], v[96:99], v[208:211], 0
    s_waitcnt vmcnt(9)
    s_add_u32 s60, s89, s79
    buffer_load_dwordx4 v[204:207], v254, s[36:39], s60 offen sc1
    v_mfma_f32_16x16x32_bf16 v[76:79], v[96:99], v[212:215], 0
    v_mfma_f32_16x16x32_bf16 v[72:75], v[92:95], v[212:215], 0
    v_mfma_f32_16x16x32_bf16 v[68:71], v[88:91], v[212:215], 0
    v_mfma_f32_16x16x32_bf16 v[64:67], v[84:87], v[212:215], 0
    v_mfma_f32_16x16x32_bf16 v[60:63], v[80:83], v[212:215], 0
    s_waitcnt vmcnt(9)
    s_add_u32 s60, s90, s79
    buffer_load_dwordx4 v[208:211], v254, s[36:39], s60 offen sc1
    v_mfma_f32_16x16x32_bf16 v[0:3], v[100:103], v[216:219], v[0:3]
    ds_read_b128 v[80:83], v252 offset:0
    v_mfma_f32_16x16x32_bf16 v[4:7], v[104:107], v[216:219], v[4:7]
    ds_read_b128 v[84:87], v252 offset:1024
    v_mfma_f32_16x16x32_bf16 v[8:11], v[108:111], v[216:219], v[8:11]
    ds_read_b128 v[88:91], v252 offset:2048
    v_mfma_f32_16x16x32_bf16 v[12:15], v[112:115], v[216:219], v[12:15]
    ds_read_b128 v[92:95], v252 offset:3072
    v_mfma_f32_16x16x32_bf16 v[16:19], v[116:119], v[216:219], v[16:19]
    ds_read_b128 v[96:99], v252 offset:4096
    s_waitcnt vmcnt(9)
    s_add_u32 s60, s91, s79
    buffer_load_dwordx4 v[212:215], v254, s[36:39], s60 offen sc1
    v_mfma_f32_16x16x32_bf16 v[36:39], v[116:119], v[220:223], v[36:39]
    v_mfma_f32_16x16x32_bf16 v[32:35], v[112:115], v[220:223], v[32:35]
    v_mfma_f32_16x16x32_bf16 v[28:31], v[108:111], v[220:223], v[28:31]
    v_mfma_f32_16x16x32_bf16 v[24:27], v[104:107], v[220:223], v[24:27]
    v_mfma_f32_16x16x32_bf16 v[20:23], v[100:103], v[220:223], v[20:23]
    s_waitcnt vmcnt(9)
    s_add_u32 s60, s88, s80
    buffer_load_dwordx4 v[216:219], v254, s[36:39], s60 offen sc1
    v_mfma_f32_16x16x32_bf16 v[40:43], v[100:103], v[224:227], v[40:43]
    v_mfma_f32_16x16x32_bf16 v[44:47], v[104:107], v[224:227], v[44:47]
    v_mfma_f32_16x16x32_bf16 v[48:51], v[108:111], v[224:227], v[48:51]
    v_mfma_f32_16x16x32_bf16 v[52:55], v[112:115], v[224:227], v[52:55]
    v_mfma_f32_16x16x32_bf16 v[56:59], v[116:119], v[224:227], v[56:59]
    s_waitcnt vmcnt(9)
    s_add_u32 s60, s89, s80
    buffer_load_dwordx4 v[220:223], v254, s[36:39], s60 offen sc1
    v_mfma_f32_16x16x32_bf16 v[76:79], v[116:119], v[228:231], v[76:79]
    v_mfma_f32_16x16x32_bf16 v[72:75], v[112:115], v[228:231], v[72:75]
    v_mfma_f32_16x16x32_bf16 v[68:71], v[108:111], v[228:231], v[68:71]
    v_mfma_f32_16x16x32_bf16 v[64:67], v[104:107], v[228:231], v[64:67]
    v_mfma_f32_16x16x32_bf16 v[60:63], v[100:103], v[228:231], v[60:63]
    s_waitcnt vmcnt(9)
    s_add_u32 s60, s90, s80
    buffer_load_dwordx4 v[224:227], v254, s[36:39], s60 offen sc1
    v_mfma_f32_16x16x32_bf16 v[0:3], v[120:123], v[232:235], v[0:3]
    ds_read_b128 v[100:103], v252 offset:5120
    v_mfma_f32_16x16x32_bf16 v[4:7], v[124:127], v[232:235], v[4:7]
    ds_read_b128 v[104:107], v252 offset:6144
    v_mfma_f32_16x16x32_bf16 v[8:11], v[128:131], v[232:235], v[8:11]
    ds_read_b128 v[108:111], v252 offset:7168
    v_mfma_f32_16x16x32_bf16 v[12:15], v[132:135], v[232:235], v[12:15]
    ds_read_b128 v[112:115], v252 offset:8192
    v_mfma_f32_16x16x32_bf16 v[16:19], v[136:139], v[232:235], v[16:19]
    ds_read_b128 v[116:119], v252 offset:9216
    s_waitcnt vmcnt(9)
    s_add_u32 s60, s91, s80
    buffer_load_dwordx4 v[228:231], v254, s[36:39], s60 offen sc1
    v_mfma_f32_16x16x32_bf16 v[36:39], v[136:139], v[236:239], v[36:39]
    v_mfma_f32_16x16x32_bf16 v[32:35], v[132:135], v[236:239], v[32:35]
    v_mfma_f32_16x16x32_bf16 v[28:31], v[128:131], v[236:239], v[28:31]
    v_mfma_f32_16x16x32_bf16 v[24:27], v[124:127], v[236:239], v[24:27]
    v_mfma_f32_16x16x32_bf16 v[20:23], v[120:123], v[236:239], v[20:23]
    s_waitcnt vmcnt(9)
    s_add_u32 s60, s88, s81
    buffer_load_dwordx4 v[232:235], v254, s[36:39], s60 offen sc1
    v_mfma_f32_16x16x32_bf16 v[40:43], v[120:123], v[240:243], v[40:43]
    v_mfma_f32_16x16x32_bf16 v[44:47], v[124:127], v[240:243], v[44:47]
    v_mfma_f32_16x16x32_bf16 v[48:51], v[128:131], v[240:243], v[48:51]
    v_mfma_f32_16x16x32_bf16 v[52:55], v[132:135], v[240:243], v[52:55]
    v_mfma_f32_16x16x32_bf16 v[56:59], v[136:139], v[240:243], v[56:59]
    s_waitcnt vmcnt(9)
    s_add_u32 s60, s89, s81
    buffer_load_dwordx4 v[236:239], v254, s[36:39], s60 offen sc1
    v_mfma_f32_16x16x32_bf16 v[76:79], v[136:139], v[244:247], v[76:79]
    v_mfma_f32_16x16x32_bf16 v[72:75], v[132:135], v[244:247], v[72:75]
    v_mfma_f32_16x16x32_bf16 v[68:71], v[128:131], v[244:247], v[68:71]
    v_mfma_f32_16x16x32_bf16 v[64:67], v[124:127], v[244:247], v[64:67]
    v_mfma_f32_16x16x32_bf16 v[60:63], v[120:123], v[244:247], v[60:63]
    s_waitcnt vmcnt(9)
    s_add_u32 s60, s90, s81
    buffer_load_dwordx4 v[240:243], v254, s[36:39], s60 offen sc1
    v_mfma_f32_16x16x32_bf16 v[0:3], v[140:143], v[200:203], v[0:3]
    ds_read_b128 v[120:123], v252 offset:10240
    v_mfma_f32_16x16x32_bf16 v[4:7], v[144:147], v[200:203], v[4:7]
    ds_read_b128 v[124:127], v252 offset:11264
    v_mfma_f32_16x16x32_bf16 v[8:11], v[148:151], v[200:203], v[8:11]
    ds_read_b128 v[128:131], v252 offset:12288
    v_mfma_f32_16x16x32_bf16 v[12:15], v[152:155], v[200:203], v[12:15]
    ds_read_b128 v[132:135], v252 offset:13312
    v_mfma_f32_16x16x32_bf16 v[16:19], v[156:159], v[200:203], v[16:19]
    ds_read_b128 v[136:139], v252 offset:14336
    s_waitcnt vmcnt(9)
    s_add_u32 s60, s91, s81
    buffer_load_dwordx4 v[244:247], v254, s[36:39], s60 offen sc1
    v_mfma_f32_16x16x32_bf16 v[36:39], v[156:159], v[204:207], v[36:39]
    v_mfma_f32_16x16x32_bf16 v[32:35], v[152:155], v[204:207], v[32:35]
    v_mfma_f32_16x16x32_bf16 v[28:31], v[148:151], v[204:207], v[28:31]
    v_mfma_f32_16x16x32_bf16 v[24:27], v[144:147], v[204:207], v[24:27]
    v_mfma_f32_16x16x32_bf16 v[20:23], v[140:143], v[204:207], v[20:23]
    s_waitcnt vmcnt(9)
    s_add_u32 s60, s88, s82
    buffer_load_dwordx4 v[200:203], v254, s[36:39], s60 offen sc1
    v_mfma_f32_16x16x32_bf16 v[40:43], v[140:143], v[208:211], v[40:43]
    v_mfma_f32_16x16x32_bf16 v[44:47], v[144:147], v[208:211], v[44:47]
    v_mfma_f32_16x16x32_bf16 v[48:51], v[148:151], v[208:211], v[48:51]
    v_mfma_f32_16x16x32_bf16 v[52:55], v[152:155], v[208:211], v[52:55]
    v_mfma_f32_16x16x32_bf16 v[56:59], v[156:159], v[208:211], v[56:59]
    s_waitcnt vmcnt(9)
    s_add_u32 s60, s89, s82
    buffer_load_dwordx4 v[204:207], v254, s[36:39], s60 offen sc1
    v_mfma_f32_16x16x32_bf16 v[76:79], v[156:159], v[212:215], v[76:79]
    v_mfma_f32_16x16x32_bf16 v[72:75], v[152:155], v[212:215], v[72:75]
    v_mfma_f32_16x16x32_bf16 v[68:71], v[148:151], v[212:215], v[68:71]
    v_mfma_f32_16x16x32_bf16 v[64:67], v[144:147], v[212:215], v[64:67]
    v_mfma_f32_16x16x32_bf16 v[60:63], v[140:143], v[212:215], v[60:63]
    s_waitcnt vmcnt(9)
    s_add_u32 s60, s90, s82
    buffer_load_dwordx4 v[208:211], v254, s[36:39], s60 offen sc1
    v_mfma_f32_16x16x32_bf16 v[0:3], v[160:163], v[216:219], v[0:3]
    ds_read_b128 v[140:143], v252 offset:15360
    v_mfma_f32_16x16x32_bf16 v[4:7], v[164:167], v[216:219], v[4:7]
    ds_read_b128 v[144:147], v252 offset:16384
    v_mfma_f32_16x16x32_bf16 v[8:11], v[168:171], v[216:219], v[8:11]
    ds_read_b128 v[148:151], v252 offset:17408
    v_mfma_f32_16x16x32_bf16 v[12:15], v[172:175], v[216:219], v[12:15]
    ds_read_b128 v[152:155], v252 offset:18432
    v_mfma_f32_16x16x32_bf16 v[16:19], v[176:179], v[216:219], v[16:19]
    ds_read_b128 v[156:159], v252 offset:19456
    s_waitcnt vmcnt(9)
    s_add_u32 s60, s91, s82
    buffer_load_dwordx4 v[212:215], v254, s[36:39], s60 offen sc1
    v_mfma_f32_16x16x32_bf16 v[36:39], v[176:179], v[220:223], v[36:39]
    v_mfma_f32_16x16x32_bf16 v[32:35], v[172:175], v[220:223], v[32:35]
    v_mfma_f32_16x16x32_bf16 v[28:31], v[168:171], v[220:223], v[28:31]
    v_mfma_f32_16x16x32_bf16 v[24:27], v[164:167], v[220:223], v[24:27]
    v_mfma_f32_16x16x32_bf16 v[20:23], v[160:163], v[220:223], v[20:23]
    s_waitcnt vmcnt(9)
    s_add_u32 s60, s88, s83
    buffer_load_dwordx4 v[216:219], v254, s[36:39], s60 offen sc1
    v_mfma_f32_16x16x32_bf16 v[40:43], v[160:163], v[224:227], v[40:43]
    v_mfma_f32_16x16x32_bf16 v[44:47], v[164:167], v[224:227], v[44:47]
    v_mfma_f32_16x16x32_bf16 v[48:51], v[168:171], v[224:227], v[48:51]
    v_mfma_f32_16x16x32_bf16 v[52:55], v[172:175], v[224:227], v[52:55]
    v_mfma_f32_16x16x32_bf16 v[56:59], v[176:179], v[224:227], v[56:59]
    s_waitcnt vmcnt(9)
    s_add_u32 s60, s89, s83
    buffer_load_dwordx4 v[220:223], v254, s[36:39], s60 offen sc1
    v_mfma_f32_16x16x32_bf16 v[76:79], v[176:179], v[228:231], v[76:79]
    v_mfma_f32_16x16x32_bf16 v[72:75], v[172:175], v[228:231], v[72:75]
    v_mfma_f32_16x16x32_bf16 v[68:71], v[168:171], v[228:231], v[68:71]
    v_mfma_f32_16x16x32_bf16 v[64:67], v[164:167], v[228:231], v[64:67]
    v_mfma_f32_16x16x32_bf16 v[60:63], v[160:163], v[228:231], v[60:63]
    s_waitcnt lgkmcnt(0)
    s_waitcnt vmcnt(9)
    s_add_u32 s60, s90, s83
    buffer_load_dwordx4 v[224:227], v254, s[36:39], s60 offen sc1
    v_mfma_f32_16x16x32_bf16 v[0:3], v[180:183], v[232:235], v[0:3]
    ds_read_b128 v[160:163], v252 offset:20480
    v_mfma_f32_16x16x32_bf16 v[4:7], v[184:187], v[232:235], v[4:7]
    ds_read_b128 v[164:167], v252 offset:21504
    v_mfma_f32_16x16x32_bf16 v[8:11], v[188:191], v[232:235], v[8:11]
    ds_read_b128 v[168:171], v252 offset:22528
    v_mfma_f32_16x16x32_bf16 v[12:15], v[192:195], v[232:235], v[12:15]
    ds_read_b128 v[172:175], v252 offset:23552
    v_mfma_f32_16x16x32_bf16 v[16:19], v[196:199], v[232:235], v[16:19]
    ds_read_b128 v[176:179], v252 offset:24576
    s_waitcnt vmcnt(9)
    s_add_u32 s60, s91, s83
    buffer_load_dwordx4 v[228:231], v254, s[36:39], s60 offen sc1
    v_mfma_f32_16x16x32_bf16 v[36:39], v[196:199], v[236:239], v[36:39]
    s_lshl_b32 s63, s27, 2
    s_add_u32 s63, s63, 163376
    v_mov_b32 v250, s63
    v_mfma_f32_16x16x32_bf16 v[32:35], v[192:195], v[236:239], v[32:35]
    ds_write_b32 v250, v250
    v_mfma_f32_16x16x32_bf16 v[28:31], v[188:191], v[236:239], v[28:31]
    v_mfma_f32_16x16x32_bf16 v[24:27], v[184:187], v[236:239], v[24:27]
    v_mfma_f32_16x16x32_bf16 v[20:23], v[180:183], v[236:239], v[20:23]
    s_waitcnt vmcnt(9)
    s_add_u32 s60, s88, s84
    buffer_load_dwordx4 v[232:235], v254, s[36:39], s60 offen sc1
    v_mfma_f32_16x16x32_bf16 v[40:43], v[180:183], v[240:243], v[40:43]
    v_mfma_f32_16x16x32_bf16 v[44:47], v[184:187], v[240:243], v[44:47]
    v_mfma_f32_16x16x32_bf16 v[48:51], v[188:191], v[240:243], v[48:51]
    v_mfma_f32_16x16x32_bf16 v[52:55], v[192:195], v[240:243], v[52:55]
    v_mfma_f32_16x16x32_bf16 v[56:59], v[196:199], v[240:243], v[56:59]
    s_waitcnt vmcnt(9)
    s_add_u32 s60, s89, s84
    buffer_load_dwordx4 v[236:239], v254, s[36:39], s60 offen sc1
    v_mfma_f32_16x16x32_bf16 v[76:79], v[196:199], v[244:247], v[76:79]
    v_mfma_f32_16x16x32_bf16 v[72:75], v[192:195], v[244:247], v[72:75]
    v_mfma_f32_16x16x32_bf16 v[68:71], v[188:191], v[244:247], v[68:71]
    v_mfma_f32_16x16x32_bf16 v[64:67], v[184:187], v[244:247], v[64:67]
    v_mfma_f32_16x16x32_bf16 v[60:63], v[180:183], v[244:247], v[60:63]
    s_waitcnt vmcnt(9)
    s_add_u32 s60, s90, s84
    buffer_load_dwordx4 v[240:243], v254, s[36:39], s60 offen sc1
    v_mfma_f32_16x16x32_bf16 v[0:3], v[80:83], v[200:203], v[0:3]
    ds_read_b128 v[180:183], v252 offset:25600
    v_mfma_f32_16x16x32_bf16 v[4:7], v[84:87], v[200:203], v[4:7]
    ds_read_b128 v[184:187], v252 offset:26624
    v_mfma_f32_16x16x32_bf16 v[8:11], v[88:91], v[200:203], v[8:11]
    ds_read_b128 v[188:191], v252 offset:27648
    v_mfma_f32_16x16x32_bf16 v[12:15], v[92:95], v[200:203], v[12:15]
    ds_read_b128 v[192:195], v252 offset:28672
    v_mfma_f32_16x16x32_bf16 v[16:19], v[96:99], v[200:203], v[16:19]
    ds_read_b128 v[196:199], v252 offset:29696
    s_waitcnt vmcnt(9)
    s_add_u32 s60, s91, s84
    buffer_load_dwordx4 v[244:247], v254, s[36:39], s60 offen sc1
    v_mfma_f32_16x16x32_bf16 v[36:39], v[96:99], v[204:207], v[36:39]
    v_mfma_f32_16x16x32_bf16 v[32:35], v[92:95], v[204:207], v[32:35]
    v_mfma_f32_16x16x32_bf16 v[28:31], v[88:91], v[204:207], v[28:31]
    v_mfma_f32_16x16x32_bf16 v[24:27], v[84:87], v[204:207], v[24:27]
    v_mfma_f32_16x16x32_bf16 v[20:23], v[80:83], v[204:207], v[20:23]
    s_waitcnt vmcnt(9)
    s_add_u32 s60, s89, s85
    buffer_load_dwordx4 v[200:203], v254, s[36:39], s60 offen sc1
    v_mfma_f32_16x16x32_bf16 v[40:43], v[80:83], v[208:211], v[40:43]
    v_mfma_f32_16x16x32_bf16 v[44:47], v[84:87], v[208:211], v[44:47]
    v_mfma_f32_16x16x32_bf16 v[48:51], v[88:91], v[208:211], v[48:51]
    v_mfma_f32_16x16x32_bf16 v[52:55], v[92:95], v[208:211], v[52:55]
    v_mfma_f32_16x16x32_bf16 v[56:59], v[96:99], v[208:211], v[56:59]
    s_waitcnt vmcnt(9)
    s_add_u32 s60, s89, s86
    buffer_load_dwordx4 v[204:207], v254, s[36:39], s60 offen sc1
    v_mfma_f32_16x16x32_bf16 v[76:79], v[96:99], v[212:215], v[76:79]
    v_mfma_f32_16x16x32_bf16 v[72:75], v[92:95], v[212:215], v[72:75]
    v_mfma_f32_16x16x32_bf16 v[68:71], v[88:91], v[212:215], v[68:71]
    v_mfma_f32_16x16x32_bf16 v[64:67], v[84:87], v[212:215], v[64:67]
    v_mfma_f32_16x16x32_bf16 v[60:63], v[80:83], v[212:215], v[60:63]
    s_waitcnt vmcnt(9)
    s_add_u32 s60, s89, s87
    buffer_load_dwordx4 v[208:211], v254, s[36:39], s60 offen sc1
    v_mfma_f32_16x16x32_bf16 v[0:3], v[100:103], v[216:219], v[0:3]
    v_mfma_f32_16x16x32_bf16 v[4:7], v[104:107], v[216:219], v[4:7]
    v_mfma_f32_16x16x32_bf16 v[8:11], v[108:111], v[216:219], v[8:11]
    v_mfma_f32_16x16x32_bf16 v[12:15], v[112:115], v[216:219], v[12:15]
    v_mfma_f32_16x16x32_bf16 v[16:19], v[116:119], v[216:219], v[16:19]
    s_waitcnt vmcnt(9)
    s_add_u32 s60, s90, s85
    buffer_load_dwordx4 v[212:215], v254, s[36:39], s60 offen sc1
    v_mfma_f32_16x16x32_bf16 v[36:39], v[116:119], v[220:223], v[36:39]
    v_mfma_f32_16x16x32_bf16 v[32:35], v[112:115], v[220:223], v[32:35]
    v_mfma_f32_16x16x32_bf16 v[28:31], v[108:111], v[220:223], v[28:31]
    v_mfma_f32_16x16x32_bf16 v[24:27], v[104:107], v[220:223], v[24:27]
    v_mfma_f32_16x16x32_bf16 v[20:23], v[100:103], v[220:223], v[20:23]
    s_waitcnt vmcnt(9)
    s_add_u32 s60, s90, s86
    buffer_load_dwordx4 v[216:219], v254, s[36:39], s60 offen sc1
    v_mfma_f32_16x16x32_bf16 v[40:43], v[100:103], v[224:227], v[40:43]
    v_mfma_f32_16x16x32_bf16 v[44:47], v[104:107], v[224:227], v[44:47]
    v_mfma_f32_16x16x32_bf16 v[48:51], v[108:111], v[224:227], v[48:51]
    v_mfma_f32_16x16x32_bf16 v[52:55], v[112:115], v[224:227], v[52:55]
    v_mfma_f32_16x16x32_bf16 v[56:59], v[116:119], v[224:227], v[56:59]
    s_waitcnt vmcnt(9)
    s_add_u32 s60, s90, s87
    buffer_load_dwordx4 v[220:223], v254, s[36:39], s60 offen sc1
    v_mfma_f32_16x16x32_bf16 v[76:79], v[116:119], v[228:231], v[76:79]
    v_mfma_f32_16x16x32_bf16 v[72:75], v[112:115], v[228:231], v[72:75]
    v_mfma_f32_16x16x32_bf16 v[68:71], v[108:111], v[228:231], v[68:71]
    v_mfma_f32_16x16x32_bf16 v[64:67], v[104:107], v[228:231], v[64:67]
    v_mfma_f32_16x16x32_bf16 v[60:63], v[100:103], v[228:231], v[60:63]
    s_mov_b32 s96, 800000
    v_mov_b32 v250, 163356
L_lw14:
    ds_read_b32 v251, v250
    s_waitcnt lgkmcnt(0)
    v_readfirstlane_b32 s60, v251
    s_nop 0
    s_cmp_ge_u32 s60, 4
    s_cbranch_scc1 L_lwe15
    s_sleep 1
    s_sub_u32 s96, s96, 1
    s_cmp_lg_u32 s96, 0
    s_cbranch_scc1 L_lw14
L_lwe15:
    s_waitcnt vmcnt(9)
    s_add_u32 s60, s91, s85
    buffer_load_dwordx4 v[224:227], v254, s[36:39], s60 offen sc1
    v_mfma_f32_16x16x32_bf16 v[0:3], v[120:123], v[232:235], v[0:3]
    v_add_u32 v80, s4, v254
    v_mfma_f32_16x16x32_bf16 v[4:7], v[124:127], v[232:235], v[4:7]
    v_add_u32 v81, s5, v254
    v_mfma_f32_16x16x32_bf16 v[8:11], v[128:131], v[232:235], v[8:11]
    v_add_u32 v82, s6, v254
    v_mfma_f32_16x16x32_bf16 v[12:15], v[132:135], v[232:235], v[12:15]
    v_add_u32 v83, s7, v254
    v_mfma_f32_16x16x32_bf16 v[16:19], v[136:139], v[232:235], v[16:19]
    s_waitcnt vmcnt(9)
    s_add_u32 s60, s91, s86
    buffer_load_dwordx4 v[228:231], v254, s[36:39], s60 offen sc1
    v_mfma_f32_16x16x32_bf16 v[36:39], v[136:139], v[236:239], v[36:39]
    v_mfma_f32_16x16x32_bf16 v[32:35], v[132:135], v[236:239], v[32:35]
    v_mfma_f32_16x16x32_bf16 v[28:31], v[128:131], v[236:239], v[28:31]
    v_mfma_f32_16x16x32_bf16 v[24:27], v[124:127], v[236:239], v[24:27]
    v_mfma_f32_16x16x32_bf16 v[20:23], v[120:123], v[236:239], v[20:23]
    s_waitcnt vmcnt(9)
    s_add_u32 s60, s91, s87
    buffer_load_dwordx4 v[232:235], v254, s[36:39], s60 offen sc1
    v_mfma_f32_16x16x32_bf16 v[40:43], v[120:123], v[240:243], v[40:43]
    v_mfma_f32_16x16x32_bf16 v[44:47], v[124:127], v[240:243], v[44:47]
    v_mfma_f32_16x16x32_bf16 v[48:51], v[128:131], v[240:243], v[48:51]
    v_mfma_f32_16x16x32_bf16 v[52:55], v[132:135], v[240:243], v[52:55]
    v_mfma_f32_16x16x32_bf16 v[56:59], v[136:139], v[240:243], v[56:59]
    s_waitcnt vmcnt(9)
    s_add_u32 s60, s88, s85
    buffer_load_dwordx4 v[236:239], v254, s[36:39], s60 offen sc1
    v_mfma_f32_16x16x32_bf16 v[76:79], v[136:139], v[244:247], v[76:79]
    v_mfma_f32_16x16x32_bf16 v[72:75], v[132:135], v[244:247], v[72:75]
    v_mfma_f32_16x16x32_bf16 v[68:71], v[128:131], v[244:247], v[68:71]
    v_mfma_f32_16x16x32_bf16 v[64:67], v[124:127], v[244:247], v[64:67]
    v_mfma_f32_16x16x32_bf16 v[60:63], v[120:123], v[244:247], v[60:63]
    s_waitcnt vmcnt(9)
    s_add_u32 s60, s88, s86
    buffer_load_dwordx4 v[240:243], v254, s[36:39], s60 offen sc1
    v_mfma_f32_16x16x32_bf16 v[20:23], v[140:143], v[200:203], v[20:23]
    v_mfma_f32_16x16x32_bf16 v[24:27], v[144:147], v[200:203], v[24:27]
    v_mfma_f32_16x16x32_bf16 v[28:31], v[148:151], v[200:203], v[28:31]
    v_mfma_f32_16x16x32_bf16 v[32:35], v[152:155], v[200:203], v[32:35]
    v_mfma_f32_16x16x32_bf16 v[36:39], v[156:159], v[200:203], v[36:39]
    s_waitcnt vmcnt(9)
    s_add_u32 s60, s88, s87
    buffer_load_dwordx4 v[244:247], v254, s[36:39], s60 offen sc1
    v_mfma_f32_16x16x32_bf16 v[36:39], v[176:179], v[204:207], v[36:39]
    v_mfma_f32_16x16x32_bf16 v[32:35], v[172:175], v[204:207], v[32:35]
    v_mfma_f32_16x16x32_bf16 v[28:31], v[168:171], v[204:207], v[28:31]
    v_mfma_f32_16x16x32_bf16 v[24:27], v[164:167], v[204:207], v[24:27]
    v_mfma_f32_16x16x32_bf16 v[20:23], v[160:163], v[204:207], v[20:23]
    s_waitcnt vmcnt(9)
    v_mfma_f32_16x16x32_bf16 v[20:23], v[180:183], v[208:211], v[20:23]
    v_mfma_f32_16x16x32_bf16 v[24:27], v[184:187], v[208:211], v[24:27]
    v_mfma_f32_16x16x32_bf16 v[28:31], v[188:191], v[208:211], v[28:31]
    v_mfma_f32_16x16x32_bf16 v[32:35], v[192:195], v[208:211], v[32:35]
    v_mfma_f32_16x16x32_bf16 v[36:39], v[196:199], v[208:211], v[36:39]
    s_waitcnt vmcnt(8)
    v_mfma_f32_16x16x32_bf16 v[56:59], v[156:159], v[212:215], v[56:59]
    v_mfma_f32_16x16x32_bf16 v[52:55], v[152:155], v[212:215], v[52:55]
    v_mfma_f32_16x16x32_bf16 v[48:51], v[148:151], v[212:215], v[48:51]
    v_mfma_f32_16x16x32_bf16 v[44:47], v[144:147], v[212:215], v[44:47]
    v_mfma_f32_16x16x32_bf16 v[40:43], v[140:143], v[212:215], v[40:43]
    s_waitcnt vmcnt(7)
    v_mfma_f32_16x16x32_bf16 v[40:43], v[160:163], v[216:219], v[40:43]
    ds_write_b128 v252, v[20:23] offset:15360
    v_mfma_f32_16x16x32_bf16 v[44:47], v[164:167], v[216:219], v[44:47]
    v_mfma_f32_16x16x32_bf16 v[48:51], v[168:171], v[216:219], v[48:51]
    ds_write_b128 v252, v[24:27] offset:16384
    v_mfma_f32_16x16x32_bf16 v[52:55], v[172:175], v[216:219], v[52:55]
    v_mfma_f32_16x16x32_bf16 v[56:59], v[176:179], v[216:219], v[56:59]
    ds_write_b128 v252, v[28:31] offset:17408
    s_waitcnt vmcnt(6)
    v_mfma_f32_16x16x32_bf16 v[56:59], v[196:199], v[220:223], v[56:59]
    v_mfma_f32_16x16x32_bf16 v[52:55], v[192:195], v[220:223], v[52:55]
    ds_write_b128 v252, v[32:35] offset:18432
    v_mfma_f32_16x16x32_bf16 v[48:51], v[188:191], v[220:223], v[48:51]
    v_mfma_f32_16x16x32_bf16 v[44:47], v[184:187], v[220:223], v[44:47]
    ds_write_b128 v252, v[36:39] offset:19456
    v_mfma_f32_16x16x32_bf16 v[40:43], v[180:183], v[220:223], v[40:43]
    s_waitcnt vmcnt(5)
    v_mfma_f32_16x16x32_bf16 v[60:63], v[140:143], v[224:227], v[60:63]
    v_mfma_f32_16x16x32_bf16 v[64:67], v[144:147], v[224:227], v[64:67]
    v_mfma_f32_16x16x32_bf16 v[68:71], v[148:151], v[224:227], v[68:71]
    v_mfma_f32_16x16x32_bf16 v[72:75], v[152:155], v[224:227], v[72:75]
    v_mfma_f32_16x16x32_bf16 v[76:79], v[156:159], v[224:227], v[76:79]
    s_waitcnt vmcnt(4)
    v_mfma_f32_16x16x32_bf16 v[76:79], v[176:179], v[228:231], v[76:79]
    ds_write_b128 v252, v[40:43] offset:20480
    v_mfma_f32_16x16x32_bf16 v[72:75], v[172:175], v[228:231], v[72:75]
    v_mfma_f32_16x16x32_bf16 v[68:71], v[168:171], v[228:231], v[68:71]
    ds_write_b128 v252, v[44:47] offset:21504
    v_mfma_f32_16x16x32_bf16 v[64:67], v[164:167], v[228:231], v[64:67]
    v_mfma_f32_16x16x32_bf16 v[60:63], v[160:163], v[228:231], v[60:63]
    ds_write_b128 v252, v[48:51] offset:22528
    s_waitcnt vmcnt(3)
    v_mfma_f32_16x16x32_bf16 v[60:63], v[180:183], v[232:235], v[60:63]
    v_mfma_f32_16x16x32_bf16 v[64:67], v[184:187], v[232:235], v[64:67]
    ds_write_b128 v252, v[52:55] offset:23552
    v_mfma_f32_16x16x32_bf16 v[68:71], v[188:191], v[232:235], v[68:71]
    v_mfma_f32_16x16x32_bf16 v[72:75], v[192:195], v[232:235], v[72:75]
    ds_write_b128 v252, v[56:59] offset:24576
    v_mfma_f32_16x16x32_bf16 v[76:79], v[196:199], v[232:235], v[76:79]
    s_waitcnt vmcnt(2)
    v_mfma_f32_16x16x32_bf16 v[16:19], v[156:159], v[236:239], v[16:19]
    v_mfma_f32_16x16x32_bf16 v[12:15], v[152:155], v[236:239], v[12:15]
    v_mfma_f32_16x16x32_bf16 v[8:11], v[148:151], v[236:239], v[8:11]
    v_mfma_f32_16x16x32_bf16 v[4:7], v[144:147], v[236:239], v[4:7]
    v_mfma_f32_16x16x32_bf16 v[0:3], v[140:143], v[236:239], v[0:3]
    s_waitcnt vmcnt(1)
    v_mfma_f32_16x16x32_bf16 v[0:3], v[160:163], v[240:243], v[0:3]
    ds_write_b128 v252, v[60:63] offset:25600
    v_mfma_f32_16x16x32_bf16 v[4:7], v[164:167], v[240:243], v[4:7]
    v_mfma_f32_16x16x32_bf16 v[8:11], v[168:171], v[240:243], v[8:11]
    ds_write_b128 v252, v[64:67] offset:26624
    v_mfma_f32_16x16x32_bf16 v[12:15], v[172:175], v[240:243], v[12:15]
    v_mfma_f32_16x16x32_bf16 v[16:19], v[176:179], v[240:243], v[16:19]
    ds_write_b128 v252, v[68:71] offset:27648
    s_waitcnt vmcnt(0)
    v_mfma_f32_16x16x32_bf16 v[16:19], v[196:199], v[244:247], v[16:19]
    v_mfma_f32_16x16x32_bf16 v[12:15], v[192:195], v[244:247], v[12:15]
    ds_write_b128 v252, v[72:75] offset:28672
    v_mfma_f32_16x16x32_bf16 v[8:11], v[188:191], v[244:247], v[8:11]
    v_mfma_f32_16x16x32_bf16 v[4:7], v[184:187], v[244:247], v[4:7]
    ds_write_b128 v252, v[76:79] offset:29696
    v_mfma_f32_16x16x32_bf16 v[0:3], v[180:183], v[244:247], v[0:3]
    s_waitcnt lgkmcnt(4)
    s_nop 6
    ds_write_b128 v80, v[0:3] offset:0
    ds_write_b128 v80, v[4:7] offset:1024
    ds_write_b128 v80, v[8:11] offset:2048
    s_waitcnt lgkmcnt(0)
    s_barrier
    ds_read_b128 v[20:23], v80 offset:3072
    ds_read_b128 v[24:27], v80 offset:4096
    ds_read_b128 v[28:31], v81 offset:3072
    ds_read_b128 v[32:35], v81 offset:4096
    ds_read_b128 v[36:39], v81 offset:18432
    ds_read_b128 v[40:43], v81 offset:19456
    ds_read_b128 v[44:47], v82 offset:8192
    ds_read_b128 v[48:51], v82 offset:9216
    ds_read_b128 v[52:55], v82 offset:23552
    ds_read_b128 v[56:59], v82 offset:24576
    ds_read_b128 v[60:63], v83 offset:13312
    ds_read_b128 v[64:67], v83 offset:14336
    ds_read_b128 v[68:71], v83 offset:28672
    ds_read_b128 v[72:75], v83 offset:29696
    s_waitcnt lgkmcnt(12)
    v_pk_add_f32 v[12:13], v[12:13], v[20:21]
    v_pk_add_f32 v[14:15], v[14:15], v[22:23]
    v_pk_add_f32 v[16:17], v[16:17], v[24:25]
    v_pk_add_f32 v[18:19], v[18:19], v[26:27]
    s_waitcnt lgkmcnt(10)
    v_pk_add_f32 v[12:13], v[12:13], v[28:29]
    v_pk_add_f32 v[14:15], v[14:15], v[30:31]
    v_pk_add_f32 v[16:17], v[16:17], v[32:33]
    v_pk_add_f32 v[18:19], v[18:19], v[34:35]
    s_waitcnt lgkmcnt(8)
    v_pk_add_f32 v[12:13], v[12:13], v[36:37]
    v_pk_add_f32 v[14:15], v[14:15], v[38:39]
    v_pk_add_f32 v[16:17], v[16:17], v[40:41]
    v_pk_add_f32 v[18:19], v[18:19], v[42:43]
    s_waitcnt lgkmcnt(6)
    v_pk_add_f32 v[12:13], v[12:13], v[44:45]
    v_pk_add_f32 v[14:15], v[14:15], v[46:47]
    v_pk_add_f32 v[16:17], v[16:17], v[48:49]
    v_pk_add_f32 v[18:19], v[18:19], v[50:51]
    s_waitcnt lgkmcnt(4)
    v_pk_add_f32 v[12:13], v[12:13], v[52:53]
    v_pk_add_f32 v[14:15], v[14:15], v[54:55]
    v_pk_add_f32 v[16:17], v[16:17], v[56:57]
    v_pk_add_f32 v[18:19], v[18:19], v[58:59]
    s_waitcnt lgkmcnt(2)
    v_pk_add_f32 v[12:13], v[12:13], v[60:61]
    v_pk_add_f32 v[14:15], v[14:15], v[62:63]
    v_pk_add_f32 v[16:17], v[16:17], v[64:65]
    v_pk_add_f32 v[18:19], v[18:19], v[66:67]
    s_waitcnt lgkmcnt(0)
    v_pk_add_f32 v[12:13], v[12:13], v[68:69]
    v_pk_add_f32 v[14:15], v[14:15], v[70:71]
    v_pk_add_f32 v[16:17], v[16:17], v[72:73]
    v_pk_add_f32 v[18:19], v[18:19], v[74:75]
    v_cvt_pk_bf16_f32 v12, v12, v13
    v_cvt_pk_bf16_f32 v13, v14, v15
    v_cvt_pk_bf16_f32 v14, v16, v17
    v_cvt_pk_bf16_f32 v15, v18, v19
    s_nop 0
    v_permlane16_swap_b32 v12, v14
    v_permlane16_swap_b32 v13, v15
    buffer_store_dwordx4 v[12:15], v248, s[44:47], s98 offen offset:96
    s_endpgm
L_M:
    s_and_b32 s60, s2, 1
    s_lshl_b32 s62, s60, 10
    s_and_b32 s60, s2, 6
    s_lshl_b32 s60, s60, 7
    s_add_u32 s62, s62, s60
    s_and_b32 s60, s2, 0xf8
    s_add_u32 s62, s62, s60
    s_lshl_b32 s60, s26, 1
    s_add_u32 s62, s62, s60
    v_lshrrev_b32 v144, 5, v255
    v_and_b32 v145, 31, v255
    v_mul_u32_u24 v144, 1280, v144
    v_lshl_add_u32 v146, v145, 4, v144
    v_lshl_add_u32 v147, v145, 3, v144
    s_mul_i32 s60, s62, 1280
    buffer_load_dwordx4 v[176:179], v146, s[28:31], s60 offen
    buffer_load_dwordx4 v[180:183], v146, s[28:31], s60 offen offset:512
    buffer_load_dwordx2 v[184:185], v147, s[28:31], s60 offen offset:1024
    s_mov_b32 s17, 0xba65210
    s_mov_b32 s60, 0xdc98743
    s_cmp_eq_u32 s50, 1
    s_cselect_b32 s17, 0x6543210, s17
    s_cselect_b32 s60, 0x7dcba98, s60
    s_cmp_eq_u32 s50, 2
    s_cselect_b32 s17, 0xcdc3210, s17
    s_cselect_b32 s60, 0xcdc7654, s60
    s_cmp_eq_u32 s49, 14
    s_cselect_b32 s17, 0xc543210, s17
    s_cselect_b32 s60, 0xcba9876, s60
    s_cmp_ge_u32 s26, 2
    s_cselect_b32 s17, s60, s17
    v_lshrrev_b32 v144, 4, v255
    v_bfe_u32 v145, v255, 2, 2
    v_lshl_add_u32 v144, v144, 3, v145
    v_mul_u32_u24 v144, 448, v144
    v_and_b32 v145, 3, v255
    v_lshl_add_u32 v144, v145, 3, v144
    v_bfe_u32 v145, v255, 4, 1
    s_bfe_u32 s60, s17, 0x40000
    v_xor_b32 v146, s60, v145
    v_lshl_add_u32 v160, v146, 5, v144
    v_add_u32 v242, 43008, v160
    s_bfe_u32 s60, s17, 0x40004
    v_xor_b32 v146, s60, v145
    v_lshl_add_u32 v161, v146, 5, v144
    v_add_u32 v243, 43008, v161
    s_bfe_u32 s60, s17, 0x40008
    v_xor_b32 v146, s60, v145
    v_lshl_add_u32 v162, v146, 5, v144
    v_add_u32 v244, 43008, v162
    s_bfe_u32 s60, s17, 0x4000c
    v_xor_b32 v146, s60, v145
    v_lshl_add_u32 v163, v146, 5, v144
    v_add_u32 v245, 43008, v163
    s_bfe_u32 s60, s17, 0x40010
    v_xor_b32 v146, s60, v145
    v_lshl_add_u32 v164, v146, 5, v144
    v_add_u32 v246, 43008, v164
    s_bfe_u32 s60, s17, 0x40014
    v_xor_b32 v146, s60, v145
    v_lshl_add_u32 v165, v146, 5, v144
    v_add_u32 v247, 43008, v165
    s_bfe_u32 s60, s17, 0x40018
    v_xor_b32 v146, s60, v145
    v_lshl_add_u32 v166, v146, 5, v144
    v_add_u32 v248, 43008, v166
    v_and_b32 v144, 15, v255
    v_bfe_u32 v145, v255, 1, 3
    v_lshrrev_b32 v146, 4, v255
    v_xor_b32 v145, v145, v146
    v_lshlrev_b32 v144, 7, v144
    v_lshl_add_u32 v144, v145, 4, v144
    s_and_b32 s60, s26, 1
    s_lshl_b32 s60, s60, 13
    s_add_u32 s60, s60, 86016
    v_add_u32 v240, s60, v144
    v_xor_b32 v241, 64, v240
    s_waitcnt lgkmcnt(0)
    s_mul_i32 s101, s101, 0x9e3779b1
    s_add_u32 s101, s101, 0x7f4a7c15
    s_setprio 1
    s_waitcnt vmcnt(5)
    s_barrier
    ds_read_b128 v[112:115], v240 offset:0
    ds_read_b128 v[116:119], v240 offset:2048
    ds_read_b128 v[120:123], v240 offset:4096
    ds_read_b128 v[124:127], v240 offset:6144
    ds_read_b64_tr_b16 v[144:145], v160 offset:0
    ds_read_b64_tr_b16 v[146:147], v160 offset:1792
    ds_read_b64_tr_b16 v[148:149], v161 offset:0
    ds_read_b64_tr_b16 v[150:151], v161 offset:1792
    ds_read_b64_tr_b16 v[152:153], v162 offset:0
    ds_read_b64_tr_b16 v[154:155], v162 offset:1792
    s_waitcnt lgkmcnt(4)
    v_mfma_f32_16x16x32_bf16 v[0:3], v[144:147], v[112:115], 0
    ds_read_b64_tr_b16 v[156:157], v163 offset:0
    v_mfma_f32_16x16x32_bf16 v[28:31], v[144:147], v[116:119], 0
    ds_read_b64_tr_b16 v[158:159], v163 offset:1792
    v_mfma_f32_16x16x32_bf16 v[56:59], v[144:147], v[120:123], 0
    v_mfma_f32_16x16x32_bf16 v[84:87], v[144:147], v[124:127], 0
    s_waitcnt lgkmcnt(4)
    v_mfma_f32_16x16x32_bf16 v[88:91], v[148:151], v[124:127], 0
    ds_read_b64_tr_b16 v[144:145], v164 offset:0
    v_mfma_f32_16x16x32_bf16 v[60:63], v[148:151], v[120:123], 0
    ds_read_b64_tr_b16 v[146:147], v164 offset:1792
    v_mfma_f32_16x16x32_bf16 v[32:35], v[148:151], v[116:119], 0
    v_mfma_f32_16x16x32_bf16 v[4:7], v[148:151], v[112:115], 0
    s_waitcnt lgkmcnt(4)
    v_mfma_f32_16x16x32_bf16 v[8:11], v[152:155], v[112:115], 0
    ds_read_b64_tr_b16 v[148:149], v165 offset:0
    v_mfma_f32_16x16x32_bf16 v[36:39], v[152:155], v[116:119], 0
    ds_read_b64_tr_b16 v[150:151], v165 offset:1792
    v_mfma_f32_16x16x32_bf16 v[64:67], v[152:155], v[120:123], 0
    v_mfma_f32_16x16x32_bf16 v[92:95], v[152:155], v[124:127], 0
    s_waitcnt lgkmcnt(4)
    v_mfma_f32_16x16x32_bf16 v[96:99], v[156:159], v[124:127], 0
    ds_read_b64_tr_b16 v[152:153], v166 offset:0
    v_mfma_f32_16x16x32_bf16 v[68:71], v[156:159], v[120:123], 0
    ds_read_b64_tr_b16 v[154:155], v166 offset:1792
    v_mfma_f32_16x16x32_bf16 v[40:43], v[156:159], v[116:119], 0
    v_mfma_f32_16x16x32_bf16 v[12:15], v[156:159], v[112:115], 0
    s_waitcnt lgkmcnt(4)
    v_mfma_f32_16x16x32_bf16 v[16:19], v[144:147], v[112:115], 0
    s_waitcnt vmcnt(3)
    s_barrier
    ds_read_b64_tr_b16 v[156:157], v160 offset:14336
    v_mfma_f32_16x16x32_bf16 v[44:47], v[144:147], v[116:119], 0
    ds_read_b64_tr_b16 v[158:159], v160 offset:16128
    v_mfma_f32_16x16x32_bf16 v[72:75], v[144:147], v[120:123], 0
    ds_read_b128 v[128:131], v241 offset:0
    v_mfma_f32_16x16x32_bf16 v[100:103], v[144:147], v[124:127], 0
    ds_read_b128 v[132:135], v241 offset:2048
    s_waitcnt lgkmcnt(6)
    v_mfma_f32_16x16x32_bf16 v[104:107], v[148:151], v[124:127], 0
    ds_read_b64_tr_b16 v[144:145], v161 offset:14336
    v_mfma_f32_16x16x32_bf16 v[76:79], v[148:151], v[120:123], 0
    ds_read_b64_tr_b16 v[146:147], v161 offset:16128
    v_mfma_f32_16x16x32_bf16 v[48:51], v[148:151], v[116:119], 0
    ds_read_b128 v[136:139], v241 offset:4096
    v_mfma_f32_16x16x32_bf16 v[20:23], v[148:151], v[112:115], 0
    ds_read_b128 v[140:143], v241 offset:6144
    s_waitcnt lgkmcnt(8)
    v_mfma_f32_16x16x32_bf16 v[24:27], v[152:155], v[112:115], 0
    ds_read_b64_tr_b16 v[148:149], v162 offset:14336
    v_mfma_f32_16x16x32_bf16 v[52:55], v[152:155], v[116:119], 0
    ds_read_b64_tr_b16 v[150:151], v162 offset:16128
    v_mfma_f32_16x16x32_bf16 v[80:83], v[152:155], v[120:123], 0
    v_mfma_f32_16x16x32_bf16 v[108:111], v[152:155], v[124:127], 0
    s_waitcnt lgkmcnt(2)
    v_mfma_f32_16x16x32_bf16 v[0:3], v[156:159], v[128:131], v[0:3]
    ds_read_b64_tr_b16 v[152:153], v163 offset:14336
    s_waitcnt vmcnt(0)
    v_mfma_f32_16x16x32_bf16 v[28:31], v[156:159], v[132:135], v[28:31]
    ds_read_b64_tr_b16 v[154:155], v163 offset:16128
    v_lshlrev_b32 v188, 16, v176
    v_mfma_f32_16x16x32_bf16 v[56:59], v[156:159], v[136:139], v[56:59]
    v_and_b32 v189, s97, v176
    v_lshlrev_b32 v190, 16, v177
    v_mfma_f32_16x16x32_bf16 v[84:87], v[156:159], v[140:143], v[84:87]
    v_and_b32 v191, s97, v177
    v_lshlrev_b32 v192, 16, v178
    v_mfma_f32_16x16x32_bf16 v[88:91], v[144:147], v[140:143], v[88:91]
    ds_read_b64_tr_b16 v[156:157], v164 offset:14336
    v_and_b32 v193, s97, v178
    v_mfma_f32_16x16x32_bf16 v[60:63], v[144:147], v[136:139], v[60:63]
    ds_read_b64_tr_b16 v[158:159], v164 offset:16128
    v_lshlrev_b32 v194, 16, v179
    v_mfma_f32_16x16x32_bf16 v[32:35], v[144:147], v[132:135], v[32:35]
    v_and_b32 v195, s97, v179
    v_lshlrev_b32 v196, 16, v180
    v_mfma_f32_16x16x32_bf16 v[4:7], v[144:147], v[128:131], v[4:7]
    v_and_b32 v197, s97, v180
    v_lshlrev_b32 v198, 16, v181
    s_waitcnt lgkmcnt(4)
    v_mfma_f32_16x16x32_bf16 v[8:11], v[148:151], v[128:131], v[8:11]
    ds_read_b64_tr_b16 v[144:145], v165 offset:14336
    v_and_b32 v199, s97, v181
    v_mfma_f32_16x16x32_bf16 v[36:39], v[148:151], v[132:135], v[36:39]
    ds_read_b64_tr_b16 v[146:147], v165 offset:16128
    v_lshlrev_b32 v200, 16, v182
    v_mfma_f32_16x16x32_bf16 v[64:67], v[148:151], v[136:139], v[64:67]
    v_and_b32 v201, s97, v182
    v_lshlrev_b32 v202, 16, v183
    v_mfma_f32_16x16x32_bf16 v[92:95], v[148:151], v[140:143], v[92:95]
    v_and_b32 v203, s97, v183
    v_lshlrev_b32 v204, 16, v184
    s_waitcnt lgkmcnt(4)
    v_mfma_f32_16x16x32_bf16 v[96:99], v[152:155], v[140:143], v[96:99]
    ds_read_b64_tr_b16 v[148:149], v166 offset:14336
    v_and_b32 v205, s97, v184
    v_mfma_f32_16x16x32_bf16 v[68:71], v[152:155], v[136:139], v[68:71]
    ds_read_b64_tr_b16 v[150:151], v166 offset:16128
    v_lshlrev_b32 v206, 16, v185
    v_mfma_f32_16x16x32_bf16 v[40:43], v[152:155], v[132:135], v[40:43]
    v_and_b32 v207, s97, v185
    v_add_f32 v208, v188, v192
    v_mfma_f32_16x16x32_bf16 v[12:15], v[152:155], v[128:131], v[12:15]
    v_add_f32 v209, v189, v193
    v_add_f32 v210, v190, v194
    s_waitcnt lgkmcnt(4)
    v_mfma_f32_16x16x32_bf16 v[16:19], v[156:159], v[128:131], v[16:19]
    s_barrier
    ds_read_b64_tr_b16 v[152:153], v160 offset:28672
    v_add_f32 v211, v191, v195
    v_mfma_f32_16x16x32_bf16 v[44:47], v[156:159], v[132:135], v[44:47]
    ds_read_b64_tr_b16 v[154:155], v160 offset:30464
    v_add_f32 v208, v208, v196
    v_mfma_f32_16x16x32_bf16 v[72:75], v[156:159], v[136:139], v[72:75]
    ds_read_b128 v[112:115], v240 offset:16384
    v_add_f32 v209, v209, v197
    v_mfma_f32_16x16x32_bf16 v[100:103], v[156:159], v[140:143], v[100:103]
    ds_read_b128 v[116:119], v240 offset:18432
    v_add_f32 v210, v210, v198
    s_waitcnt lgkmcnt(6)
    v_mfma_f32_16x16x32_bf16 v[104:107], v[144:147], v[140:143], v[104:107]
    ds_read_b64_tr_b16 v[156:157], v161 offset:28672
    v_add_f32 v211, v211, v199
    v_mfma_f32_16x16x32_bf16 v[76:79], v[144:147], v[136:139], v[76:79]
    ds_read_b64_tr_b16 v[158:159], v161 offset:30464
    v_add_f32 v208, v208, v200
    v_mfma_f32_16x16x32_bf16 v[48:51], v[144:147], v[132:135], v[48:51]
    ds_read_b128 v[120:123], v240 offset:20480
    v_add_f32 v209, v209, v201
    v_mfma_f32_16x16x32_bf16 v[20:23], v[144:147], v[128:131], v[20:23]
    ds_read_b128 v[124:127], v240 offset:22528
    v_add_f32 v210, v210, v202
    s_waitcnt lgkmcnt(8)
    v_mfma_f32_16x16x32_bf16 v[24:27], v[148:151], v[128:131], v[24:27]
    ds_read_b64_tr_b16 v[144:145], v162 offset:28672
    v_add_f32 v211, v211, v203
    v_mfma_f32_16x16x32_bf16 v[52:55], v[148:151], v[132:135], v[52:55]
    ds_read_b64_tr_b16 v[146:147], v162 offset:30464
    v_add_f32 v208, v208, v204
    v_mfma_f32_16x16x32_bf16 v[80:83], v[148:151], v[136:139], v[80:83]
    v_add_f32 v209, v209, v205
    v_add_f32 v210, v210, v206
    v_mfma_f32_16x16x32_bf16 v[108:111], v[148:151], v[140:143], v[108:111]
    v_add_f32 v211, v211, v207
    v_add_f32 v208, v208, v209
    s_waitcnt lgkmcnt(2)
    v_mfma_f32_16x16x32_bf16 v[0:3], v[152:155], v[112:115], v[0:3]
    ds_read_b64_tr_b16 v[148:149], v163 offset:28672
    v_add_f32 v210, v210, v211
    v_mfma_f32_16x16x32_bf16 v[28:31], v[152:155], v[116:119], v[28:31]
    ds_read_b64_tr_b16 v[150:151], v163 offset:30464
    v_add_f32 v208, v208, v210
    v_mfma_f32_16x16x32_bf16 v[56:59], v[152:155], v[120:123], v[56:59]
    s_nop 0
    v_add_f32_dpp v208, v208, v208 quad_perm:[1,0,3,2] row_mask:0xf bank_mask:0xf
    v_mfma_f32_16x16x32_bf16 v[84:87], v[152:155], v[124:127], v[84:87]
    s_nop 0
    v_add_f32_dpp v208, v208, v208 quad_perm:[2,3,0,1] row_mask:0xf bank_mask:0xf
    v_mfma_f32_16x16x32_bf16 v[88:91], v[156:159], v[124:127], v[88:91]
    ds_read_b64_tr_b16 v[152:153], v164 offset:28672
    v_mfma_f32_16x16x32_bf16 v[60:63], v[156:159], v[120:123], v[60:63]
    ds_read_b64_tr_b16 v[154:155], v164 offset:30464
    v_add_f32_dpp v208, v208, v208 row_half_mirror row_mask:0xf bank_mask:0xf
    v_mfma_f32_16x16x32_bf16 v[32:35], v[156:159], v[116:119], v[32:35]
    s_nop 0
    v_add_f32_dpp v208, v208, v208 row_mirror row_mask:0xf bank_mask:0xf
    v_mfma_f32_16x16x32_bf16 v[4:7], v[156:159], v[112:115], v[4:7]
    v_mov_b32 v209, v208
    s_waitcnt lgkmcnt(4)
    v_mfma_f32_16x16x32_bf16 v[8:11], v[144:147], v[112:115], v[8:11]
    ds_read_b64_tr_b16 v[156:157], v165 offset:28672
    v_mfma_f32_16x16x32_bf16 v[36:39], v[144:147], v[116:119], v[36:39]
    ds_read_b64_tr_b16 v[158:159], v165 offset:30464
    v_permlane16_swap_b32 v208, v209
    v_mfma_f32_16x16x32_bf16 v[64:67], v[144:147], v[120:123], v[64:67]
    v_add_f32 v208, v208, v209
    v_mfma_f32_16x16x32_bf16 v[92:95], v[144:147], v[124:127], v[92:95]
    v_mul_f32 v208, 0xbacccccd, v208
    s_waitcnt lgkmcnt(4)
    v_mfma_f32_16x16x32_bf16 v[96:99], v[148:151], v[124:127], v[96:99]
    ds_read_b64_tr_b16 v[144:145], v166 offset:28672
    v_add_f32 v188, v188, v208
    v_mfma_f32_16x16x32_bf16 v[68:71], v[148:151], v[120:123], v[68:71]
    ds_read_b64_tr_b16 v[146:147], v166 offset:30464
    v_add_f32 v189, v189, v208
    v_mfma_f32_16x16x32_bf16 v[40:43], v[148:151], v[116:119], v[40:43]
    v_add_f32 v190, v190, v208
    v_add_f32 v191, v191, v208
    v_mfma_f32_16x16x32_bf16 v[12:15], v[148:151], v[112:115], v[12:15]
    v_add_f32 v192, v192, v208
    v_add_f32 v193, v193, v208
    s_waitcnt lgkmcnt(4)
    v_mfma_f32_16x16x32_bf16 v[16:19], v[152:155], v[112:115], v[16:19]
    s_barrier
    ds_read_b64_tr_b16 v[148:149], v242 offset:0
    v_add_f32 v194, v194, v208
    v_mfma_f32_16x16x32_bf16 v[44:47], v[152:155], v[116:119], v[44:47]
    ds_read_b64_tr_b16 v[150:151], v242 offset:1792
    v_add_f32 v195, v195, v208
    v_mfma_f32_16x16x32_bf16 v[72:75], v[152:155], v[120:123], v[72:75]
    ds_read_b128 v[128:131], v241 offset:16384
    v_add_f32 v196, v196, v208
    v_mfma_f32_16x16x32_bf16 v[100:103], v[152:155], v[124:127], v[100:103]
    ds_read_b128 v[132:135], v241 offset:18432
    v_add_f32 v197, v197, v208
    s_waitcnt lgkmcnt(6)
    v_mfma_f32_16x16x32_bf16 v[104:107], v[156:159], v[124:127], v[104:107]
    ds_read_b64_tr_b16 v[152:153], v243 offset:0
    v_add_f32 v198, v198, v208
    v_mfma_f32_16x16x32_bf16 v[76:79], v[156:159], v[120:123], v[76:79]
    ds_read_b64_tr_b16 v[154:155], v243 offset:1792
    v_add_f32 v199, v199, v208
    v_mfma_f32_16x16x32_bf16 v[48:51], v[156:159], v[116:119], v[48:51]
    ds_read_b128 v[136:139], v241 offset:20480
    v_add_f32 v200, v200, v208
    v_mfma_f32_16x16x32_bf16 v[20:23], v[156:159], v[112:115], v[20:23]
    ds_read_b128 v[140:143], v241 offset:22528
    v_add_f32 v201, v201, v208
    s_waitcnt lgkmcnt(8)
    v_mfma_f32_16x16x32_bf16 v[24:27], v[144:147], v[112:115], v[24:27]
    ds_read_b64_tr_b16 v[156:157], v244 offset:0
    v_add_f32 v202, v202, v208
    v_mfma_f32_16x16x32_bf16 v[52:55], v[144:147], v[116:119], v[52:55]
    ds_read_b64_tr_b16 v[158:159], v244 offset:1792
    v_add_f32 v203, v203, v208
    v_mfma_f32_16x16x32_bf16 v[80:83], v[144:147], v[120:123], v[80:83]
    v_add_f32 v204, v204, v208
    v_add_f32 v205, v205, v208
    v_mfma_f32_16x16x32_bf16 v[108:111], v[144:147], v[124:127], v[108:111]
    v_add_f32 v206, v206, v208
    v_add_f32 v207, v207, v208
    s_waitcnt lgkmcnt(2)
    v_mfma_f32_16x16x32_bf16 v[0:3], v[148:151], v[128:131], v[0:3]
    ds_read_b64_tr_b16 v[144:145], v245 offset:0
    v_mul_f32 v176, v188, v188
    v_mfma_f32_16x16x32_bf16 v[28:31], v[148:151], v[132:135], v[28:31]
    ds_read_b64_tr_b16 v[146:147], v245 offset:1792
    v_mul_f32 v177, v189, v189
    v_mfma_f32_16x16x32_bf16 v[56:59], v[148:151], v[136:139], v[56:59]
    v_mul_f32 v178, v190, v190
    v_mul_f32 v179, v191, v191
    v_mfma_f32_16x16x32_bf16 v[84:87], v[148:151], v[140:143], v[84:87]
    v_fmac_f32 v176, v192, v192
    v_fmac_f32 v177, v193, v193
    v_mfma_f32_16x16x32_bf16 v[88:91], v[152:155], v[140:143], v[88:91]
    ds_read_b64_tr_b16 v[148:149], v246 offset:0
    v_fmac_f32 v178, v194, v194
    v_mfma_f32_16x16x32_bf16 v[60:63], v[152:155], v[136:139], v[60:63]
    ds_read_b64_tr_b16 v[150:151], v246 offset:1792
    v_fmac_f32 v179, v195, v195
    v_mfma_f32_16x16x32_bf16 v[32:35], v[152:155], v[132:135], v[32:35]
    v_fmac_f32 v176, v196, v196
    v_fmac_f32 v177, v197, v197
    v_mfma_f32_16x16x32_bf16 v[4:7], v[152:155], v[128:131], v[4:7]
    v_fmac_f32 v178, v198, v198
    v_fmac_f32 v179, v199, v199
    s_waitcnt lgkmcnt(4)
    v_mfma_f32_16x16x32_bf16 v[8:11], v[156:159], v[128:131], v[8:11]
    ds_read_b64_tr_b16 v[152:153], v247 offset:0
    v_fmac_f32 v176, v200, v200
    v_mfma_f32_16x16x32_bf16 v[36:39], v[156:159], v[132:135], v[36:39]
    ds_read_b64_tr_b16 v[154:155], v247 offset:1792
    v_fmac_f32 v177, v201, v201
    v_mfma_f32_16x16x32_bf16 v[64:67], v[156:159], v[136:139], v[64:67]
    v_fmac_f32 v178, v202, v202
    v_fmac_f32 v179, v203, v203
    v_mfma_f32_16x16x32_bf16 v[92:95], v[156:159], v[140:143], v[92:95]
    v_fmac_f32 v176, v204, v204
    v_fmac_f32 v177, v205, v205
    s_waitcnt lgkmcnt(4)
    v_mfma_f32_16x16x32_bf16 v[96:99], v[144:147], v[140:143], v[96:99]
    ds_read_b64_tr_b16 v[156:157], v248 offset:0
    v_fmac_f32 v178, v206, v206
    v_mfma_f32_16x16x32_bf16 v[68:71], v[144:147], v[136:139], v[68:71]
    ds_read_b64_tr_b16 v[158:159], v248 offset:1792
    v_fmac_f32 v179, v207, v207
    v_mfma_f32_16x16x32_bf16 v[40:43], v[144:147], v[132:135], v[40:43]
    v_add_f32 v176, v176, v177
    v_add_f32 v178, v178, v179
    v_mfma_f32_16x16x32_bf16 v[12:15], v[144:147], v[128:131], v[12:15]
    v_add_f32 v210, v176, v178
    s_waitcnt lgkmcnt(4)
    v_mfma_f32_16x16x32_bf16 v[16:19], v[148:151], v[128:131], v[16:19]
    s_barrier
    ds_read_b64_tr_b16 v[144:145], v242 offset:14336
    v_add_f32_dpp v210, v210, v210 quad_perm:[1,0,3,2] row_mask:0xf bank_mask:0xf
    v_mfma_f32_16x16x32_bf16 v[44:47], v[148:151], v[132:135], v[44:47]
    ds_read_b64_tr_b16 v[146:147], v242 offset:16128
    v_mfma_f32_16x16x32_bf16 v[72:75], v[148:151], v[136:139], v[72:75]
    ds_read_b128 v[112:115], v240 offset:32768
    v_add_f32_dpp v210, v210, v210 quad_perm:[2,3,0,1] row_mask:0xf bank_mask:0xf
    v_mfma_f32_16x16x32_bf16 v[100:103], v[148:151], v[140:143], v[100:103]
    ds_read_b128 v[116:119], v240 offset:34816
    s_waitcnt lgkmcnt(6)
    v_mfma_f32_16x16x32_bf16 v[104:107], v[152:155], v[140:143], v[104:107]
    ds_read_b64_tr_b16 v[148:149], v243 offset:14336
    v_add_f32_dpp v210, v210, v210 row_half_mirror row_mask:0xf bank_mask:0xf
    v_mfma_f32_16x16x32_bf16 v[76:79], v[152:155], v[136:139], v[76:79]
    ds_read_b64_tr_b16 v[150:151], v243 offset:16128
    v_mfma_f32_16x16x32_bf16 v[48:51], v[152:155], v[132:135], v[48:51]
    ds_read_b128 v[120:123], v240 offset:36864
    v_add_f32_dpp v210, v210, v210 row_mirror row_mask:0xf bank_mask:0xf
    v_mfma_f32_16x16x32_bf16 v[20:23], v[152:155], v[128:131], v[20:23]
    ds_read_b128 v[124:127], v240 offset:38912
    s_waitcnt lgkmcnt(8)
    v_mfma_f32_16x16x32_bf16 v[24:27], v[156:159], v[128:131], v[24:27]
    ds_read_b64_tr_b16 v[152:153], v244 offset:14336
    v_mov_b32 v211, v210
    v_mfma_f32_16x16x32_bf16 v[52:55], v[156:159], v[132:135], v[52:55]
    ds_read_b64_tr_b16 v[154:155], v244 offset:16128
    v_mfma_f32_16x16x32_bf16 v[80:83], v[156:159], v[136:139], v[80:83]
    v_permlane16_swap_b32 v210, v211
    v_mfma_f32_16x16x32_bf16 v[108:111], v[156:159], v[140:143], v[108:111]
    v_add_f32 v210, v210, v211
    s_waitcnt lgkmcnt(2)
    v_mfma_f32_16x16x32_bf16 v[0:3], v[144:147], v[112:115], v[0:3]
    ds_read_b64_tr_b16 v[156:157], v245 offset:14336
    v_mul_f32 v210, 0x3acccccd, v210
    v_mfma_f32_16x16x32_bf16 v[28:31], v[144:147], v[116:119], v[28:31]
    ds_read_b64_tr_b16 v[158:159], v245 offset:16128
    v_cvt_pk_bf16_f32 v210, v210, v210
    v_mfma_f32_16x16x32_bf16 v[56:59], v[144:147], v[120:123], v[56:59]
    v_and_b32 v210, s97, v210
    v_add_f32 v210, 0x3727c5ac, v210
    v_mfma_f32_16x16x32_bf16 v[84:87], v[144:147], v[124:127], v[84:87]
    v_cvt_pk_bf16_f32 v210, v210, v210
    v_and_b32 v210, s97, v210
    v_mfma_f32_16x16x32_bf16 v[88:91], v[148:151], v[124:127], v[88:91]
    ds_read_b64_tr_b16 v[144:145], v246 offset:14336
    v_sqrt_f32 v210, v210
    v_mfma_f32_16x16x32_bf16 v[60:63], v[148:151], v[120:123], v[60:63]
    ds_read_b64_tr_b16 v[146:147], v246 offset:16128
    v_mfma_f32_16x16x32_bf16 v[32:35], v[148:151], v[116:119], v[32:35]
    v_cvt_pk_bf16_f32 v208, v208, v210
    v_mov_b32 v209, s101
    v_mfma_f32_16x16x32_bf16 v[4:7], v[148:151], v[112:115], v[4:7]
    s_lshl_b32 s60, s26, 4
    s_add_u32 s60, s60, 163584
    s_waitcnt lgkmcnt(4)
    v_mfma_f32_16x16x32_bf16 v[8:11], v[152:155], v[112:115], v[8:11]
    ds_read_b64_tr_b16 v[148:149], v247 offset:14336
    v_lshrrev_b32 v210, 5, v255
    v_mfma_f32_16x16x32_bf16 v[36:39], v[152:155], v[116:119], v[36:39]
    ds_read_b64_tr_b16 v[150:151], v247 offset:16128
    v_lshl_add_u32 v210, v210, 3, s60
    v_mfma_f32_16x16x32_bf16 v[64:67], v[152:155], v[120:123], v[64:67]
    ds_write_b64 v210, v[208:209]
    s_and_b32 s60, s49, 7
    v_mfma_f32_16x16x32_bf16 v[92:95], v[152:155], v[124:127], v[92:95]
    s_mul_i32 s56, s60, 7
    s_lshl_b32 s60, s60, 1
    s_waitcnt lgkmcnt(5)
    v_mfma_f32_16x16x32_bf16 v[96:99], v[156:159], v[124:127], v[96:99]
    ds_read_b64_tr_b16 v[152:153], v248 offset:14336
    s_add_u32 s60, s60, 43
    v_mfma_f32_16x16x32_bf16 v[68:71], v[156:159], v[120:123], v[68:71]
    ds_read_b64_tr_b16 v[154:155], v248 offset:16128
    s_cmp_eq_u32 s50, 0
    v_mfma_f32_16x16x32_bf16 v[40:43], v[156:159], v[116:119], v[40:43]
    s_cselect_b32 s56, s60, s56
    s_cmp_eq_u32 s50, 2
    v_mfma_f32_16x16x32_bf16 v[12:15], v[156:159], v[112:115], v[12:15]
    s_cselect_b32 s56, 64, s56
    s_add_u32 s60, s27, 0
    s_waitcnt lgkmcnt(5)
    v_mfma_f32_16x16x32_bf16 v[16:19], v[144:147], v[112:115], v[16:19]
    s_barrier
    ds_read_b64_tr_b16 v[156:157], v242 offset:28672
    s_and_b32 s60, s60, 3
    v_mfma_f32_16x16x32_bf16 v[44:47], v[144:147], v[116:119], v[44:47]
    ds_read_b64_tr_b16 v[158:159], v242 offset:30464
    s_lshl_b32 s61, s58, 2
    v_mfma_f32_16x16x32_bf16 v[72:75], v[144:147], v[120:123], v[72:75]
    ds_read_b128 v[128:131], v241 offset:32768
    s_add_u32 s60, s60, s61
    v_mfma_f32_16x16x32_bf16 v[100:103], v[144:147], v[124:127], v[100:103]
    ds_read_b128 v[132:135], v241 offset:34816
    s_mul_i32 s88, s60, 69632
    s_waitcnt lgkmcnt(7)
    v_mfma_f32_16x16x32_bf16 v[104:107], v[148:151], v[124:127], v[104:107]
    ds_read_b64_tr_b16 v[144:145], v243 offset:28672
    s_mul_i32 s98, s60, 20480
    v_mfma_f32_16x16x32_bf16 v[76:79], v[148:151], v[120:123], v[76:79]
    ds_read_b64_tr_b16 v[146:147], v243 offset:30464
    s_mul_i32 s99, s59, 160
    v_mfma_f32_16x16x32_bf16 v[48:51], v[148:151], v[116:119], v[48:51]
    ds_read_b128 v[136:139], v241 offset:36864
    s_add_u32 s98, s98, s99
    v_mfma_f32_16x16x32_bf16 v[20:23], v[148:151], v[112:115], v[20:23]
    ds_read_b128 v[140:143], v241 offset:38912
    s_add_u32 s60, s27, 1
    s_waitcnt lgkmcnt(8)
    v_mfma_f32_16x16x32_bf16 v[24:27], v[152:155], v[112:115], v[24:27]
    ds_read_b64_tr_b16 v[148:149], v244 offset:28672
    s_and_b32 s60, s60, 3
    v_mfma_f32_16x16x32_bf16 v[52:55], v[152:155], v[116:119], v[52:55]
    ds_read_b64_tr_b16 v[150:151], v244 offset:30464
    s_lshl_b32 s61, s58, 2
    v_mfma_f32_16x16x32_bf16 v[80:83], v[152:155], v[120:123], v[80:83]
    s_add_u32 s60, s60, s61
    s_mul_i32 s89, s60, 69632
    v_mfma_f32_16x16x32_bf16 v[108:111], v[152:155], v[124:127], v[108:111]
    s_add_u32 s60, s27, 2
    s_and_b32 s60, s60, 3
    s_waitcnt lgkmcnt(2)
    v_mfma_f32_16x16x32_bf16 v[0:3], v[156:159], v[128:131], v[0:3]
    ds_read_b64_tr_b16 v[152:153], v245 offset:28672
    s_lshl_b32 s61, s58, 2
    v_mfma_f32_16x16x32_bf16 v[28:31], v[156:159], v[132:135], v[28:31]
    ds_read_b64_tr_b16 v[154:155], v245 offset:30464
    s_add_u32 s60, s60, s61
    v_mfma_f32_16x16x32_bf16 v[56:59], v[156:159], v[136:139], v[56:59]
    s_mul_i32 s90, s60, 69632
    s_add_u32 s60, s27, 3
    v_mfma_f32_16x16x32_bf16 v[84:87], v[156:159], v[140:143], v[84:87]
    s_and_b32 s60, s60, 3
    s_lshl_b32 s61, s58, 2
    v_mfma_f32_16x16x32_bf16 v[88:91], v[144:147], v[140:143], v[88:91]
    ds_read_b64_tr_b16 v[156:157], v246 offset:28672
    s_add_u32 s60, s60, s61
    v_mfma_f32_16x16x32_bf16 v[60:63], v[144:147], v[136:139], v[60:63]
    ds_read_b64_tr_b16 v[158:159], v246 offset:30464
    s_mul_i32 s91, s60, 69632
    v_mfma_f32_16x16x32_bf16 v[32:35], v[144:147], v[132:135], v[32:35]
    s_lshl_b32 s80, s58, 3
    s_add_u32 s80, s80, s59
    v_mfma_f32_16x16x32_bf16 v[4:7], v[144:147], v[128:131], v[4:7]
    s_lshl_b32 s80, s80, 8
    s_add_u32 s80, s80, 12900480
    s_waitcnt lgkmcnt(4)
    v_mfma_f32_16x16x32_bf16 v[8:11], v[148:151], v[128:131], v[8:11]
    ds_read_b64_tr_b16 v[144:145], v247 offset:28672
    s_lshl_b32 s81, s26, 2
    v_mfma_f32_16x16x32_bf16 v[36:39], v[148:151], v[132:135], v[36:39]
    ds_read_b64_tr_b16 v[146:147], v247 offset:30464
    s_add_u32 s81, s81, s80
    v_mfma_f32_16x16x32_bf16 v[64:67], v[148:151], v[136:139], v[64:67]
    s_add_u32 s81, s81, 64
    s_lshl_b32 s60, s58, 11
    v_mfma_f32_16x16x32_bf16 v[92:95], v[148:151], v[140:143], v[92:95]
    s_lshr_b32 s61, s59, 1
    s_lshl_b32 s61, s61, 2
    s_waitcnt lgkmcnt(4)
    v_mfma_f32_16x16x32_bf16 v[96:99], v[152:155], v[140:143], v[96:99]
    ds_read_b64_tr_b16 v[148:149], v248 offset:28672
    s_add_u32 s60, s60, s61
    v_mfma_f32_16x16x32_bf16 v[68:71], v[152:155], v[136:139], v[68:71]
    ds_read_b64_tr_b16 v[150:151], v248 offset:30464
    s_add_u32 s60, s60, 12900544
    v_mfma_f32_16x16x32_bf16 v[40:43], v[152:155], v[132:135], v[40:43]
    s_add_u32 s82, s24, s60
    s_addc_u32 s83, s25, 0
    v_mfma_f32_16x16x32_bf16 v[12:15], v[152:155], v[128:131], v[12:15]
    s_sub_u32 s62, s27, 1
    s_and_b32 s62, s62, 3
    s_waitcnt lgkmcnt(4)
    v_mfma_f32_16x16x32_bf16 v[16:19], v[156:159], v[128:131], v[16:19]
    s_barrier
    ds_read_b64_tr_b16 v[152:153], v160 offset:0
    s_sub_u32 s33, s62, 1
    v_mfma_f32_16x16x32_bf16 v[44:47], v[156:159], v[132:135], v[44:47]
    ds_read_b64_tr_b16 v[154:155], v160 offset:1792
    s_mul_i32 s33, s33, 30720
    v_mfma_f32_16x16x32_bf16 v[72:75], v[156:159], v[136:139], v[72:75]
    ds_read_b128 v[112:115], v240 offset:0
    s_add_u32 s33, s33, 62976
    v_mfma_f32_16x16x32_bf16 v[100:103], v[156:159], v[140:143], v[100:103]
    ds_read_b128 v[116:119], v240 offset:2048
    s_cmp_eq_u32 s62, 0
    s_waitcnt lgkmcnt(6)
    v_mfma_f32_16x16x32_bf16 v[104:107], v[144:147], v[140:143], v[104:107]
    ds_read_b64_tr_b16 v[156:157], v161 offset:0
    s_cselect_b32 s33, 0, s33
    v_mfma_f32_16x16x32_bf16 v[76:79], v[144:147], v[136:139], v[76:79]
    ds_read_b64_tr_b16 v[158:159], v161 offset:1792
    s_sub_u32 s62, s27, 2
    v_mfma_f32_16x16x32_bf16 v[48:51], v[144:147], v[132:135], v[48:51]
    ds_read_b128 v[120:123], v240 offset:4096
    s_and_b32 s62, s62, 3
    v_mfma_f32_16x16x32_bf16 v[20:23], v[144:147], v[128:131], v[20:23]
    ds_read_b128 v[124:127], v240 offset:6144
    s_sub_u32 s34, s62, 1
    s_waitcnt lgkmcnt(8)
    v_mfma_f32_16x16x32_bf16 v[24:27], v[148:151], v[128:131], v[24:27]
    ds_read_b64_tr_b16 v[144:145], v162 offset:0
    s_mul_i32 s34, s34, 30720
    v_mfma_f32_16x16x32_bf16 v[52:55], v[148:151], v[132:135], v[52:55]
    ds_read_b64_tr_b16 v[146:147], v162 offset:1792
    s_add_u32 s34, s34, 62976
    v_mfma_f32_16x16x32_bf16 v[80:83], v[148:151], v[136:139], v[80:83]
    s_cmp_eq_u32 s62, 0
    s_cselect_b32 s34, 0, s34
    v_mfma_f32_16x16x32_bf16 v[108:111], v[148:151], v[140:143], v[108:111]
    s_sub_u32 s62, s27, 3
    s_and_b32 s62, s62, 3
    s_waitcnt lgkmcnt(2)
    v_mfma_f32_16x16x32_bf16 v[0:3], v[152:155], v[112:115], v[0:3]
    ds_read_b64_tr_b16 v[148:149], v163 offset:0
    s_sub_u32 s35, s62, 1
    v_mfma_f32_16x16x32_bf16 v[28:31], v[152:155], v[116:119], v[28:31]
    ds_read_b64_tr_b16 v[150:151], v163 offset:1792
    s_mul_i32 s35, s35, 30720
    v_mfma_f32_16x16x32_bf16 v[56:59], v[152:155], v[120:123], v[56:59]
    s_add_u32 s35, s35, 62976
    s_cmp_eq_u32 s62, 0
    v_mfma_f32_16x16x32_bf16 v[84:87], v[152:155], v[124:127], v[84:87]
    s_cselect_b32 s35, 0, s35
    s_mul_i32 s32, s27, 5120
    v_mfma_f32_16x16x32_bf16 v[88:91], v[156:159], v[124:127], v[88:91]
    ds_read_b64_tr_b16 v[152:153], v164 offset:0
    s_add_u32 s32, s32, 30720
    v_mfma_f32_16x16x32_bf16 v[60:63], v[156:159], v[120:123], v[60:63]
    ds_read_b64_tr_b16 v[154:155], v164 offset:1792
    s_sub_u32 s84, s27, 1
    v_mfma_f32_16x16x32_bf16 v[32:35], v[156:159], v[116:119], v[32:35]
    s_mul_i32 s84, s84, 30720
    s_add_u32 s84, s84, 62976
    v_mfma_f32_16x16x32_bf16 v[4:7], v[156:159], v[112:115], v[4:7]
    s_cmp_eq_u32 s27, 0
    s_cselect_b32 s84, 0, s84
    s_waitcnt lgkmcnt(4)
    v_mfma_f32_16x16x32_bf16 v[8:11], v[144:147], v[112:115], v[8:11]
    ds_read_b64_tr_b16 v[156:157], v165 offset:0
    s_mov_b32 s40, s18
    v_mfma_f32_16x16x32_bf16 v[36:39], v[144:147], v[116:119], v[36:39]
    ds_read_b64_tr_b16 v[158:159], v165 offset:1792
    s_mov_b32 s41, s19
    v_mfma_f32_16x16x32_bf16 v[64:67], v[144:147], v[120:123], v[64:67]
    s_mov_b32 s42, 0x500
    s_mov_b32 s43, 0x20000
    v_mfma_f32_16x16x32_bf16 v[92:95], v[144:147], v[124:127], v[92:95]
    s_mov_b32 s44, s20
    s_mov_b32 s45, s21
    s_waitcnt lgkmcnt(4)
    v_mfma_f32_16x16x32_bf16 v[96:99], v[148:151], v[124:127], v[96:99]
    ds_read_b64_tr_b16 v[144:145], v166 offset:0
    s_mov_b32 s46, 0x280000
    v_mfma_f32_16x16x32_bf16 v[68:71], v[148:151], v[120:123], v[68:71]
    ds_read_b64_tr_b16 v[146:147], v166 offset:1792
    s_mov_b32 s47, 0x20000
    v_mfma_f32_16x16x32_bf16 v[40:43], v[148:151], v[116:119], v[40:43]
    s_mul_i32 s60, s59, 5
    s_lshr_b32 s60, s60, 1
    v_mfma_f32_16x16x32_bf16 v[12:15], v[148:151], v[112:115], v[12:15]
    s_add_u32 s60, s60, 48
    s_lshl_b32 s60, s60, 10
    s_waitcnt lgkmcnt(4)
    v_mfma_f32_16x16x32_bf16 v[16:19], v[152:155], v[112:115], v[16:19]
    s_barrier
    ds_read_b64_tr_b16 v[148:149], v160 offset:14336
    s_add_u32 s4, s60, s88
    v_mfma_f32_16x16x32_bf16 v[44:47], v[152:155], v[116:119], v[44:47]
    ds_read_b64_tr_b16 v[150:151], v160 offset:16128
    s_lshl_b32 s14, s59, 2
    v_mfma_f32_16x16x32_bf16 v[72:75], v[152:155], v[120:123], v[72:75]
    ds_read_b128 v[128:131], v241 offset:0
    s_add_u32 s14, s14, s26
    v_mfma_f32_16x16x32_bf16 v[100:103], v[152:155], v[124:127], v[100:103]
    ds_read_b128 v[132:135], v241 offset:2048
    s_mul_i32 s14, s14, 1728
    s_waitcnt lgkmcnt(6)
    v_mfma_f32_16x16x32_bf16 v[104:107], v[156:159], v[124:127], v[104:107]
    ds_read_b64_tr_b16 v[152:153], v161 offset:14336
    s_add_u32 s14, s14, 12845056
    v_mfma_f32_16x16x32_bf16 v[76:79], v[156:159], v[120:123], v[76:79]
    ds_read_b64_tr_b16 v[154:155], v161 offset:16128
    s_add_u32 s60, s27, 0
    v_mfma_f32_16x16x32_bf16 v[48:51], v[156:159], v[116:119], v[48:51]
    ds_read_b128 v[136:139], v241 offset:4096
    s_and_b32 s60, s60, 3
    v_mfma_f32_16x16x32_bf16 v[20:23], v[156:159], v[112:115], v[20:23]
    ds_read_b128 v[140:143], v241 offset:6144
    s_lshl_b32 s61, s58, 2
    s_waitcnt lgkmcnt(8)
    v_mfma_f32_16x16x32_bf16 v[24:27], v[144:147], v[112:115], v[24:27]
    ds_read_b64_tr_b16 v[156:157], v162 offset:14336
    s_add_u32 s60, s60, s61
    v_mfma_f32_16x16x32_bf16 v[52:55], v[144:147], v[116:119], v[52:55]
    ds_read_b64_tr_b16 v[158:159], v162 offset:16128
    s_mul_i32 s60, s60, 20480
    v_mfma_f32_16x16x32_bf16 v[80:83], v[144:147], v[120:123], v[80:83]
    s_add_u32 s60, s60, 13631488
    s_mul_i32 s15, s59, 2560
    v_mfma_f32_16x16x32_bf16 v[108:111], v[144:147], v[124:127], v[108:111]
    s_add_u32 s15, s15, s60
    s_mul_i32 s61, s26, 5120
    s_waitcnt lgkmcnt(2)
    v_mfma_f32_16x16x32_bf16 v[0:3], v[148:151], v[128:131], v[0:3]
    ds_read_b64_tr_b16 v[144:145], v163 offset:14336
    s_add_u32 s88, s60, s61
    v_mfma_f32_16x16x32_bf16 v[28:31], v[148:151], v[132:135], v[28:31]
    ds_read_b64_tr_b16 v[146:147], v163 offset:16128
    s_add_u32 s60, s27, 1
    v_mfma_f32_16x16x32_bf16 v[56:59], v[148:151], v[136:139], v[56:59]
    s_and_b32 s60, s60, 3
    s_lshl_b32 s61, s58, 2
    v_mfma_f32_16x16x32_bf16 v[84:87], v[148:151], v[140:143], v[84:87]
    s_add_u32 s60, s60, s61
    s_mul_i32 s60, s60, 20480
    v_mfma_f32_16x16x32_bf16 v[88:91], v[152:155], v[140:143], v[88:91]
    ds_read_b64_tr_b16 v[148:149], v164 offset:14336
    s_add_u32 s60, s60, 13631488
    v_mfma_f32_16x16x32_bf16 v[60:63], v[152:155], v[136:139], v[60:63]
    ds_read_b64_tr_b16 v[150:151], v164 offset:16128
    s_mul_i32 s61, s26, 5120
    v_mfma_f32_16x16x32_bf16 v[32:35], v[152:155], v[132:135], v[32:35]
    s_add_u32 s89, s60, s61
    s_add_u32 s60, s27, 2
    v_mfma_f32_16x16x32_bf16 v[4:7], v[152:155], v[128:131], v[4:7]
    s_and_b32 s60, s60, 3
    s_lshl_b32 s61, s58, 2
    s_waitcnt lgkmcnt(4)
    v_mfma_f32_16x16x32_bf16 v[8:11], v[156:159], v[128:131], v[8:11]
    ds_read_b64_tr_b16 v[152:153], v165 offset:14336
    s_add_u32 s60, s60, s61
    v_mfma_f32_16x16x32_bf16 v[36:39], v[156:159], v[132:135], v[36:39]
    ds_read_b64_tr_b16 v[154:155], v165 offset:16128
    s_mul_i32 s60, s60, 20480
    v_mfma_f32_16x16x32_bf16 v[64:67], v[156:159], v[136:139], v[64:67]
    s_add_u32 s60, s60, 13631488
    s_mul_i32 s61, s26, 5120
    v_mfma_f32_16x16x32_bf16 v[92:95], v[156:159], v[140:143], v[92:95]
    s_add_u32 s90, s60, s61
    s_add_u32 s60, s27, 3
    s_waitcnt lgkmcnt(4)
    v_mfma_f32_16x16x32_bf16 v[96:99], v[144:147], v[140:143], v[96:99]
    ds_read_b64_tr_b16 v[156:157], v166 offset:14336
    s_and_b32 s60, s60, 3
    v_mfma_f32_16x16x32_bf16 v[68:71], v[144:147], v[136:139], v[68:71]
    ds_read_b64_tr_b16 v[158:159], v166 offset:16128
    s_lshl_b32 s61, s58, 2
    v_mfma_f32_16x16x32_bf16 v[40:43], v[144:147], v[132:135], v[40:43]
    s_add_u32 s60, s60, s61
    s_mul_i32 s60, s60, 20480
    v_mfma_f32_16x16x32_bf16 v[12:15], v[144:147], v[128:131], v[12:15]
    s_add_u32 s60, s60, 13631488
    s_mul_i32 s61, s26, 5120
    s_waitcnt lgkmcnt(4)
    v_mfma_f32_16x16x32_bf16 v[16:19], v[148:151], v[128:131], v[16:19]
    s_barrier
    ds_read_b64_tr_b16 v[144:145], v160 offset:28672
    s_add_u32 s91, s60, s61
    v_mfma_f32_16x16x32_bf16 v[44:47], v[148:151], v[132:135], v[44:47]
    ds_read_b64_tr_b16 v[146:147], v160 offset:30464
    s_and_b32 s60, s26, 1
    v_mfma_f32_16x16x32_bf16 v[72:75], v[148:151], v[136:139], v[72:75]
    ds_read_b128 v[112:115], v240 offset:16384
    s_lshl_b32 s61, s48, 1
    v_mfma_f32_16x16x32_bf16 v[100:103], v[148:151], v[140:143], v[100:103]
    ds_read_b128 v[116:119], v240 offset:18432
    s_add_u32 s60, s60, s61
    s_waitcnt lgkmcnt(6)
    v_mfma_f32_16x16x32_bf16 v[104:107], v[152:155], v[140:143], v[104:107]
    ds_read_b64_tr_b16 v[148:149], v161 offset:28672
    s_mul_i32 s60, s60, 272
    v_mfma_f32_16x16x32_bf16 v[76:79], v[152:155], v[136:139], v[76:79]
    ds_read_b64_tr_b16 v[150:151], v161 offset:30464
    s_add_u32 s60, s60, s56
    v_mfma_f32_16x16x32_bf16 v[48:51], v[152:155], v[132:135], v[48:51]
    ds_read_b128 v[120:123], v240 offset:20480
    s_lshl_b32 s64, s60, 10
    v_mfma_f32_16x16x32_bf16 v[20:23], v[152:155], v[128:131], v[20:23]
    ds_read_b128 v[124:127], v240 offset:22528
    s_add_u32 s65, s64, 69632
    s_waitcnt lgkmcnt(8)
    v_mfma_f32_16x16x32_bf16 v[24:27], v[156:159], v[128:131], v[24:27]
    ds_read_b64_tr_b16 v[152:153], v162 offset:28672
    s_add_u32 s66, s65, 69632
    v_mfma_f32_16x16x32_bf16 v[52:55], v[156:159], v[132:135], v[52:55]
    ds_read_b64_tr_b16 v[154:155], v162 offset:30464
    s_add_u32 s67, s66, 69632
    v_mfma_f32_16x16x32_bf16 v[80:83], v[156:159], v[136:139], v[80:83]
    s_bfe_u32 s60, s17, 0x40000
    s_lshr_b32 s68, s60, 1
    v_mfma_f32_16x16x32_bf16 v[108:111], v[156:159], v[140:143], v[108:111]
    s_lshl_b32 s68, s68, 10
    s_bfe_u32 s60, s17, 0x40008
    s_waitcnt lgkmcnt(2)
    v_mfma_f32_16x16x32_bf16 v[0:3], v[144:147], v[112:115], v[0:3]
    ds_read_b64_tr_b16 v[156:157], v163 offset:28672
    s_lshr_b32 s69, s60, 1
    v_mfma_f32_16x16x32_bf16 v[28:31], v[144:147], v[116:119], v[28:31]
    ds_read_b64_tr_b16 v[158:159], v163 offset:30464
    s_lshl_b32 s69, s69, 10
    v_mfma_f32_16x16x32_bf16 v[56:59], v[144:147], v[120:123], v[56:59]
    s_bfe_u32 s60, s17, 0x40010
    s_lshr_b32 s70, s60, 1
    v_mfma_f32_16x16x32_bf16 v[84:87], v[144:147], v[124:127], v[84:87]
    s_lshl_b32 s70, s70, 10
    s_bfe_u32 s60, s17, 0x40018
    v_mfma_f32_16x16x32_bf16 v[88:91], v[148:151], v[124:127], v[88:91]
    ds_read_b64_tr_b16 v[144:145], v164 offset:28672
    s_lshr_b32 s71, s60, 1
    v_mfma_f32_16x16x32_bf16 v[60:63], v[148:151], v[120:123], v[60:63]
    ds_read_b64_tr_b16 v[146:147], v164 offset:30464
    s_lshl_b32 s71, s71, 10
    v_mfma_f32_16x16x32_bf16 v[32:35], v[148:151], v[116:119], v[32:35]
    s_and_b32 s61, s60, 1
    s_lshl_b32 s61, s61, 3
    v_mfma_f32_16x16x32_bf16 v[4:7], v[148:151], v[112:115], v[4:7]
    s_add_u32 s72, s71, s61
    s_cmp_eq_u32 s49, 14
    s_waitcnt lgkmcnt(4)
    v_mfma_f32_16x16x32_bf16 v[8:11], v[152:155], v[112:115], v[8:11]
    ds_read_b64_tr_b16 v[148:149], v165 offset:28672
    s_cselect_b32 s72, 16777216, s72
    v_mfma_f32_16x16x32_bf16 v[36:39], v[152:155], v[116:119], v[36:39]
    ds_read_b64_tr_b16 v[150:151], v165 offset:30464
    s_mul_i32 s100, s59, 348160
    v_mfma_f32_16x16x32_bf16 v[64:67], v[152:155], v[120:123], v[64:67]
    s_mul_i32 s60, s26, 25600
    s_add_u32 s100, s100, s60
    v_mfma_f32_16x16x32_bf16 v[92:95], v[152:155], v[124:127], v[92:95]
    s_add_u32 s100, s100, 9617408
    v_add_u32 v249, s68, v254
    s_waitcnt lgkmcnt(4)
    v_mfma_f32_16x16x32_bf16 v[96:99], v[156:159], v[124:127], v[96:99]
    ds_read_b64_tr_b16 v[152:153], v166 offset:28672
    v_add_u32 v250, s69, v254
    v_mfma_f32_16x16x32_bf16 v[68:71], v[156:159], v[120:123], v[68:71]
    ds_read_b64_tr_b16 v[154:155], v166 offset:30464
    v_add_u32 v251, s70, v254
    v_mfma_f32_16x16x32_bf16 v[40:43], v[156:159], v[116:119], v[40:43]
    v_add_u32 v252, s71, v254
    s_add_u32 s18, s100, 65536
    v_mfma_f32_16x16x32_bf16 v[12:15], v[156:159], v[112:115], v[12:15]
    s_add_u32 s19, s100, 69632
    s_add_u32 s20, s100, 73728
    s_waitcnt lgkmcnt(4)
    v_mfma_f32_16x16x32_bf16 v[16:19], v[144:147], v[112:115], v[16:19]
    s_barrier
    ds_read_b64_tr_b16 v[156:157], v242 offset:0
    s_cmp_ge_u32 s26, 2
    v_mfma_f32_16x16x32_bf16 v[44:47], v[144:147], v[116:119], v[44:47]
    ds_read_b64_tr_b16 v[158:159], v242 offset:1792
    s_cselect_b32 s73, s66, s64
    v_mfma_f32_16x16x32_bf16 v[72:75], v[144:147], v[120:123], v[72:75]
    ds_read_b128 v[128:131], v241 offset:16384
    s_add_u32 s73, s73, s71
    v_mfma_f32_16x16x32_bf16 v[100:103], v[144:147], v[124:127], v[100:103]
    ds_read_b128 v[132:135], v241 offset:18432
    s_cmp_eq_u32 s49, 14
    s_waitcnt lgkmcnt(6)
    v_mfma_f32_16x16x32_bf16 v[104:107], v[148:151], v[124:127], v[104:107]
    ds_read_b64_tr_b16 v[144:145], v243 offset:0
    s_cselect_b32 s73, 16777216, s73
    v_mfma_f32_16x16x32_bf16 v[76:79], v[148:151], v[120:123], v[76:79]
    ds_read_b64_tr_b16 v[146:147], v243 offset:1792
    s_add_u32 s74, s73, 69632
    v_mfma_f32_16x16x32_bf16 v[48:51], v[148:151], v[116:119], v[48:51]
    ds_read_b128 v[136:139], v241 offset:20480
    v_mov_b32 v174, 0
    v_mfma_f32_16x16x32_bf16 v[20:23], v[148:151], v[112:115], v[20:23]
    ds_read_b128 v[140:143], v241 offset:22528
    v_mov_b32 v175, 0
    s_waitcnt lgkmcnt(8)
    v_mfma_f32_16x16x32_bf16 v[24:27], v[152:155], v[112:115], v[24:27]
    ds_read_b64_tr_b16 v[148:149], v244 offset:0
    v_mov_b32 v178, 0
    v_mfma_f32_16x16x32_bf16 v[52:55], v[152:155], v[116:119], v[52:55]
    ds_read_b64_tr_b16 v[150:151], v244 offset:1792
    v_mov_b32 v179, 0
    v_mfma_f32_16x16x32_bf16 v[80:83], v[152:155], v[120:123], v[80:83]
    v_mov_b32 v182, 0
    v_mov_b32 v183, 0
    v_mfma_f32_16x16x32_bf16 v[108:111], v[152:155], v[124:127], v[108:111]
    v_mov_b32 v186, 0
    v_mov_b32 v187, 0
    s_waitcnt lgkmcnt(2)
    v_mfma_f32_16x16x32_bf16 v[0:3], v[156:159], v[128:131], v[0:3]
    ds_read_b64_tr_b16 v[152:153], v245 offset:0
    v_mov_b32 v190, 0
    v_mfma_f32_16x16x32_bf16 v[28:31], v[156:159], v[132:135], v[28:31]
    ds_read_b64_tr_b16 v[154:155], v245 offset:1792
    v_mov_b32 v191, 0
    v_mfma_f32_16x16x32_bf16 v[56:59], v[156:159], v[136:139], v[56:59]
    v_mov_b32 v194, 0
    v_mov_b32 v195, 0
    v_mfma_f32_16x16x32_bf16 v[84:87], v[156:159], v[140:143], v[84:87]
    v_mov_b32 v198, 0
    v_mov_b32 v199, 0
    v_mfma_f32_16x16x32_bf16 v[88:91], v[144:147], v[140:143], v[88:91]
    ds_read_b64_tr_b16 v[156:157], v246 offset:0
    v_mov_b32 v202, 0
    v_mfma_f32_16x16x32_bf16 v[60:63], v[144:147], v[136:139], v[60:63]
    ds_read_b64_tr_b16 v[158:159], v246 offset:1792
    v_mov_b32 v203, 0
    v_mfma_f32_16x16x32_bf16 v[32:35], v[144:147], v[132:135], v[32:35]
    v_mov_b32 v206, 0
    v_mov_b32 v207, 0
    v_mfma_f32_16x16x32_bf16 v[4:7], v[144:147], v[128:131], v[4:7]
    v_mov_b32 v210, 0
    v_mov_b32 v211, 0
    s_waitcnt lgkmcnt(4)
    v_mfma_f32_16x16x32_bf16 v[8:11], v[148:151], v[128:131], v[8:11]
    ds_read_b64_tr_b16 v[144:145], v247 offset:0
    v_mov_b32 v214, 0
    v_mfma_f32_16x16x32_bf16 v[36:39], v[148:151], v[132:135], v[36:39]
    ds_read_b64_tr_b16 v[146:147], v247 offset:1792
    v_mov_b32 v215, 0
    v_mfma_f32_16x16x32_bf16 v[64:67], v[148:151], v[136:139], v[64:67]
    s_and_b32 s60, s26, 1
    s_lshl_b32 s60, s60, 9
    v_mfma_f32_16x16x32_bf16 v[92:95], v[148:151], v[140:143], v[92:95]
    s_add_u32 s60, s60, 162304
    v_and_b32 v171, 15, v255
    s_waitcnt lgkmcnt(4)
    v_mfma_f32_16x16x32_bf16 v[96:99], v[152:155], v[140:143], v[96:99]
    ds_read_b64_tr_b16 v[148:149], v248 offset:0
    v_lshl_add_u32 v171, v171, 3, s60
    v_mfma_f32_16x16x32_bf16 v[68:71], v[152:155], v[136:139], v[68:71]
    ds_read_b64_tr_b16 v[150:151], v248 offset:1792
    s_bfe_u32 s60, s17, 0x40000
    v_mfma_f32_16x16x32_bf16 v[40:43], v[152:155], v[132:135], v[40:43]
    s_lshl_b32 s60, s60, 9
    s_add_u32 s60, s60, 155136
    v_mfma_f32_16x16x32_bf16 v[12:15], v[152:155], v[128:131], v[12:15]
    v_lshl_add_u32 v172, v255, 3, s60
    s_bfe_u32 s60, s17, 0x40004
    s_waitcnt lgkmcnt(4)
    v_mfma_f32_16x16x32_bf16 v[16:19], v[156:159], v[128:131], v[16:19]
    s_barrier
    ds_read_b64_tr_b16 v[152:153], v242 offset:14336
    s_lshl_b32 s60, s60, 9
    v_mfma_f32_16x16x32_bf16 v[44:47], v[156:159], v[132:135], v[44:47]
    ds_read_b64_tr_b16 v[154:155], v242 offset:16128
    s_add_u32 s60, s60, 155136
    v_mfma_f32_16x16x32_bf16 v[72:75], v[156:159], v[136:139], v[72:75]
    ds_read_b128 v[112:115], v240 offset:32768
    v_lshl_add_u32 v176, v255, 3, s60
    v_mfma_f32_16x16x32_bf16 v[100:103], v[156:159], v[140:143], v[100:103]
    ds_read_b128 v[116:119], v240 offset:34816
    s_bfe_u32 s60, s17, 0x40008
    s_waitcnt lgkmcnt(6)
    v_mfma_f32_16x16x32_bf16 v[104:107], v[144:147], v[140:143], v[104:107]
    ds_read_b64_tr_b16 v[156:157], v243 offset:14336
    s_lshl_b32 s60, s60, 9
    v_mfma_f32_16x16x32_bf16 v[76:79], v[144:147], v[136:139], v[76:79]
    ds_read_b64_tr_b16 v[158:159], v243 offset:16128
    s_add_u32 s60, s60, 155136
    v_mfma_f32_16x16x32_bf16 v[48:51], v[144:147], v[132:135], v[48:51]
    ds_read_b128 v[120:123], v240 offset:36864
    v_lshl_add_u32 v180, v255, 3, s60
    v_mfma_f32_16x16x32_bf16 v[20:23], v[144:147], v[128:131], v[20:23]
    ds_read_b128 v[124:127], v240 offset:38912
    s_bfe_u32 s60, s17, 0x4000c
    s_waitcnt lgkmcnt(8)
    v_mfma_f32_16x16x32_bf16 v[24:27], v[148:151], v[128:131], v[24:27]
    ds_read_b64_tr_b16 v[144:145], v244 offset:14336
    s_lshl_b32 s60, s60, 9
    v_mfma_f32_16x16x32_bf16 v[52:55], v[148:151], v[132:135], v[52:55]
    ds_read_b64_tr_b16 v[146:147], v244 offset:16128
    s_add_u32 s60, s60, 155136
    v_mfma_f32_16x16x32_bf16 v[80:83], v[148:151], v[136:139], v[80:83]
    v_lshl_add_u32 v184, v255, 3, s60
    s_bfe_u32 s60, s17, 0x40010
    v_mfma_f32_16x16x32_bf16 v[108:111], v[148:151], v[140:143], v[108:111]
    s_lshl_b32 s60, s60, 9
    s_add_u32 s60, s60, 155136
    s_waitcnt lgkmcnt(2)
    v_mfma_f32_16x16x32_bf16 v[0:3], v[152:155], v[112:115], v[0:3]
    ds_read_b64_tr_b16 v[148:149], v245 offset:14336
    v_lshl_add_u32 v188, v255, 3, s60
    v_mfma_f32_16x16x32_bf16 v[28:31], v[152:155], v[116:119], v[28:31]
    ds_read_b64_tr_b16 v[150:151], v245 offset:16128
    s_bfe_u32 s60, s17, 0x40014
    v_mfma_f32_16x16x32_bf16 v[56:59], v[152:155], v[120:123], v[56:59]
    s_lshl_b32 s60, s60, 9
    s_add_u32 s60, s60, 155136
    v_mfma_f32_16x16x32_bf16 v[84:87], v[152:155], v[124:127], v[84:87]
    v_lshl_add_u32 v192, v255, 3, s60
    s_bfe_u32 s60, s17, 0x40018
    v_mfma_f32_16x16x32_bf16 v[88:91], v[156:159], v[124:127], v[88:91]
    ds_read_b64_tr_b16 v[152:153], v246 offset:14336
    s_lshl_b32 s60, s60, 9
    v_mfma_f32_16x16x32_bf16 v[60:63], v[156:159], v[120:123], v[60:63]
    ds_read_b64_tr_b16 v[154:155], v246 offset:16128
    s_add_u32 s60, s60, 155136
    v_mfma_f32_16x16x32_bf16 v[32:35], v[156:159], v[116:119], v[32:35]
    v_lshl_add_u32 v196, v255, 3, s60
    v_cmp_gt_u32 vcc, 16, v255
    v_mfma_f32_16x16x32_bf16 v[4:7], v[156:159], v[112:115], v[4:7]
    v_mov_b32 v221, 0x358637bd
    v_mov_b32 v227, 0x358637bd
    s_waitcnt lgkmcnt(4)
    v_mfma_f32_16x16x32_bf16 v[8:11], v[144:147], v[112:115], v[8:11]
    ds_read_b64_tr_b16 v[156:157], v247 offset:14336
    v_mov_b32 v233, 0x358637bd
    v_mfma_f32_16x16x32_bf16 v[36:39], v[144:147], v[116:119], v[36:39]
    ds_read_b64_tr_b16 v[158:159], v247 offset:16128
    v_mov_b32 v239, 0x358637bd
    v_mfma_f32_16x16x32_bf16 v[64:67], v[144:147], v[120:123], v[64:67]
    v_mfma_f32_16x16x32_bf16 v[92:95], v[144:147], v[124:127], v[92:95]
    s_waitcnt lgkmcnt(4)
    v_mfma_f32_16x16x32_bf16 v[96:99], v[148:151], v[124:127], v[96:99]
    ds_read_b64_tr_b16 v[144:145], v248 offset:14336
    v_mfma_f32_16x16x32_bf16 v[68:71], v[148:151], v[120:123], v[68:71]
    ds_read_b64_tr_b16 v[146:147], v248 offset:16128
    v_mfma_f32_16x16x32_bf16 v[40:43], v[148:151], v[116:119], v[40:43]
    v_mfma_f32_16x16x32_bf16 v[12:15], v[148:151], v[112:115], v[12:15]
    s_waitcnt lgkmcnt(4)
    v_mfma_f32_16x16x32_bf16 v[16:19], v[152:155], v[112:115], v[16:19]
    s_barrier
    ds_read_b64_tr_b16 v[148:149], v242 offset:28672
    v_mfma_f32_16x16x32_bf16 v[44:47], v[152:155], v[116:119], v[44:47]
    ds_read_b64_tr_b16 v[150:151], v242 offset:30464
    v_mfma_f32_16x16x32_bf16 v[72:75], v[152:155], v[120:123], v[72:75]
    ds_read_b128 v[128:131], v241 offset:32768
    v_mfma_f32_16x16x32_bf16 v[100:103], v[152:155], v[124:127], v[100:103]
    ds_read_b128 v[132:135], v241 offset:34816
    s_waitcnt lgkmcnt(6)
    v_mfma_f32_16x16x32_bf16 v[104:107], v[156:159], v[124:127], v[104:107]
    ds_read_b64_tr_b16 v[152:153], v243 offset:28672
    v_mfma_f32_16x16x32_bf16 v[76:79], v[156:159], v[120:123], v[76:79]
    ds_read_b64_tr_b16 v[154:155], v243 offset:30464
    v_mfma_f32_16x16x32_bf16 v[48:51], v[156:159], v[116:119], v[48:51]
    ds_read_b128 v[136:139], v241 offset:36864
    v_mfma_f32_16x16x32_bf16 v[20:23], v[156:159], v[112:115], v[20:23]
    ds_read_b128 v[140:143], v241 offset:38912
    s_waitcnt lgkmcnt(8)
    v_mfma_f32_16x16x32_bf16 v[24:27], v[144:147], v[112:115], v[24:27]
    ds_read_b64_tr_b16 v[156:157], v244 offset:28672
    v_mfma_f32_16x16x32_bf16 v[52:55], v[144:147], v[116:119], v[52:55]
    ds_read_b64_tr_b16 v[158:159], v244 offset:30464
    v_mfma_f32_16x16x32_bf16 v[80:83], v[144:147], v[120:123], v[80:83]
    v_mfma_f32_16x16x32_bf16 v[108:111], v[144:147], v[124:127], v[108:111]
    s_waitcnt lgkmcnt(2)
    v_mfma_f32_16x16x32_bf16 v[0:3], v[148:151], v[128:131], v[0:3]
    ds_read_b64_tr_b16 v[144:145], v245 offset:28672
    v_mfma_f32_16x16x32_bf16 v[28:31], v[148:151], v[132:135], v[28:31]
    ds_read_b64_tr_b16 v[146:147], v245 offset:30464
    v_mfma_f32_16x16x32_bf16 v[56:59], v[148:151], v[136:139], v[56:59]
    v_mfma_f32_16x16x32_bf16 v[84:87], v[148:151], v[140:143], v[84:87]
    v_mfma_f32_16x16x32_bf16 v[88:91], v[152:155], v[140:143], v[88:91]
    ds_read_b64_tr_b16 v[148:149], v246 offset:28672
    v_mfma_f32_16x16x32_bf16 v[60:63], v[152:155], v[136:139], v[60:63]
    ds_read_b64_tr_b16 v[150:151], v246 offset:30464
    v_mfma_f32_16x16x32_bf16 v[32:35], v[152:155], v[132:135], v[32:35]
    v_mfma_f32_16x16x32_bf16 v[4:7], v[152:155], v[128:131], v[4:7]
    s_waitcnt lgkmcnt(4)
    v_mfma_f32_16x16x32_bf16 v[8:11], v[156:159], v[128:131], v[8:11]
    ds_read_b64_tr_b16 v[152:153], v247 offset:28672
    v_mfma_f32_16x16x32_bf16 v[36:39], v[156:159], v[132:135], v[36:39]
    ds_read_b64_tr_b16 v[154:155], v247 offset:30464
    v_mfma_f32_16x16x32_bf16 v[64:67], v[156:159], v[136:139], v[64:67]
    v_mfma_f32_16x16x32_bf16 v[92:95], v[156:159], v[140:143], v[92:95]
    s_waitcnt lgkmcnt(4)
    v_mfma_f32_16x16x32_bf16 v[96:99], v[144:147], v[140:143], v[96:99]
    ds_read_b64_tr_b16 v[156:157], v248 offset:28672
    v_mfma_f32_16x16x32_bf16 v[68:71], v[144:147], v[136:139], v[68:71]
    ds_read_b64_tr_b16 v[158:159], v248 offset:30464
    v_mfma_f32_16x16x32_bf16 v[40:43], v[144:147], v[132:135], v[40:43]
    v_mfma_f32_16x16x32_bf16 v[12:15], v[144:147], v[128:131], v[12:15]
    s_waitcnt lgkmcnt(4)
    v_mfma_f32_16x16x32_bf16 v[16:19], v[148:151], v[128:131], v[16:19]
    s_barrier
    ds_read_b64_tr_b16 v[144:145], v160 offset:0
    v_mfma_f32_16x16x32_bf16 v[44:47], v[148:151], v[132:135], v[44:47]
    ds_read_b64_tr_b16 v[146:147], v160 offset:1792
    v_mfma_f32_16x16x32_bf16 v[72:75], v[148:151], v[136:139], v[72:75]
    ds_read_b128 v[112:115], v240 offset:0
    v_mfma_f32_16x16x32_bf16 v[100:103], v[148:151], v[140:143], v[100:103]
    ds_read_b128 v[116:119], v240 offset:2048
    s_waitcnt lgkmcnt(6)
    v_mfma_f32_16x16x32_bf16 v[104:107], v[152:155], v[140:143], v[104:107]
    ds_read_b64_tr_b16 v[148:149], v161 offset:0
    v_mfma_f32_16x16x32_bf16 v[76:79], v[152:155], v[136:139], v[76:79]
    ds_read_b64_tr_b16 v[150:151], v161 offset:1792
    v_mfma_f32_16x16x32_bf16 v[48:51], v[152:155], v[132:135], v[48:51]
    ds_read_b128 v[120:123], v240 offset:4096
    v_mfma_f32_16x16x32_bf16 v[20:23], v[152:155], v[128:131], v[20:23]
    ds_read_b128 v[124:127], v240 offset:6144
    s_waitcnt lgkmcnt(8)
    v_mfma_f32_16x16x32_bf16 v[24:27], v[156:159], v[128:131], v[24:27]
    ds_read_b64_tr_b16 v[152:153], v162 offset:0
    v_mfma_f32_16x16x32_bf16 v[52:55], v[156:159], v[132:135], v[52:55]
    ds_read_b64_tr_b16 v[154:155], v162 offset:1792
    v_mfma_f32_16x16x32_bf16 v[80:83], v[156:159], v[136:139], v[80:83]
    v_mfma_f32_16x16x32_bf16 v[108:111], v[156:159], v[140:143], v[108:111]
    s_waitcnt lgkmcnt(2)
    v_mfma_f32_16x16x32_bf16 v[0:3], v[144:147], v[112:115], v[0:3]
    ds_read_b64_tr_b16 v[156:157], v163 offset:0
    v_mfma_f32_16x16x32_bf16 v[28:31], v[144:147], v[116:119], v[28:31]
    ds_read_b64_tr_b16 v[158:159], v163 offset:1792
    v_mfma_f32_16x16x32_bf16 v[56:59], v[144:147], v[120:123], v[56:59]
    v_mfma_f32_16x16x32_bf16 v[84:87], v[144:147], v[124:127], v[84:87]
    v_mfma_f32_16x16x32_bf16 v[88:91], v[148:151], v[124:127], v[88:91]
    ds_read_b64_tr_b16 v[144:145], v164 offset:0
    v_mfma_f32_16x16x32_bf16 v[60:63], v[148:151], v[120:123], v[60:63]
    ds_read_b64_tr_b16 v[146:147], v164 offset:1792
    v_mfma_f32_16x16x32_bf16 v[32:35], v[148:151], v[116:119], v[32:35]
    v_mfma_f32_16x16x32_bf16 v[4:7], v[148:151], v[112:115], v[4:7]
    s_waitcnt lgkmcnt(4)
    v_mfma_f32_16x16x32_bf16 v[8:11], v[152:155], v[112:115], v[8:11]
    ds_read_b64_tr_b16 v[148:149], v165 offset:0
    v_mfma_f32_16x16x32_bf16 v[36:39], v[152:155], v[116:119], v[36:39]
    ds_read_b64_tr_b16 v[150:151], v165 offset:1792
    v_mfma_f32_16x16x32_bf16 v[64:67], v[152:155], v[120:123], v[64:67]
    v_mfma_f32_16x16x32_bf16 v[92:95], v[152:155], v[124:127], v[92:95]
    s_waitcnt lgkmcnt(4)
    v_mfma_f32_16x16x32_bf16 v[96:99], v[156:159], v[124:127], v[96:99]
    ds_read_b64_tr_b16 v[152:153], v166 offset:0
    v_mfma_f32_16x16x32_bf16 v[68:71], v[156:159], v[120:123], v[68:71]
    ds_read_b64_tr_b16 v[154:155], v166 offset:1792
    v_mfma_f32_16x16x32_bf16 v[40:43], v[156:159], v[116:119], v[40:43]
    v_mfma_f32_16x16x32_bf16 v[12:15], v[156:159], v[112:115], v[12:15]
    s_waitcnt lgkmcnt(4)
    v_mfma_f32_16x16x32_bf16 v[16:19], v[144:147], v[112:115], v[16:19]
    s_barrier
    ds_read_b64_tr_b16 v[156:157], v160 offset:14336
    v_mfma_f32_16x16x32_bf16 v[44:47], v[144:147], v[116:119], v[44:47]
    ds_read_b64_tr_b16 v[158:159], v160 offset:16128
    v_mfma_f32_16x16x32_bf16 v[72:75], v[144:147], v[120:123], v[72:75]
    ds_read_b128 v[128:131], v241 offset:0
    v_mfma_f32_16x16x32_bf16 v[100:103], v[144:147], v[124:127], v[100:103]
    ds_read_b128 v[132:135], v241 offset:2048
    s_waitcnt lgkmcnt(6)
    v_mfma_f32_16x16x32_bf16 v[104:107], v[148:151], v[124:127], v[104:107]
    ds_read_b64_tr_b16 v[144:145], v161 offset:14336
    v_mfma_f32_16x16x32_bf16 v[76:79], v[148:151], v[120:123], v[76:79]
    ds_read_b64_tr_b16 v[146:147], v161 offset:16128
    v_mfma_f32_16x16x32_bf16 v[48:51], v[148:151], v[116:119], v[48:51]
    ds_read_b128 v[136:139], v241 offset:4096
    v_mfma_f32_16x16x32_bf16 v[20:23], v[148:151], v[112:115], v[20:23]
    ds_read_b128 v[140:143], v241 offset:6144
    s_waitcnt lgkmcnt(8)
    v_mfma_f32_16x16x32_bf16 v[24:27], v[152:155], v[112:115], v[24:27]
    ds_read_b64_tr_b16 v[148:149], v162 offset:14336
    v_mfma_f32_16x16x32_bf16 v[52:55], v[152:155], v[116:119], v[52:55]
    ds_read_b64_tr_b16 v[150:151], v162 offset:16128
    v_mfma_f32_16x16x32_bf16 v[80:83], v[152:155], v[120:123], v[80:83]
    v_mfma_f32_16x16x32_bf16 v[108:111], v[152:155], v[124:127], v[108:111]
    s_waitcnt lgkmcnt(2)
    v_mfma_f32_16x16x32_bf16 v[0:3], v[156:159], v[128:131], v[0:3]
    ds_read_b64_tr_b16 v[152:153], v163 offset:14336
    v_mfma_f32_16x16x32_bf16 v[28:31], v[156:159], v[132:135], v[28:31]
    ds_read_b64_tr_b16 v[154:155], v163 offset:16128
    v_mfma_f32_16x16x32_bf16 v[56:59], v[156:159], v[136:139], v[56:59]
    v_mfma_f32_16x16x32_bf16 v[84:87], v[156:159], v[140:143], v[84:87]
    v_mfma_f32_16x16x32_bf16 v[88:91], v[144:147], v[140:143], v[88:91]
    ds_read_b64_tr_b16 v[156:157], v164 offset:14336
    v_mfma_f32_16x16x32_bf16 v[60:63], v[144:147], v[136:139], v[60:63]
    ds_read_b64_tr_b16 v[158:159], v164 offset:16128
    v_mfma_f32_16x16x32_bf16 v[32:35], v[144:147], v[132:135], v[32:35]
    v_mfma_f32_16x16x32_bf16 v[4:7], v[144:147], v[128:131], v[4:7]
    s_waitcnt lgkmcnt(4)
    v_mfma_f32_16x16x32_bf16 v[8:11], v[148:151], v[128:131], v[8:11]
    ds_read_b64_tr_b16 v[144:145], v165 offset:14336
    v_mfma_f32_16x16x32_bf16 v[36:39], v[148:151], v[132:135], v[36:39]
    ds_read_b64_tr_b16 v[146:147], v165 offset:16128
    v_mfma_f32_16x16x32_bf16 v[64:67], v[148:151], v[136:139], v[64:67]
    v_mfma_f32_16x16x32_bf16 v[92:95], v[148:151], v[140:143], v[92:95]
    s_waitcnt lgkmcnt(4)
    v_mfma_f32_16x16x32_bf16 v[96:99], v[152:155], v[140:143], v[96:99]
    ds_read_b64_tr_b16 v[148:149], v166 offset:14336
    v_mfma_f32_16x16x32_bf16 v[68:71], v[152:155], v[136:139], v[68:71]
    ds_read_b64_tr_b16 v[150:151], v166 offset:16128
    v_mfma_f32_16x16x32_bf16 v[40:43], v[152:155], v[132:135], v[40:43]
    v_mfma_f32_16x16x32_bf16 v[12:15], v[152:155], v[128:131], v[12:15]
    s_waitcnt lgkmcnt(4)
    v_mfma_f32_16x16x32_bf16 v[16:19], v[156:159], v[128:131], v[16:19]
    s_barrier
    ds_read_b64_tr_b16 v[152:153], v160 offset:28672
    v_mfma_f32_16x16x32_bf16 v[44:47], v[156:159], v[132:135], v[44:47]
    ds_read_b64_tr_b16 v[154:155], v160 offset:30464
    v_mfma_f32_16x16x32_bf16 v[72:75], v[156:159], v[136:139], v[72:75]
    ds_read_b128 v[112:115], v240 offset:16384
    v_mfma_f32_16x16x32_bf16 v[100:103], v[156:159], v[140:143], v[100:103]
    ds_read_b128 v[116:119], v240 offset:18432
    s_waitcnt lgkmcnt(6)
    v_mfma_f32_16x16x32_bf16 v[104:107], v[144:147], v[140:143], v[104:107]
    ds_read_b64_tr_b16 v[156:157], v161 offset:28672
    v_mfma_f32_16x16x32_bf16 v[76:79], v[144:147], v[136:139], v[76:79]
    ds_read_b64_tr_b16 v[158:159], v161 offset:30464
    v_mfma_f32_16x16x32_bf16 v[48:51], v[144:147], v[132:135], v[48:51]
    ds_read_b128 v[120:123], v240 offset:20480
    v_mfma_f32_16x16x32_bf16 v[20:23], v[144:147], v[128:131], v[20:23]
    ds_read_b128 v[124:127], v240 offset:22528
    s_waitcnt lgkmcnt(8)
    v_mfma_f32_16x16x32_bf16 v[24:27], v[148:151], v[128:131], v[24:27]
    ds_read_b64_tr_b16 v[144:145], v162 offset:28672
    v_mfma_f32_16x16x32_bf16 v[52:55], v[148:151], v[132:135], v[52:55]
    ds_read_b64_tr_b16 v[146:147], v162 offset:30464
    v_mfma_f32_16x16x32_bf16 v[80:83], v[148:151], v[136:139], v[80:83]
    v_mfma_f32_16x16x32_bf16 v[108:111], v[148:151], v[140:143], v[108:111]
    s_waitcnt lgkmcnt(2)
    v_mfma_f32_16x16x32_bf16 v[0:3], v[152:155], v[112:115], v[0:3]
    ds_read_b64_tr_b16 v[148:149], v163 offset:28672
    v_mfma_f32_16x16x32_bf16 v[28:31], v[152:155], v[116:119], v[28:31]
    ds_read_b64_tr_b16 v[150:151], v163 offset:30464
    v_mfma_f32_16x16x32_bf16 v[56:59], v[152:155], v[120:123], v[56:59]
    v_mfma_f32_16x16x32_bf16 v[84:87], v[152:155], v[124:127], v[84:87]
    v_mfma_f32_16x16x32_bf16 v[88:91], v[156:159], v[124:127], v[88:91]
    ds_read_b64_tr_b16 v[152:153], v164 offset:28672
    v_mfma_f32_16x16x32_bf16 v[60:63], v[156:159], v[120:123], v[60:63]
    ds_read_b64_tr_b16 v[154:155], v164 offset:30464
    v_mfma_f32_16x16x32_bf16 v[32:35], v[156:159], v[116:119], v[32:35]
    v_mfma_f32_16x16x32_bf16 v[4:7], v[156:159], v[112:115], v[4:7]
    s_waitcnt lgkmcnt(4)
    v_mfma_f32_16x16x32_bf16 v[8:11], v[144:147], v[112:115], v[8:11]
    ds_read_b64_tr_b16 v[156:157], v165 offset:28672
    v_mfma_f32_16x16x32_bf16 v[36:39], v[144:147], v[116:119], v[36:39]
    ds_read_b64_tr_b16 v[158:159], v165 offset:30464
    v_mfma_f32_16x16x32_bf16 v[64:67], v[144:147], v[120:123], v[64:67]
    v_mfma_f32_16x16x32_bf16 v[92:95], v[144:147], v[124:127], v[92:95]
    s_waitcnt lgkmcnt(4)
    v_mfma_f32_16x16x32_bf16 v[96:99], v[148:151], v[124:127], v[96:99]
    ds_read_b64_tr_b16 v[144:145], v166 offset:28672
    v_mfma_f32_16x16x32_bf16 v[68:71], v[148:151], v[120:123], v[68:71]
    ds_read_b64_tr_b16 v[146:147], v166 offset:30464
    v_mfma_f32_16x16x32_bf16 v[40:43], v[148:151], v[116:119], v[40:43]
    v_mfma_f32_16x16x32_bf16 v[12:15], v[148:151], v[112:115], v[12:15]
    s_waitcnt lgkmcnt(4)
    v_mfma_f32_16x16x32_bf16 v[16:19], v[152:155], v[112:115], v[16:19]
    s_barrier
    ds_read_b64_tr_b16 v[148:149], v242 offset:0
    v_mfma_f32_16x16x32_bf16 v[44:47], v[152:155], v[116:119], v[44:47]
    ds_read_b64_tr_b16 v[150:151], v242 offset:1792
    v_mfma_f32_16x16x32_bf16 v[72:75], v[152:155], v[120:123], v[72:75]
    ds_read_b128 v[128:131], v241 offset:16384
    v_mfma_f32_16x16x32_bf16 v[100:103], v[152:155], v[124:127], v[100:103]
    ds_read_b128 v[132:135], v241 offset:18432
    s_waitcnt lgkmcnt(6)
    v_mfma_f32_16x16x32_bf16 v[104:107], v[156:159], v[124:127], v[104:107]
    ds_read_b64_tr_b16 v[152:153], v243 offset:0
    v_mfma_f32_16x16x32_bf16 v[76:79], v[156:159], v[120:123], v[76:79]
    ds_read_b64_tr_b16 v[154:155], v243 offset:1792
    v_mfma_f32_16x16x32_bf16 v[48:51], v[156:159], v[116:119], v[48:51]
    ds_read_b128 v[136:139], v241 offset:20480
    v_mfma_f32_16x16x32_bf16 v[20:23], v[156:159], v[112:115], v[20:23]
    ds_read_b128 v[140:143], v241 offset:22528
    s_waitcnt lgkmcnt(8)
    v_mfma_f32_16x16x32_bf16 v[24:27], v[144:147], v[112:115], v[24:27]
    ds_read_b64_tr_b16 v[156:157], v244 offset:0
    v_mfma_f32_16x16x32_bf16 v[52:55], v[144:147], v[116:119], v[52:55]
    ds_read_b64_tr_b16 v[158:159], v244 offset:1792
    v_mfma_f32_16x16x32_bf16 v[80:83], v[144:147], v[120:123], v[80:83]
    v_mfma_f32_16x16x32_bf16 v[108:111], v[144:147], v[124:127], v[108:111]
    s_waitcnt lgkmcnt(2)
    v_mfma_f32_16x16x32_bf16 v[0:3], v[148:151], v[128:131], v[0:3]
    ds_read_b64_tr_b16 v[144:145], v245 offset:0
    v_mfma_f32_16x16x32_bf16 v[28:31], v[148:151], v[132:135], v[28:31]
    ds_read_b64_tr_b16 v[146:147], v245 offset:1792
    v_mfma_f32_16x16x32_bf16 v[56:59], v[148:151], v[136:139], v[56:59]
    v_mfma_f32_16x16x32_bf16 v[84:87], v[148:151], v[140:143], v[84:87]
    v_mfma_f32_16x16x32_bf16 v[88:91], v[152:155], v[140:143], v[88:91]
    ds_read_b64_tr_b16 v[148:149], v246 offset:0
    v_mfma_f32_16x16x32_bf16 v[60:63], v[152:155], v[136:139], v[60:63]
    ds_read_b64_tr_b16 v[150:151], v246 offset:1792
    v_mfma_f32_16x16x32_bf16 v[32:35], v[152:155], v[132:135], v[32:35]
    v_mfma_f32_16x16x32_bf16 v[4:7], v[152:155], v[128:131], v[4:7]
    s_waitcnt lgkmcnt(4)
    v_mfma_f32_16x16x32_bf16 v[8:11], v[156:159], v[128:131], v[8:11]
    ds_read_b64_tr_b16 v[152:153], v247 offset:0
    v_mfma_f32_16x16x32_bf16 v[36:39], v[156:159], v[132:135], v[36:39]
    ds_read_b64_tr_b16 v[154:155], v247 offset:1792
    v_mfma_f32_16x16x32_bf16 v[64:67], v[156:159], v[136:139], v[64:67]
    v_mfma_f32_16x16x32_bf16 v[92:95], v[156:159], v[140:143], v[92:95]
    s_waitcnt lgkmcnt(4)
    v_mfma_f32_16x16x32_bf16 v[96:99], v[144:147], v[140:143], v[96:99]
    ds_read_b64_tr_b16 v[156:157], v248 offset:0
    v_mfma_f32_16x16x32_bf16 v[68:71], v[144:147], v[136:139], v[68:71]
    ds_read_b64_tr_b16 v[158:159], v248 offset:1792
    v_mfma_f32_16x16x32_bf16 v[40:43], v[144:147], v[132:135], v[40:43]
    v_mfma_f32_16x16x32_bf16 v[12:15], v[144:147], v[128:131], v[12:15]
    s_waitcnt lgkmcnt(4)
    v_mfma_f32_16x16x32_bf16 v[16:19], v[148:151], v[128:131], v[16:19]
    s_barrier
    ds_read_b64_tr_b16 v[144:145], v242 offset:14336
    v_mfma_f32_16x16x32_bf16 v[44:47], v[148:151], v[132:135], v[44:47]
    ds_read_b64_tr_b16 v[146:147], v242 offset:16128
    v_mfma_f32_16x16x32_bf16 v[72:75], v[148:151], v[136:139], v[72:75]
    ds_read_b128 v[112:115], v240 offset:32768
    v_mfma_f32_16x16x32_bf16 v[100:103], v[148:151], v[140:143], v[100:103]
    ds_read_b128 v[116:119], v240 offset:34816
    s_waitcnt lgkmcnt(6)
    v_mfma_f32_16x16x32_bf16 v[104:107], v[152:155], v[140:143], v[104:107]
    ds_read_b64_tr_b16 v[148:149], v243 offset:14336
    v_mfma_f32_16x16x32_bf16 v[76:79], v[152:155], v[136:139], v[76:79]
    ds_read_b64_tr_b16 v[150:151], v243 offset:16128
    v_mfma_f32_16x16x32_bf16 v[48:51], v[152:155], v[132:135], v[48:51]
    ds_read_b128 v[120:123], v240 offset:36864
    v_mfma_f32_16x16x32_bf16 v[20:23], v[152:155], v[128:131], v[20:23]
    ds_read_b128 v[124:127], v240 offset:38912
    s_waitcnt lgkmcnt(8)
    v_mfma_f32_16x16x32_bf16 v[24:27], v[156:159], v[128:131], v[24:27]
    ds_read_b64_tr_b16 v[152:153], v244 offset:14336
    v_mfma_f32_16x16x32_bf16 v[52:55], v[156:159], v[132:135], v[52:55]
    ds_read_b64_tr_b16 v[154:155], v244 offset:16128
    v_mfma_f32_16x16x32_bf16 v[80:83], v[156:159], v[136:139], v[80:83]
    v_mfma_f32_16x16x32_bf16 v[108:111], v[156:159], v[140:143], v[108:111]
    s_waitcnt lgkmcnt(2)
    v_mfma_f32_16x16x32_bf16 v[0:3], v[144:147], v[112:115], v[0:3]
    ds_read_b64_tr_b16 v[156:157], v245 offset:14336
    v_mfma_f32_16x16x32_bf16 v[28:31], v[144:147], v[116:119], v[28:31]
    ds_read_b64_tr_b16 v[158:159], v245 offset:16128
    v_mfma_f32_16x16x32_bf16 v[56:59], v[144:147], v[120:123], v[56:59]
    v_mfma_f32_16x16x32_bf16 v[84:87], v[144:147], v[124:127], v[84:87]
    v_mfma_f32_16x16x32_bf16 v[88:91], v[148:151], v[124:127], v[88:91]
    ds_read_b64_tr_b16 v[144:145], v246 offset:14336
    v_mfma_f32_16x16x32_bf16 v[60:63], v[148:151], v[120:123], v[60:63]
    ds_read_b64_tr_b16 v[146:147], v246 offset:16128
    v_mfma_f32_16x16x32_bf16 v[32:35], v[148:151], v[116:119], v[32:35]
    v_mfma_f32_16x16x32_bf16 v[4:7], v[148:151], v[112:115], v[4:7]
    s_waitcnt lgkmcnt(4)
    v_mfma_f32_16x16x32_bf16 v[8:11], v[152:155], v[112:115], v[8:11]
    ds_read_b64_tr_b16 v[148:149], v247 offset:14336
    v_mfma_f32_16x16x32_bf16 v[36:39], v[152:155], v[116:119], v[36:39]
    ds_read_b64_tr_b16 v[150:151], v247 offset:16128
    v_mfma_f32_16x16x32_bf16 v[64:67], v[152:155], v[120:123], v[64:67]
    v_mfma_f32_16x16x32_bf16 v[92:95], v[152:155], v[124:127], v[92:95]
    s_waitcnt lgkmcnt(4)
    v_mfma_f32_16x16x32_bf16 v[96:99], v[156:159], v[124:127], v[96:99]
    ds_read_b64_tr_b16 v[152:153], v248 offset:14336
    v_mfma_f32_16x16x32_bf16 v[68:71], v[156:159], v[120:123], v[68:71]
    ds_read_b64_tr_b16 v[154:155], v248 offset:16128
    v_mfma_f32_16x16x32_bf16 v[40:43], v[156:159], v[116:119], v[40:43]
    v_mfma_f32_16x16x32_bf16 v[12:15], v[156:159], v[112:115], v[12:15]
    s_waitcnt lgkmcnt(4)
    v_mfma_f32_16x16x32_bf16 v[16:19], v[144:147], v[112:115], v[16:19]
    s_barrier
    ds_read_b64_tr_b16 v[156:157], v242 offset:28672
    v_mfma_f32_16x16x32_bf16 v[44:47], v[144:147], v[116:119], v[44:47]
    ds_read_b64_tr_b16 v[158:159], v242 offset:30464
    v_mfma_f32_16x16x32_bf16 v[72:75], v[144:147], v[120:123], v[72:75]
    ds_read_b128 v[128:131], v241 offset:32768
    v_mfma_f32_16x16x32_bf16 v[100:103], v[144:147], v[124:127], v[100:103]
    ds_read_b128 v[132:135], v241 offset:34816
    s_waitcnt lgkmcnt(6)
    v_mfma_f32_16x16x32_bf16 v[104:107], v[148:151], v[124:127], v[104:107]
    ds_read_b64_tr_b16 v[144:145], v243 offset:28672
    v_mfma_f32_16x16x32_bf16 v[76:79], v[148:151], v[120:123], v[76:79]
    ds_read_b64_tr_b16 v[146:147], v243 offset:30464
    v_mfma_f32_16x16x32_bf16 v[48:51], v[148:151], v[116:119], v[48:51]
    ds_read_b128 v[136:139], v241 offset:36864
    v_mfma_f32_16x16x32_bf16 v[20:23], v[148:151], v[112:115], v[20:23]
    ds_read_b128 v[140:143], v241 offset:38912
    s_waitcnt lgkmcnt(8)
    v_mfma_f32_16x16x32_bf16 v[24:27], v[152:155], v[112:115], v[24:27]
    ds_read_b64_tr_b16 v[148:149], v244 offset:28672
    v_mfma_f32_16x16x32_bf16 v[52:55], v[152:155], v[116:119], v[52:55]
    ds_read_b64_tr_b16 v[150:151], v244 offset:30464
    v_mfma_f32_16x16x32_bf16 v[80:83], v[152:155], v[120:123], v[80:83]
    v_mfma_f32_16x16x32_bf16 v[108:111], v[152:155], v[124:127], v[108:111]
    s_waitcnt lgkmcnt(2)
    v_mfma_f32_16x16x32_bf16 v[0:3], v[156:159], v[128:131], v[0:3]
    ds_read_b64_tr_b16 v[152:153], v245 offset:28672
    v_mfma_f32_16x16x32_bf16 v[28:31], v[156:159], v[132:135], v[28:31]
    ds_read_b64_tr_b16 v[154:155], v245 offset:30464
    v_mfma_f32_16x16x32_bf16 v[56:59], v[156:159], v[136:139], v[56:59]
    v_mfma_f32_16x16x32_bf16 v[84:87], v[156:159], v[140:143], v[84:87]
    v_mfma_f32_16x16x32_bf16 v[88:91], v[144:147], v[140:143], v[88:91]
    ds_read_b64_tr_b16 v[156:157], v246 offset:28672
    v_mfma_f32_16x16x32_bf16 v[60:63], v[144:147], v[136:139], v[60:63]
    ds_read_b64_tr_b16 v[158:159], v246 offset:30464
    v_mfma_f32_16x16x32_bf16 v[32:35], v[144:147], v[132:135], v[32:35]
    v_mfma_f32_16x16x32_bf16 v[4:7], v[144:147], v[128:131], v[4:7]
    s_waitcnt lgkmcnt(4)
    v_mfma_f32_16x16x32_bf16 v[8:11], v[148:151], v[128:131], v[8:11]
    ds_read_b64_tr_b16 v[144:145], v247 offset:28672
    v_mfma_f32_16x16x32_bf16 v[36:39], v[148:151], v[132:135], v[36:39]
    ds_read_b64_tr_b16 v[146:147], v247 offset:30464
    v_mfma_f32_16x16x32_bf16 v[64:67], v[148:151], v[136:139], v[64:67]
    v_mfma_f32_16x16x32_bf16 v[92:95], v[148:151], v[140:143], v[92:95]
    s_waitcnt lgkmcnt(4)
    v_mfma_f32_16x16x32_bf16 v[96:99], v[152:155], v[140:143], v[96:99]
    ds_read_b64_tr_b16 v[148:149], v248 offset:28672
    v_mfma_f32_16x16x32_bf16 v[68:71], v[152:155], v[136:139], v[68:71]
    ds_read_b64_tr_b16 v[150:151], v248 offset:30464
    v_mfma_f32_16x16x32_bf16 v[40:43], v[152:155], v[132:135], v[40:43]
    v_mfma_f32_16x16x32_bf16 v[12:15], v[152:155], v[128:131], v[12:15]
    s_waitcnt lgkmcnt(4)
    v_mfma_f32_16x16x32_bf16 v[16:19], v[156:159], v[128:131], v[16:19]
    s_waitcnt lgkmcnt(0)
    s_barrier
    ds_read_b64_tr_b16 v[152:153], v160 offset:0
    v_mfma_f32_16x16x32_bf16 v[44:47], v[156:159], v[132:135], v[44:47]
    ds_read_b64_tr_b16 v[154:155], v160 offset:1792
    v_mfma_f32_16x16x32_bf16 v[72:75], v[156:159], v[136:139], v[72:75]
    ds_read_b128 v[112:115], v240 offset:0
    v_mfma_f32_16x16x32_bf16 v[100:103], v[156:159], v[140:143], v[100:103]
    ds_read_b128 v[116:119], v240 offset:2048
    v_mfma_f32_16x16x32_bf16 v[104:107], v[144:147], v[140:143], v[104:107]
    ds_read_b64_tr_b16 v[156:157], v161 offset:0
    v_mfma_f32_16x16x32_bf16 v[76:79], v[144:147], v[136:139], v[76:79]
    ds_read_b64_tr_b16 v[158:159], v161 offset:1792
    v_mfma_f32_16x16x32_bf16 v[48:51], v[144:147], v[132:135], v[48:51]
    ds_read_b128 v[120:123], v240 offset:4096
    v_mfma_f32_16x16x32_bf16 v[20:23], v[144:147], v[128:131], v[20:23]
    ds_read_b128 v[124:127], v240 offset:6144
    v_mfma_f32_16x16x32_bf16 v[24:27], v[148:151], v[128:131], v[24:27]
    ds_read_b64_tr_b16 v[144:145], v162 offset:0
    v_mfma_f32_16x16x32_bf16 v[52:55], v[148:151], v[132:135], v[52:55]
    ds_read_b64_tr_b16 v[146:147], v162 offset:1792
    v_mfma_f32_16x16x32_bf16 v[80:83], v[148:151], v[136:139], v[80:83]
    v_mfma_f32_16x16x32_bf16 v[108:111], v[148:151], v[140:143], v[108:111]
    s_waitcnt lgkmcnt(2)
    v_mfma_f32_16x16x32_bf16 v[0:3], v[152:155], v[112:115], v[0:3]
    ds_read_b64_tr_b16 v[148:149], v163 offset:0
    v_mfma_f32_16x16x32_bf16 v[28:31], v[152:155], v[116:119], v[28:31]
    ds_read_b64_tr_b16 v[150:151], v163 offset:1792
    v_mfma_f32_16x16x32_bf16 v[56:59], v[152:155], v[120:123], v[56:59]
    v_mfma_f32_16x16x32_bf16 v[84:87], v[152:155], v[124:127], v[84:87]
    v_mfma_f32_16x16x32_bf16 v[88:91], v[156:159], v[124:127], v[88:91]
    ds_read_b64_tr_b16 v[152:153], v164 offset:0
    v_mfma_f32_16x16x32_bf16 v[60:63], v[156:159], v[120:123], v[60:63]
    ds_read_b64_tr_b16 v[154:155], v164 offset:1792
    v_mfma_f32_16x16x32_bf16 v[32:35], v[156:159], v[116:119], v[32:35]
    v_mfma_f32_16x16x32_bf16 v[4:7], v[156:159], v[112:115], v[4:7]
    s_waitcnt lgkmcnt(4)
    v_mfma_f32_16x16x32_bf16 v[8:11], v[144:147], v[112:115], v[8:11]
    ds_read_b64_tr_b16 v[156:157], v165 offset:0
    v_mfma_f32_16x16x32_bf16 v[36:39], v[144:147], v[116:119], v[36:39]
    ds_read_b64_tr_b16 v[158:159], v165 offset:1792
    v_mfma_f32_16x16x32_bf16 v[64:67], v[144:147], v[120:123], v[64:67]
    v_mfma_f32_16x16x32_bf16 v[92:95], v[144:147], v[124:127], v[92:95]
    s_waitcnt lgkmcnt(4)
    v_mfma_f32_16x16x32_bf16 v[96:99], v[148:151], v[124:127], v[96:99]
    ds_read_b64_tr_b16 v[144:145], v166 offset:0
    v_mfma_f32_16x16x32_bf16 v[68:71], v[148:151], v[120:123], v[68:71]
    ds_read_b64_tr_b16 v[146:147], v166 offset:1792
    v_mfma_f32_16x16x32_bf16 v[40:43], v[148:151], v[116:119], v[40:43]
    v_mfma_f32_16x16x32_bf16 v[12:15], v[148:151], v[112:115], v[12:15]
    s_waitcnt lgkmcnt(4)
    v_mfma_f32_16x16x32_bf16 v[16:19], v[152:155], v[112:115], v[16:19]
    ds_read_b64_tr_b16 v[148:149], v160 offset:14336
    v_mfma_f32_16x16x32_bf16 v[44:47], v[152:155], v[116:119], v[44:47]
    ds_read_b64_tr_b16 v[150:151], v160 offset:16128
    v_mfma_f32_16x16x32_bf16 v[72:75], v[152:155], v[120:123], v[72:75]
    ds_read_b128 v[128:131], v241 offset:0
    v_mfma_f32_16x16x32_bf16 v[100:103], v[152:155], v[124:127], v[100:103]
    ds_read_b128 v[132:135], v241 offset:2048
    s_waitcnt lgkmcnt(6)
    v_mfma_f32_16x16x32_bf16 v[104:107], v[156:159], v[124:127], v[104:107]
    ds_read_b64_tr_b16 v[152:153], v161 offset:14336
    v_mfma_f32_16x16x32_bf16 v[76:79], v[156:159], v[120:123], v[76:79]
    ds_read_b64_tr_b16 v[154:155], v161 offset:16128
    v_mfma_f32_16x16x32_bf16 v[48:51], v[156:159], v[116:119], v[48:51]
    ds_read_b128 v[136:139], v241 offset:4096
    v_mfma_f32_16x16x32_bf16 v[20:23], v[156:159], v[112:115], v[20:23]
    ds_read_b128 v[140:143], v241 offset:6144
    s_waitcnt lgkmcnt(8)
    v_mfma_f32_16x16x32_bf16 v[24:27], v[144:147], v[112:115], v[24:27]
    ds_read_b64_tr_b16 v[156:157], v162 offset:14336
    v_mfma_f32_16x16x32_bf16 v[52:55], v[144:147], v[116:119], v[52:55]
    ds_read_b64_tr_b16 v[158:159], v162 offset:16128
    v_mfma_f32_16x16x32_bf16 v[80:83], v[144:147], v[120:123], v[80:83]
    v_mfma_f32_16x16x32_bf16 v[108:111], v[144:147], v[124:127], v[108:111]
    s_waitcnt lgkmcnt(2)
    v_mfma_f32_16x16x32_bf16 v[0:3], v[148:151], v[128:131], v[0:3]
    ds_read_b64_tr_b16 v[144:145], v163 offset:14336
    v_mfma_f32_16x16x32_bf16 v[28:31], v[148:151], v[132:135], v[28:31]
    ds_read_b64_tr_b16 v[146:147], v163 offset:16128
    v_mfma_f32_16x16x32_bf16 v[56:59], v[148:151], v[136:139], v[56:59]
    ds_read_b32 v167, v171 offset:0
    v_mfma_f32_16x16x32_bf16 v[84:87], v[148:151], v[140:143], v[84:87]
    ds_read_b32 v168, v171 offset:128
    v_mfma_f32_16x16x32_bf16 v[88:91], v[152:155], v[140:143], v[88:91]
    ds_read_b64_tr_b16 v[148:149], v164 offset:14336
    v_mfma_f32_16x16x32_bf16 v[60:63], v[152:155], v[136:139], v[60:63]
    ds_read_b64_tr_b16 v[150:151], v164 offset:16128
    v_mfma_f32_16x16x32_bf16 v[32:35], v[152:155], v[132:135], v[32:35]
    ds_read_b32 v169, v171 offset:256
    v_mfma_f32_16x16x32_bf16 v[4:7], v[152:155], v[128:131], v[4:7]
    ds_read_b32 v170, v171 offset:384
    s_waitcnt lgkmcnt(8)
    v_mfma_f32_16x16x32_bf16 v[8:11], v[156:159], v[128:131], v[8:11]
    ds_read_b64_tr_b16 v[152:153], v165 offset:14336
    v_mfma_f32_16x16x32_bf16 v[36:39], v[156:159], v[132:135], v[36:39]
    ds_read_b64_tr_b16 v[154:155], v165 offset:16128
    v_mfma_f32_16x16x32_bf16 v[64:67], v[156:159], v[136:139], v[64:67]
    ds_read_b64 v[172:173], v172
    v_mfma_f32_16x16x32_bf16 v[92:95], v[156:159], v[140:143], v[92:95]
    ds_read_b64 v[176:177], v176
    s_waitcnt lgkmcnt(10)
    v_mfma_f32_16x16x32_bf16 v[96:99], v[144:147], v[140:143], v[96:99]
    ds_read_b64_tr_b16 v[156:157], v166 offset:14336
    v_mfma_f32_16x16x32_bf16 v[68:71], v[144:147], v[136:139], v[68:71]
    ds_read_b64_tr_b16 v[158:159], v166 offset:16128
    v_mfma_f32_16x16x32_bf16 v[40:43], v[144:147], v[132:135], v[40:43]
    ds_read_b64 v[180:181], v180
    v_mfma_f32_16x16x32_bf16 v[12:15], v[144:147], v[128:131], v[12:15]
    ds_read_b64 v[184:185], v184
    s_waitcnt lgkmcnt(10)
    v_mfma_f32_16x16x32_bf16 v[16:19], v[148:151], v[128:131], v[16:19]
    ds_read_b64 v[188:189], v188
    v_mfma_f32_16x16x32_bf16 v[44:47], v[148:151], v[132:135], v[44:47]
    ds_read_b64 v[192:193], v192
    v_mfma_f32_16x16x32_bf16 v[72:75], v[148:151], v[136:139], v[72:75]
    ds_read_b64 v[196:197], v196
    v_mfma_f32_16x16x32_bf16 v[100:103], v[148:151], v[140:143], v[100:103]
    s_waitcnt lgkmcnt(11)
    s_waitcnt lgkmcnt(9)
    v_mfma_f32_16x16x32_bf16 v[104:107], v[152:155], v[140:143], v[104:107]
    v_and_b32 v200, 0xffff, v167
    v_lshrrev_b32 v201, 16, v167
    v_mfma_f32_16x16x32_bf16 v[76:79], v[152:155], v[136:139], v[76:79]
    v_and_b32 v204, 0xffff, v168
    v_lshrrev_b32 v205, 16, v168
    v_mfma_f32_16x16x32_bf16 v[48:51], v[152:155], v[132:135], v[48:51]
    v_and_b32 v208, 0xffff, v169
    v_lshrrev_b32 v209, 16, v169
    v_mfma_f32_16x16x32_bf16 v[20:23], v[152:155], v[128:131], v[20:23]
    v_and_b32 v212, 0xffff, v170
    v_lshrrev_b32 v213, 16, v170
    s_waitcnt lgkmcnt(5)
    v_mfma_f32_16x16x32_bf16 v[24:27], v[156:159], v[128:131], v[24:27]
    v_lshl_or_b32 v200, v200, 16, v200
    v_cndmask_b32 v201, 0, v201, vcc
    v_mfma_f32_16x16x32_bf16 v[52:55], v[156:159], v[132:135], v[52:55]
    v_lshl_or_b32 v204, v204, 16, v204
    v_cndmask_b32 v205, 0, v205, vcc
    v_mfma_f32_16x16x32_bf16 v[80:83], v[156:159], v[136:139], v[80:83]
    v_lshl_or_b32 v208, v208, 16, v208
    v_cndmask_b32 v209, 0, v209, vcc
    v_mfma_f32_16x16x32_bf16 v[108:111], v[156:159], v[140:143], v[108:111]
    v_lshl_or_b32 v212, v212, 16, v212
    v_cndmask_b32 v213, 0, v213, vcc
    s_waitcnt lgkmcnt(0)
    v_mfma_f32_16x16x32_bf16 v[24:27], v[196:199], v[200:203], v[24:27]
    v_and_b32 v220, s97, v167
    v_mfma_f32_16x16x32_bf16 v[52:55], v[196:199], v[204:207], v[52:55]
    v_and_b32 v226, s97, v168
    v_mfma_f32_16x16x32_bf16 v[80:83], v[196:199], v[208:211], v[80:83]
    v_and_b32 v232, s97, v169
    v_mfma_f32_16x16x32_bf16 v[108:111], v[196:199], v[212:215], v[108:111]
    v_and_b32 v238, s97, v170
    v_mfma_f32_16x16x32_bf16 v[0:3], v[172:175], v[200:203], v[0:3]
    v_rcp_f32 v216, v220
    v_mfma_f32_16x16x32_bf16 v[28:31], v[172:175], v[204:207], v[28:31]
    v_rcp_f32 v222, v226
    v_mfma_f32_16x16x32_bf16 v[56:59], v[172:175], v[208:211], v[56:59]
    v_rcp_f32 v228, v232
    v_mfma_f32_16x16x32_bf16 v[84:87], v[172:175], v[212:215], v[84:87]
    v_rcp_f32 v234, v238
    v_mfma_f32_16x16x32_bf16 v[4:7], v[176:179], v[200:203], v[4:7]
    v_mul_f32 v217, 0x3fb8aa3b, v216
    v_mfma_f32_16x16x32_bf16 v[32:35], v[176:179], v[204:207], v[32:35]
    v_mul_f32 v218, 0xc0135761, v216
    v_mfma_f32_16x16x32_bf16 v[60:63], v[176:179], v[208:211], v[60:63]
    v_mul_f32 v219, v216, v216
    v_mfma_f32_16x16x32_bf16 v[88:91], v[176:179], v[212:215], v[88:91]
    v_mul_f32 v223, 0x3fb8aa3b, v222
    v_mfma_f32_16x16x32_bf16 v[8:11], v[180:183], v[200:203], v[8:11]
    v_mul_f32 v224, 0xc0135761, v222
    v_mfma_f32_16x16x32_bf16 v[36:39], v[180:183], v[204:207], v[36:39]
    v_mul_f32 v225, v222, v222
    v_mfma_f32_16x16x32_bf16 v[64:67], v[180:183], v[208:211], v[64:67]
    v_mul_f32 v229, 0x3fb8aa3b, v228
    v_mfma_f32_16x16x32_bf16 v[92:95], v[180:183], v[212:215], v[92:95]
    v_mul_f32 v230, 0xc0135761, v228
    v_mfma_f32_16x16x32_bf16 v[12:15], v[184:187], v[200:203], v[12:15]
    v_mul_f32 v231, v228, v228
    v_mfma_f32_16x16x32_bf16 v[40:43], v[184:187], v[204:207], v[40:43]
    v_mul_f32 v235, 0x3fb8aa3b, v234
    v_mfma_f32_16x16x32_bf16 v[68:71], v[184:187], v[208:211], v[68:71]
    v_mul_f32 v236, 0xc0135761, v234
    v_mfma_f32_16x16x32_bf16 v[96:99], v[184:187], v[212:215], v[96:99]
    v_mul_f32 v237, v234, v234
    v_mfma_f32_16x16x32_bf16 v[16:19], v[188:191], v[200:203], v[16:19]
    v_mul_f32 v219, v219, v218
    v_mfma_f32_16x16x32_bf16 v[44:47], v[188:191], v[204:207], v[44:47]
    v_mul_f32 v225, v225, v224
    v_mfma_f32_16x16x32_bf16 v[72:75], v[188:191], v[208:211], v[72:75]
    v_mul_f32 v231, v231, v230
    v_mfma_f32_16x16x32_bf16 v[100:103], v[188:191], v[212:215], v[100:103]
    v_mul_f32 v237, v237, v236
    v_mfma_f32_16x16x32_bf16 v[20:23], v[192:195], v[200:203], v[20:23]
    v_mul_f32 v219, 0x3d372713, v219
    v_mfma_f32_16x16x32_bf16 v[48:51], v[192:195], v[204:207], v[48:51]
    v_mul_f32 v225, 0x3d372713, v225
    v_mfma_f32_16x16x32_bf16 v[76:79], v[192:195], v[208:211], v[76:79]
    v_mul_f32 v231, 0x3d372713, v231
    v_mfma_f32_16x16x32_bf16 v[104:107], v[192:195], v[212:215], v[104:107]
    v_mul_f32 v237, 0x3d372713, v237
    v_mov_b32 v112, 163328
    v_mov_b32 v113, 1
    s_mov_b64 exec, 1
    ds_add_u32 v112, v113
    s_mov_b64 exec, -1
    s_cmp_eq_u32 s50, 0
    s_cbranch_scc1 L_ep_kvq
    v_mov_b32 v112, 163360
    v_mov_b32 v113, 1
    s_mov_b64 exec, 1
    ds_add_u32 v112, v113
    s_mov_b64 exec, -1
    s_cmp_eq_u32 s50, 2
    s_cbranch_scc1 L_ep_qx
    s_and_b32 s60, s26, 1
    s_lshl_b32 s60, s60, 12
    s_add_u32 s60, s60, 30720
    s_lshr_b32 s61, s26, 1
    s_lshl_b32 s62, s61, 3
    s_add_u32 s62, s62, s60
    v_add_u32 v114, s62, v254
    s_lshl_b32 s61, s61, 11
    s_add_u32 s61, s61, s60
    v_add_u32 v115, s61, v254
    v_mov_b32 v116, 163348
    v_mov_b32 v117, 1
.p2align 3
    v_pk_mul_f32 v[144:145], v[24:25], v[24:25]
    v_pk_mul_f32 v[146:147], v[26:27], v[26:27]
    v_pk_mul_f32 v[148:149], v[52:53], v[52:53]
    v_pk_mul_f32 v[150:151], v[54:55], v[54:55]
    v_pk_fma_f32 v[144:145], v[144:145], v[218:219], v[218:219] op_sel:[0,1,0] op_sel_hi:[1,1,0]
    v_pk_fma_f32 v[146:147], v[146:147], v[218:219], v[218:219] op_sel:[0,1,0] op_sel_hi:[1,1,0]
    v_pk_fma_f32 v[148:149], v[148:149], v[224:225], v[224:225] op_sel:[0,1,0] op_sel_hi:[1,1,0]
    v_pk_fma_f32 v[150:151], v[150:151], v[224:225], v[224:225] op_sel:[0,1,0] op_sel_hi:[1,1,0]
    v_pk_mul_f32 v[144:145], v[144:145], v[24:25]
    v_pk_mul_f32 v[146:147], v[146:147], v[26:27]
    v_pk_mul_f32 v[148:149], v[148:149], v[52:53]
    v_pk_mul_f32 v[150:151], v[150:151], v[54:55]
    v_exp_f32_e64 v144, v144
    v_pk_mul_f32 v[152:153], v[80:81], v[80:81]
    v_exp_f32_e64 v145, v145
    v_pk_mul_f32 v[154:155], v[82:83], v[82:83]
    v_exp_f32_e64 v146, v146
    v_exp_f32_e64 v147, v147
    v_pk_mul_f32 v[156:157], v[108:109], v[108:109]
    v_exp_f32_e64 v148, v148
    v_exp_f32_e64 v149, v149
    v_pk_mul_f32 v[158:159], v[110:111], v[110:111]
    v_exp_f32_e64 v150, v150
    v_pk_fma_f32 v[152:153], v[152:153], v[230:231], v[230:231] op_sel:[0,1,0] op_sel_hi:[1,1,0]
    v_exp_f32_e64 v151, v151
    v_pk_fma_f32 v[144:145], v[144:145], v[220:221], v[220:221] op_sel_hi:[1,0,0]
    v_pk_fma_f32 v[154:155], v[154:155], v[230:231], v[230:231] op_sel:[0,1,0] op_sel_hi:[1,1,0]
    v_pk_fma_f32 v[146:147], v[146:147], v[220:221], v[220:221] op_sel_hi:[1,0,0]
    v_pk_fma_f32 v[148:149], v[148:149], v[226:227], v[226:227] op_sel_hi:[1,0,0]
    v_pk_fma_f32 v[156:157], v[156:157], v[236:237], v[236:237] op_sel:[0,1,0] op_sel_hi:[1,1,0]
    v_pk_fma_f32 v[150:151], v[150:151], v[226:227], v[226:227] op_sel_hi:[1,0,0]
    v_pk_fma_f32 v[158:159], v[158:159], v[236:237], v[236:237] op_sel:[0,1,0] op_sel_hi:[1,1,0]
    v_rcp_f32_e64 v144, v144
    v_rcp_f32_e64 v145, v145
    v_pk_mul_f32 v[152:153], v[152:153], v[80:81]
    v_rcp_f32_e64 v146, v146
    v_rcp_f32_e64 v147, v147
    v_pk_mul_f32 v[154:155], v[154:155], v[82:83]
    v_rcp_f32_e64 v148, v148
    v_pk_mul_f32 v[156:157], v[156:157], v[108:109]
    v_rcp_f32_e64 v149, v149
    v_rcp_f32_e64 v150, v150
    v_pk_mul_f32 v[158:159], v[158:159], v[110:111]
    v_rcp_f32_e64 v151, v151
    v_exp_f32_e64 v152, v152
    v_pk_mul_f32 v[144:145], v[144:145], v[24:25]
    v_pk_mul_f32 v[146:147], v[146:147], v[26:27]
    v_exp_f32_e64 v153, v153
    v_pk_mul_f32 v[148:149], v[148:149], v[52:53]
    v_exp_f32_e64 v154, v154
    v_pk_mul_f32 v[150:151], v[150:151], v[54:55]
    v_exp_f32_e64 v155, v155
    v_cvt_pk_bf16_f32 v24, v144, v145
    v_exp_f32_e64 v156, v156
    v_cvt_pk_bf16_f32 v25, v146, v147
    v_exp_f32_e64 v157, v157
    v_cvt_pk_bf16_f32 v52, v148, v149
    v_exp_f32_e64 v158, v158
    v_cvt_pk_bf16_f32 v53, v150, v151
    v_exp_f32_e64 v159, v159
    ds_write_b64 v114, v[24:25] offset:0
    v_pk_fma_f32 v[152:153], v[152:153], v[232:233], v[232:233] op_sel_hi:[1,0,0]
    ds_write_b64 v114, v[52:53] offset:1024
    v_pk_fma_f32 v[154:155], v[154:155], v[232:233], v[232:233] op_sel_hi:[1,0,0]
    v_pk_mul_f32 v[144:145], v[0:1], v[0:1]
    v_pk_fma_f32 v[156:157], v[156:157], v[238:239], v[238:239] op_sel_hi:[1,0,0]
    v_pk_mul_f32 v[146:147], v[2:3], v[2:3]
    v_pk_mul_f32 v[148:149], v[4:5], v[4:5]
    v_pk_fma_f32 v[158:159], v[158:159], v[238:239], v[238:239] op_sel_hi:[1,0,0]
    v_pk_mul_f32 v[150:151], v[6:7], v[6:7]
    v_rcp_f32_e64 v152, v152
    v_pk_fma_f32 v[144:145], v[144:145], v[218:219], v[218:219] op_sel:[0,1,0] op_sel_hi:[1,1,0]
    v_rcp_f32_e64 v153, v153
    v_pk_fma_f32 v[146:147], v[146:147], v[218:219], v[218:219] op_sel:[0,1,0] op_sel_hi:[1,1,0]
    v_rcp_f32_e64 v154, v154
    v_pk_fma_f32 v[148:149], v[148:149], v[218:219], v[218:219] op_sel:[0,1,0] op_sel_hi:[1,1,0]
    v_rcp_f32_e64 v155, v155
    v_pk_fma_f32 v[150:151], v[150:151], v[218:219], v[218:219] op_sel:[0,1,0] op_sel_hi:[1,1,0]
    v_rcp_f32_e64 v156, v156
    v_pk_mul_f32 v[144:145], v[144:145], v[0:1]
    v_rcp_f32_e64 v157, v157
    v_pk_mul_f32 v[146:147], v[146:147], v[2:3]
    v_rcp_f32_e64 v158, v158
    v_pk_mul_f32 v[148:149], v[148:149], v[4:5]
    v_rcp_f32_e64 v159, v159
    v_pk_mul_f32 v[150:151], v[150:151], v[6:7]
    v_exp_f32_e64 v144, v144
    v_pk_mul_f32 v[152:153], v[152:153], v[80:81]
    v_pk_mul_f32 v[154:155], v[154:155], v[82:83]
    v_exp_f32_e64 v145, v145
    v_pk_mul_f32 v[156:157], v[156:157], v[108:109]
    v_exp_f32_e64 v146, v146
    v_pk_mul_f32 v[158:159], v[158:159], v[110:111]
    v_exp_f32_e64 v147, v147
    v_cvt_pk_bf16_f32 v80, v152, v153
    v_exp_f32_e64 v148, v148
    v_cvt_pk_bf16_f32 v81, v154, v155
    v_exp_f32_e64 v149, v149
    v_cvt_pk_bf16_f32 v108, v156, v157
    v_exp_f32_e64 v150, v150
    v_cvt_pk_bf16_f32 v109, v158, v159
    v_exp_f32_e64 v151, v151
    ds_write_b64 v114, v[80:81] offset:2048
    v_pk_fma_f32 v[144:145], v[144:145], v[220:221], v[220:221] op_sel_hi:[1,0,0]
    ds_write_b64 v114, v[108:109] offset:3072
    v_pk_fma_f32 v[146:147], v[146:147], v[220:221], v[220:221] op_sel_hi:[1,0,0]
    v_pk_mul_f32 v[152:153], v[28:29], v[28:29]
    v_pk_fma_f32 v[148:149], v[148:149], v[220:221], v[220:221] op_sel_hi:[1,0,0]
    v_pk_mul_f32 v[154:155], v[30:31], v[30:31]
    v_pk_mul_f32 v[156:157], v[32:33], v[32:33]
    v_pk_fma_f32 v[150:151], v[150:151], v[220:221], v[220:221] op_sel_hi:[1,0,0]
    v_pk_mul_f32 v[158:159], v[34:35], v[34:35]
    v_rcp_f32_e64 v144, v144
    v_pk_fma_f32 v[152:153], v[152:153], v[224:225], v[224:225] op_sel:[0,1,0] op_sel_hi:[1,1,0]
    v_rcp_f32_e64 v145, v145
    v_pk_fma_f32 v[154:155], v[154:155], v[224:225], v[224:225] op_sel:[0,1,0] op_sel_hi:[1,1,0]
    v_rcp_f32_e64 v146, v146
    v_pk_fma_f32 v[156:157], v[156:157], v[224:225], v[224:225] op_sel:[0,1,0] op_sel_hi:[1,1,0]
    v_rcp_f32_e64 v147, v147
    v_pk_fma_f32 v[158:159], v[158:159], v[224:225], v[224:225] op_sel:[0,1,0] op_sel_hi:[1,1,0]
    v_rcp_f32_e64 v148, v148
    v_pk_mul_f32 v[152:153], v[152:153], v[28:29]
    v_rcp_f32_e64 v149, v149
    v_pk_mul_f32 v[154:155], v[154:155], v[30:31]
    v_rcp_f32_e64 v150, v150
    v_pk_mul_f32 v[156:157], v[156:157], v[32:33]
    v_rcp_f32_e64 v151, v151
    v_pk_mul_f32 v[158:159], v[158:159], v[34:35]
    v_exp_f32_e64 v152, v152
    v_pk_mul_f32 v[144:145], v[144:145], v[0:1]
    v_pk_mul_f32 v[146:147], v[146:147], v[2:3]
    v_exp_f32_e64 v153, v153
    v_pk_mul_f32 v[148:149], v[148:149], v[4:5]
    v_exp_f32_e64 v154, v154
    v_pk_mul_f32 v[150:151], v[150:151], v[6:7]
    v_exp_f32_e64 v155, v155
    v_cvt_pk_bf16_f32 v0, v144, v145
    v_exp_f32_e64 v156, v156
    v_cvt_pk_bf16_f32 v1, v146, v147
    v_exp_f32_e64 v157, v157
    v_cvt_pk_bf16_f32 v2, v148, v149
    v_exp_f32_e64 v158, v158
    v_cvt_pk_bf16_f32 v3, v150, v151
    v_exp_f32_e64 v159, v159
    buffer_store_dwordx4 v[0:3], v249, s[36:39], s64 offen sc1
    v_pk_fma_f32 v[152:153], v[152:153], v[226:227], v[226:227] op_sel_hi:[1,0,0]
    v_pk_mul_f32 v[144:145], v[56:57], v[56:57]
    v_pk_fma_f32 v[154:155], v[154:155], v[226:227], v[226:227] op_sel_hi:[1,0,0]
    v_pk_mul_f32 v[146:147], v[58:59], v[58:59]
    v_pk_fma_f32 v[156:157], v[156:157], v[226:227], v[226:227] op_sel_hi:[1,0,0]
    v_pk_mul_f32 v[148:149], v[60:61], v[60:61]
    v_pk_fma_f32 v[158:159], v[158:159], v[226:227], v[226:227] op_sel_hi:[1,0,0]
    v_pk_mul_f32 v[150:151], v[62:63], v[62:63]
    v_rcp_f32_e64 v152, v152
    v_pk_fma_f32 v[144:145], v[144:145], v[230:231], v[230:231] op_sel:[0,1,0] op_sel_hi:[1,1,0]
    v_rcp_f32_e64 v153, v153
    v_pk_fma_f32 v[146:147], v[146:147], v[230:231], v[230:231] op_sel:[0,1,0] op_sel_hi:[1,1,0]
    v_rcp_f32_e64 v154, v154
    v_pk_fma_f32 v[148:149], v[148:149], v[230:231], v[230:231] op_sel:[0,1,0] op_sel_hi:[1,1,0]
    v_rcp_f32_e64 v155, v155
    v_pk_fma_f32 v[150:151], v[150:151], v[230:231], v[230:231] op_sel:[0,1,0] op_sel_hi:[1,1,0]
    v_rcp_f32_e64 v156, v156
    v_pk_mul_f32 v[144:145], v[144:145], v[56:57]
    v_rcp_f32_e64 v157, v157
    v_pk_mul_f32 v[146:147], v[146:147], v[58:59]
    v_rcp_f32_e64 v158, v158
    v_pk_mul_f32 v[148:149], v[148:149], v[60:61]
    v_rcp_f32_e64 v159, v159
    v_pk_mul_f32 v[150:151], v[150:151], v[62:63]
    v_exp_f32_e64 v144, v144
    v_pk_mul_f32 v[152:153], v[152:153], v[28:29]
    v_pk_mul_f32 v[154:155], v[154:155], v[30:31]
    v_exp_f32_e64 v145, v145
    v_pk_mul_f32 v[156:157], v[156:157], v[32:33]
    v_exp_f32_e64 v146, v146
    v_pk_mul_f32 v[158:159], v[158:159], v[34:35]
    v_exp_f32_e64 v147, v147
    v_cvt_pk_bf16_f32 v28, v152, v153
    v_exp_f32_e64 v148, v148
    v_cvt_pk_bf16_f32 v29, v154, v155
    v_exp_f32_e64 v149, v149
    v_cvt_pk_bf16_f32 v30, v156, v157
    v_exp_f32_e64 v150, v150
    v_cvt_pk_bf16_f32 v31, v158, v159
    v_exp_f32_e64 v151, v151
    buffer_store_dwordx4 v[28:31], v249, s[36:39], s65 offen sc1
    v_pk_fma_f32 v[144:145], v[144:145], v[232:233], v[232:233] op_sel_hi:[1,0,0]
    s_waitcnt lgkmcnt(0)
    s_mov_b64 exec, 1
    ds_add_u32 v116, v117
    s_mov_b64 exec, -1
.p2align 3
    v_pk_fma_f32 v[146:147], v[146:147], v[232:233], v[232:233] op_sel_hi:[1,0,0]
    v_pk_mul_f32 v[152:153], v[84:85], v[84:85]
    v_pk_fma_f32 v[148:149], v[148:149], v[232:233], v[232:233] op_sel_hi:[1,0,0]
    v_pk_mul_f32 v[154:155], v[86:87], v[86:87]
    v_pk_mul_f32 v[156:157], v[88:89], v[88:89]
    v_pk_fma_f32 v[150:151], v[150:151], v[232:233], v[232:233] op_sel_hi:[1,0,0]
    v_pk_mul_f32 v[158:159], v[90:91], v[90:91]
    v_rcp_f32_e64 v144, v144
    v_pk_fma_f32 v[152:153], v[152:153], v[236:237], v[236:237] op_sel:[0,1,0] op_sel_hi:[1,1,0]
    v_rcp_f32_e64 v145, v145
    v_pk_fma_f32 v[154:155], v[154:155], v[236:237], v[236:237] op_sel:[0,1,0] op_sel_hi:[1,1,0]
    v_rcp_f32_e64 v146, v146
    v_pk_fma_f32 v[156:157], v[156:157], v[236:237], v[236:237] op_sel:[0,1,0] op_sel_hi:[1,1,0]
    v_rcp_f32_e64 v147, v147
    v_pk_fma_f32 v[158:159], v[158:159], v[236:237], v[236:237] op_sel:[0,1,0] op_sel_hi:[1,1,0]
    v_rcp_f32_e64 v148, v148
    v_pk_mul_f32 v[152:153], v[152:153], v[84:85]
    v_rcp_f32_e64 v149, v149
    v_pk_mul_f32 v[154:155], v[154:155], v[86:87]
    v_rcp_f32_e64 v150, v150
    v_pk_mul_f32 v[156:157], v[156:157], v[88:89]
    v_rcp_f32_e64 v151, v151
    v_pk_mul_f32 v[158:159], v[158:159], v[90:91]
    v_exp_f32_e64 v152, v152
    v_pk_mul_f32 v[144:145], v[144:145], v[56:57]
    v_pk_mul_f32 v[146:147], v[146:147], v[58:59]
    v_exp_f32_e64 v153, v153
    v_pk_mul_f32 v[148:149], v[148:149], v[60:61]
    v_exp_f32_e64 v154, v154
    v_pk_mul_f32 v[150:151], v[150:151], v[62:63]
    v_exp_f32_e64 v155, v155
    v_cvt_pk_bf16_f32 v56, v144, v145
    v_exp_f32_e64 v156, v156
    v_cvt_pk_bf16_f32 v57, v146, v147
    v_exp_f32_e64 v157, v157
    v_cvt_pk_bf16_f32 v58, v148, v149
    v_exp_f32_e64 v158, v158
    v_cvt_pk_bf16_f32 v59, v150, v151
    v_exp_f32_e64 v159, v159
    buffer_store_dwordx4 v[56:59], v249, s[36:39], s66 offen sc1
    v_pk_fma_f32 v[152:153], v[152:153], v[238:239], v[238:239] op_sel_hi:[1,0,0]
    v_pk_mul_f32 v[144:145], v[8:9], v[8:9]
    v_pk_fma_f32 v[154:155], v[154:155], v[238:239], v[238:239] op_sel_hi:[1,0,0]
    v_pk_mul_f32 v[146:147], v[10:11], v[10:11]
    v_pk_fma_f32 v[156:157], v[156:157], v[238:239], v[238:239] op_sel_hi:[1,0,0]
    v_pk_mul_f32 v[148:149], v[12:13], v[12:13]
    v_pk_fma_f32 v[158:159], v[158:159], v[238:239], v[238:239] op_sel_hi:[1,0,0]
    v_pk_mul_f32 v[150:151], v[14:15], v[14:15]
    v_rcp_f32_e64 v152, v152
    v_pk_fma_f32 v[144:145], v[144:145], v[218:219], v[218:219] op_sel:[0,1,0] op_sel_hi:[1,1,0]
    v_rcp_f32_e64 v153, v153
    v_pk_fma_f32 v[146:147], v[146:147], v[218:219], v[218:219] op_sel:[0,1,0] op_sel_hi:[1,1,0]
    v_rcp_f32_e64 v154, v154
    v_pk_fma_f32 v[148:149], v[148:149], v[218:219], v[218:219] op_sel:[0,1,0] op_sel_hi:[1,1,0]
    v_rcp_f32_e64 v155, v155
    v_pk_fma_f32 v[150:151], v[150:151], v[218:219], v[218:219] op_sel:[0,1,0] op_sel_hi:[1,1,0]
    v_rcp_f32_e64 v156, v156
    v_pk_mul_f32 v[144:145], v[144:145], v[8:9]
    v_rcp_f32_e64 v157, v157
    v_pk_mul_f32 v[146:147], v[146:147], v[10:11]
    v_rcp_f32_e64 v158, v158
    v_pk_mul_f32 v[148:149], v[148:149], v[12:13]
    v_rcp_f32_e64 v159, v159
    v_pk_mul_f32 v[150:151], v[150:151], v[14:15]
    v_exp_f32_e64 v144, v144
    v_pk_mul_f32 v[152:153], v[152:153], v[84:85]
    v_pk_mul_f32 v[154:155], v[154:155], v[86:87]
    v_exp_f32_e64 v145, v145
    v_pk_mul_f32 v[156:157], v[156:157], v[88:89]
    v_exp_f32_e64 v146, v146
    v_pk_mul_f32 v[158:159], v[158:159], v[90:91]
    v_exp_f32_e64 v147, v147
    v_cvt_pk_bf16_f32 v84, v152, v153
    v_exp_f32_e64 v148, v148
    v_cvt_pk_bf16_f32 v85, v154, v155
    v_exp_f32_e64 v149, v149
    v_cvt_pk_bf16_f32 v86, v156, v157
    v_exp_f32_e64 v150, v150
    v_cvt_pk_bf16_f32 v87, v158, v159
    v_exp_f32_e64 v151, v151
    buffer_store_dwordx4 v[84:87], v249, s[36:39], s67 offen sc1
    v_pk_fma_f32 v[144:145], v[144:145], v[220:221], v[220:221] op_sel_hi:[1,0,0]
    v_pk_mul_f32 v[152:153], v[36:37], v[36:37]
    v_pk_fma_f32 v[146:147], v[146:147], v[220:221], v[220:221] op_sel_hi:[1,0,0]
    v_pk_mul_f32 v[154:155], v[38:39], v[38:39]
    v_pk_fma_f32 v[148:149], v[148:149], v[220:221], v[220:221] op_sel_hi:[1,0,0]
    v_pk_mul_f32 v[156:157], v[40:41], v[40:41]
    v_pk_fma_f32 v[150:151], v[150:151], v[220:221], v[220:221] op_sel_hi:[1,0,0]
    v_pk_mul_f32 v[158:159], v[42:43], v[42:43]
    v_rcp_f32_e64 v144, v144
    v_pk_fma_f32 v[152:153], v[152:153], v[224:225], v[224:225] op_sel:[0,1,0] op_sel_hi:[1,1,0]
    v_rcp_f32_e64 v145, v145
    v_pk_fma_f32 v[154:155], v[154:155], v[224:225], v[224:225] op_sel:[0,1,0] op_sel_hi:[1,1,0]
    v_rcp_f32_e64 v146, v146
    v_pk_fma_f32 v[156:157], v[156:157], v[224:225], v[224:225] op_sel:[0,1,0] op_sel_hi:[1,1,0]
    v_rcp_f32_e64 v147, v147
    v_pk_fma_f32 v[158:159], v[158:159], v[224:225], v[224:225] op_sel:[0,1,0] op_sel_hi:[1,1,0]
    v_rcp_f32_e64 v148, v148
    v_pk_mul_f32 v[152:153], v[152:153], v[36:37]
    v_rcp_f32_e64 v149, v149
    v_pk_mul_f32 v[154:155], v[154:155], v[38:39]
    v_rcp_f32_e64 v150, v150
    v_pk_mul_f32 v[156:157], v[156:157], v[40:41]
    v_rcp_f32_e64 v151, v151
    v_pk_mul_f32 v[158:159], v[158:159], v[42:43]
    v_exp_f32_e64 v152, v152
    v_pk_mul_f32 v[144:145], v[144:145], v[8:9]
    v_exp_f32_e64 v153, v153
    v_exp_f32_e64 v154, v154
    v_pk_mul_f32 v[146:147], v[146:147], v[10:11]
    v_exp_f32_e64 v155, v155
    v_exp_f32_e64 v156, v156
    v_pk_mul_f32 v[148:149], v[148:149], v[12:13]
    v_exp_f32_e64 v157, v157
    v_exp_f32_e64 v158, v158
    v_pk_mul_f32 v[150:151], v[150:151], v[14:15]
    v_exp_f32_e64 v159, v159
    v_pk_fma_f32 v[152:153], v[152:153], v[226:227], v[226:227] op_sel_hi:[1,0,0]
    v_cvt_pk_bf16_f32 v8, v144, v145
    v_pk_fma_f32 v[154:155], v[154:155], v[226:227], v[226:227] op_sel_hi:[1,0,0]
    v_pk_fma_f32 v[156:157], v[156:157], v[226:227], v[226:227] op_sel_hi:[1,0,0]
    v_pk_fma_f32 v[158:159], v[158:159], v[226:227], v[226:227] op_sel_hi:[1,0,0]
    v_cvt_pk_bf16_f32 v9, v146, v147
    v_rcp_f32_e64 v152, v152
    v_rcp_f32_e64 v153, v153
    v_cvt_pk_bf16_f32 v10, v148, v149
    v_rcp_f32_e64 v154, v154
    v_rcp_f32_e64 v155, v155
    v_cvt_pk_bf16_f32 v11, v150, v151
    v_rcp_f32_e64 v156, v156
    v_rcp_f32_e64 v157, v157
    buffer_store_dwordx4 v[8:11], v250, s[36:39], s64 offen sc1
    v_rcp_f32_e64 v158, v158
    v_rcp_f32_e64 v159, v159
    v_pk_mul_f32 v[152:153], v[152:153], v[36:37]
    v_pk_mul_f32 v[154:155], v[154:155], v[38:39]
    v_pk_mul_f32 v[156:157], v[156:157], v[40:41]
    v_pk_mul_f32 v[158:159], v[158:159], v[42:43]
    v_cvt_pk_bf16_f32 v36, v152, v153
    v_cvt_pk_bf16_f32 v37, v154, v155
    v_cvt_pk_bf16_f32 v38, v156, v157
    v_cvt_pk_bf16_f32 v39, v158, v159
    buffer_store_dwordx4 v[36:39], v250, s[36:39], s65 offen sc1
    s_mov_b32 s96, 800000
    v_mov_b32 v118, 163348
L_lw16:
    ds_read_b32 v119, v118
    s_waitcnt lgkmcnt(0)
    v_readfirstlane_b32 s60, v119
    s_nop 0
    s_cmp_ge_u32 s60, 4
    s_cbranch_scc1 L_lwe17
    s_sleep 1
    s_sub_u32 s96, s96, 1
    s_cmp_lg_u32 s96, 0
    s_cbranch_scc1 L_lw16
L_lwe17:
    ds_read_b128 v[120:123], v115
    ds_read_b128 v[124:127], v115 offset:1024
.p2align 3
    v_pk_mul_f32 v[144:145], v[64:65], v[64:65]
    v_pk_mul_f32 v[146:147], v[66:67], v[66:67]
    v_pk_mul_f32 v[148:149], v[68:69], v[68:69]
    v_pk_mul_f32 v[150:151], v[70:71], v[70:71]
    v_pk_fma_f32 v[144:145], v[144:145], v[230:231], v[230:231] op_sel:[0,1,0] op_sel_hi:[1,1,0]
    v_pk_fma_f32 v[146:147], v[146:147], v[230:231], v[230:231] op_sel:[0,1,0] op_sel_hi:[1,1,0]
    v_pk_fma_f32 v[148:149], v[148:149], v[230:231], v[230:231] op_sel:[0,1,0] op_sel_hi:[1,1,0]
    v_pk_fma_f32 v[150:151], v[150:151], v[230:231], v[230:231] op_sel:[0,1,0] op_sel_hi:[1,1,0]
    v_pk_mul_f32 v[144:145], v[144:145], v[64:65]
    v_pk_mul_f32 v[146:147], v[146:147], v[66:67]
    v_pk_mul_f32 v[148:149], v[148:149], v[68:69]
    v_pk_mul_f32 v[150:151], v[150:151], v[70:71]
    v_exp_f32_e64 v144, v144
    v_pk_mul_f32 v[152:153], v[92:93], v[92:93]
    v_exp_f32_e64 v145, v145
    v_pk_mul_f32 v[154:155], v[94:95], v[94:95]
    v_exp_f32_e64 v146, v146
    v_exp_f32_e64 v147, v147
    v_pk_mul_f32 v[156:157], v[96:97], v[96:97]
    v_exp_f32_e64 v148, v148
    v_exp_f32_e64 v149, v149
    v_pk_mul_f32 v[158:159], v[98:99], v[98:99]
    v_exp_f32_e64 v150, v150
    v_pk_fma_f32 v[152:153], v[152:153], v[236:237], v[236:237] op_sel:[0,1,0] op_sel_hi:[1,1,0]
    v_exp_f32_e64 v151, v151
    v_pk_fma_f32 v[144:145], v[144:145], v[232:233], v[232:233] op_sel_hi:[1,0,0]
    v_pk_fma_f32 v[154:155], v[154:155], v[236:237], v[236:237] op_sel:[0,1,0] op_sel_hi:[1,1,0]
    v_pk_fma_f32 v[146:147], v[146:147], v[232:233], v[232:233] op_sel_hi:[1,0,0]
    v_pk_fma_f32 v[148:149], v[148:149], v[232:233], v[232:233] op_sel_hi:[1,0,0]
    v_pk_fma_f32 v[156:157], v[156:157], v[236:237], v[236:237] op_sel:[0,1,0] op_sel_hi:[1,1,0]
    v_pk_fma_f32 v[150:151], v[150:151], v[232:233], v[232:233] op_sel_hi:[1,0,0]
    v_pk_fma_f32 v[158:159], v[158:159], v[236:237], v[236:237] op_sel:[0,1,0] op_sel_hi:[1,1,0]
    v_rcp_f32_e64 v144, v144
    v_rcp_f32_e64 v145, v145
    v_pk_mul_f32 v[152:153], v[152:153], v[92:93]
    v_rcp_f32_e64 v146, v146
    v_rcp_f32_e64 v147, v147
    v_pk_mul_f32 v[154:155], v[154:155], v[94:95]
    v_rcp_f32_e64 v148, v148
    v_pk_mul_f32 v[156:157], v[156:157], v[96:97]
    v_rcp_f32_e64 v149, v149
    v_rcp_f32_e64 v150, v150
    v_pk_mul_f32 v[158:159], v[158:159], v[98:99]
    v_rcp_f32_e64 v151, v151
    v_exp_f32_e64 v152, v152
    v_pk_mul_f32 v[144:145], v[144:145], v[64:65]
    v_pk_mul_f32 v[146:147], v[146:147], v[66:67]
    v_exp_f32_e64 v153, v153
    v_pk_mul_f32 v[148:149], v[148:149], v[68:69]
    v_exp_f32_e64 v154, v154
    v_pk_mul_f32 v[150:151], v[150:151], v[70:71]
    v_exp_f32_e64 v155, v155
    v_cvt_pk_bf16_f32 v64, v144, v145
    v_exp_f32_e64 v156, v156
    v_cvt_pk_bf16_f32 v65, v146, v147
    v_exp_f32_e64 v157, v157
    v_cvt_pk_bf16_f32 v66, v148, v149
    v_cvt_pk_bf16_f32 v67, v150, v151
    v_exp_f32_e64 v158, v158
    buffer_store_dwordx4 v[64:67], v250, s[36:39], s66 offen sc1
    v_exp_f32_e64 v159, v159
    s_waitcnt lgkmcnt(0)
.p2align 3
    v_pk_fma_f32 v[152:153], v[152:153], v[238:239], v[238:239] op_sel_hi:[1,0,0]
    buffer_store_dwordx4 v[120:123], v254, s[36:39], s73 offen sc1
    v_pk_fma_f32 v[154:155], v[154:155], v[238:239], v[238:239] op_sel_hi:[1,0,0]
    buffer_store_dwordx4 v[124:127], v254, s[36:39], s74 offen sc1
    v_pk_fma_f32 v[156:157], v[156:157], v[238:239], v[238:239] op_sel_hi:[1,0,0]
    v_pk_mul_f32 v[144:145], v[16:17], v[16:17]
    v_pk_mul_f32 v[146:147], v[18:19], v[18:19]
    v_pk_fma_f32 v[158:159], v[158:159], v[238:239], v[238:239] op_sel_hi:[1,0,0]
    v_pk_mul_f32 v[148:149], v[20:21], v[20:21]
    v_rcp_f32_e64 v152, v152
    v_pk_mul_f32 v[150:151], v[22:23], v[22:23]
    v_rcp_f32_e64 v153, v153
    v_pk_fma_f32 v[144:145], v[144:145], v[218:219], v[218:219] op_sel:[0,1,0] op_sel_hi:[1,1,0]
    v_rcp_f32_e64 v154, v154
    v_pk_fma_f32 v[146:147], v[146:147], v[218:219], v[218:219] op_sel:[0,1,0] op_sel_hi:[1,1,0]
    v_rcp_f32_e64 v155, v155
    v_pk_fma_f32 v[148:149], v[148:149], v[218:219], v[218:219] op_sel:[0,1,0] op_sel_hi:[1,1,0]
    v_pk_fma_f32 v[150:151], v[150:151], v[218:219], v[218:219] op_sel:[0,1,0] op_sel_hi:[1,1,0]
    v_rcp_f32_e64 v156, v156
    v_pk_mul_f32 v[144:145], v[144:145], v[16:17]
    v_rcp_f32_e64 v157, v157
    v_pk_mul_f32 v[146:147], v[146:147], v[18:19]
    v_rcp_f32_e64 v158, v158
    v_pk_mul_f32 v[148:149], v[148:149], v[20:21]
    v_rcp_f32_e64 v159, v159
    v_pk_mul_f32 v[150:151], v[150:151], v[22:23]
    v_exp_f32_e64 v144, v144
    v_pk_mul_f32 v[152:153], v[152:153], v[92:93]
    v_pk_mul_f32 v[154:155], v[154:155], v[94:95]
    v_exp_f32_e64 v145, v145
    v_pk_mul_f32 v[156:157], v[156:157], v[96:97]
    v_exp_f32_e64 v146, v146
    v_pk_mul_f32 v[158:159], v[158:159], v[98:99]
    v_exp_f32_e64 v147, v147
    v_cvt_pk_bf16_f32 v92, v152, v153
    v_exp_f32_e64 v148, v148
    v_cvt_pk_bf16_f32 v93, v154, v155
    v_exp_f32_e64 v149, v149
    v_cvt_pk_bf16_f32 v94, v156, v157
    v_exp_f32_e64 v150, v150
    v_cvt_pk_bf16_f32 v95, v158, v159
    v_exp_f32_e64 v151, v151
    buffer_store_dwordx4 v[92:95], v250, s[36:39], s67 offen sc1
    v_pk_fma_f32 v[144:145], v[144:145], v[220:221], v[220:221] op_sel_hi:[1,0,0]
    v_pk_mul_f32 v[152:153], v[44:45], v[44:45]
    v_pk_fma_f32 v[146:147], v[146:147], v[220:221], v[220:221] op_sel_hi:[1,0,0]
    v_pk_mul_f32 v[154:155], v[46:47], v[46:47]
    v_pk_fma_f32 v[148:149], v[148:149], v[220:221], v[220:221] op_sel_hi:[1,0,0]
    v_pk_mul_f32 v[156:157], v[48:49], v[48:49]
    v_pk_fma_f32 v[150:151], v[150:151], v[220:221], v[220:221] op_sel_hi:[1,0,0]
    v_pk_mul_f32 v[158:159], v[50:51], v[50:51]
    v_rcp_f32_e64 v144, v144
    v_pk_fma_f32 v[152:153], v[152:153], v[224:225], v[224:225] op_sel:[0,1,0] op_sel_hi:[1,1,0]
    v_rcp_f32_e64 v145, v145
    v_pk_fma_f32 v[154:155], v[154:155], v[224:225], v[224:225] op_sel:[0,1,0] op_sel_hi:[1,1,0]
    v_rcp_f32_e64 v146, v146
    v_pk_fma_f32 v[156:157], v[156:157], v[224:225], v[224:225] op_sel:[0,1,0] op_sel_hi:[1,1,0]
    v_rcp_f32_e64 v147, v147
    v_pk_fma_f32 v[158:159], v[158:159], v[224:225], v[224:225] op_sel:[0,1,0] op_sel_hi:[1,1,0]
    v_rcp_f32_e64 v148, v148
    v_pk_mul_f32 v[152:153], v[152:153], v[44:45]
    v_rcp_f32_e64 v149, v149
    v_pk_mul_f32 v[154:155], v[154:155], v[46:47]
    v_rcp_f32_e64 v150, v150
    v_pk_mul_f32 v[156:157], v[156:157], v[48:49]
    v_rcp_f32_e64 v151, v151
    v_pk_mul_f32 v[158:159], v[158:159], v[50:51]
    v_exp_f32_e64 v152, v152
    v_pk_mul_f32 v[144:145], v[144:145], v[16:17]
    v_pk_mul_f32 v[146:147], v[146:147], v[18:19]
    v_exp_f32_e64 v153, v153
    v_pk_mul_f32 v[148:149], v[148:149], v[20:21]
    v_exp_f32_e64 v154, v154
    v_pk_mul_f32 v[150:151], v[150:151], v[22:23]
    v_exp_f32_e64 v155, v155
    v_cvt_pk_bf16_f32 v16, v144, v145
    v_exp_f32_e64 v156, v156
    v_cvt_pk_bf16_f32 v17, v146, v147
    v_exp_f32_e64 v157, v157
    v_cvt_pk_bf16_f32 v18, v148, v149
    v_exp_f32_e64 v158, v158
    v_cvt_pk_bf16_f32 v19, v150, v151
    v_exp_f32_e64 v159, v159
    buffer_store_dwordx4 v[16:19], v251, s[36:39], s64 offen sc1
    v_pk_fma_f32 v[152:153], v[152:153], v[226:227], v[226:227] op_sel_hi:[1,0,0]
    v_pk_mul_f32 v[144:145], v[72:73], v[72:73]
    v_pk_fma_f32 v[154:155], v[154:155], v[226:227], v[226:227] op_sel_hi:[1,0,0]
    v_pk_mul_f32 v[146:147], v[74:75], v[74:75]
    v_pk_fma_f32 v[156:157], v[156:157], v[226:227], v[226:227] op_sel_hi:[1,0,0]
    v_pk_mul_f32 v[148:149], v[76:77], v[76:77]
    v_pk_fma_f32 v[158:159], v[158:159], v[226:227], v[226:227] op_sel_hi:[1,0,0]
    v_pk_mul_f32 v[150:151], v[78:79], v[78:79]
    v_rcp_f32_e64 v152, v152
    v_pk_fma_f32 v[144:145], v[144:145], v[230:231], v[230:231] op_sel:[0,1,0] op_sel_hi:[1,1,0]
    v_rcp_f32_e64 v153, v153
    v_pk_fma_f32 v[146:147], v[146:147], v[230:231], v[230:231] op_sel:[0,1,0] op_sel_hi:[1,1,0]
    v_rcp_f32_e64 v154, v154
    v_pk_fma_f32 v[148:149], v[148:149], v[230:231], v[230:231] op_sel:[0,1,0] op_sel_hi:[1,1,0]
    v_rcp_f32_e64 v155, v155
    v_pk_fma_f32 v[150:151], v[150:151], v[230:231], v[230:231] op_sel:[0,1,0] op_sel_hi:[1,1,0]
    v_rcp_f32_e64 v156, v156
    v_pk_mul_f32 v[144:145], v[144:145], v[72:73]
    v_rcp_f32_e64 v157, v157
    v_pk_mul_f32 v[146:147], v[146:147], v[74:75]
    v_rcp_f32_e64 v158, v158
    v_pk_mul_f32 v[148:149], v[148:149], v[76:77]
    v_rcp_f32_e64 v159, v159
    v_pk_mul_f32 v[150:151], v[150:151], v[78:79]
    v_exp_f32_e64 v144, v144
    v_pk_mul_f32 v[152:153], v[152:153], v[44:45]
    v_pk_mul_f32 v[154:155], v[154:155], v[46:47]
    v_exp_f32_e64 v145, v145
    v_pk_mul_f32 v[156:157], v[156:157], v[48:49]
    v_exp_f32_e64 v146, v146
    v_pk_mul_f32 v[158:159], v[158:159], v[50:51]
    v_exp_f32_e64 v147, v147
    v_cvt_pk_bf16_f32 v44, v152, v153
    v_exp_f32_e64 v148, v148
    v_cvt_pk_bf16_f32 v45, v154, v155
    v_exp_f32_e64 v149, v149
    v_cvt_pk_bf16_f32 v46, v156, v157
    v_exp_f32_e64 v150, v150
    v_cvt_pk_bf16_f32 v47, v158, v159
    v_exp_f32_e64 v151, v151
    buffer_store_dwordx4 v[44:47], v251, s[36:39], s65 offen sc1
    v_pk_fma_f32 v[144:145], v[144:145], v[232:233], v[232:233] op_sel_hi:[1,0,0]
    v_pk_mul_f32 v[152:153], v[100:101], v[100:101]
    v_pk_fma_f32 v[146:147], v[146:147], v[232:233], v[232:233] op_sel_hi:[1,0,0]
    v_pk_mul_f32 v[154:155], v[102:103], v[102:103]
    v_pk_fma_f32 v[148:149], v[148:149], v[232:233], v[232:233] op_sel_hi:[1,0,0]
    v_pk_mul_f32 v[156:157], v[104:105], v[104:105]
    v_pk_fma_f32 v[150:151], v[150:151], v[232:233], v[232:233] op_sel_hi:[1,0,0]
    v_pk_mul_f32 v[158:159], v[106:107], v[106:107]
    v_rcp_f32_e64 v144, v144
    v_pk_fma_f32 v[152:153], v[152:153], v[236:237], v[236:237] op_sel:[0,1,0] op_sel_hi:[1,1,0]
    v_rcp_f32_e64 v145, v145
    v_pk_fma_f32 v[154:155], v[154:155], v[236:237], v[236:237] op_sel:[0,1,0] op_sel_hi:[1,1,0]
    v_rcp_f32_e64 v146, v146
    v_pk_fma_f32 v[156:157], v[156:157], v[236:237], v[236:237] op_sel:[0,1,0] op_sel_hi:[1,1,0]
    v_rcp_f32_e64 v147, v147
    v_pk_fma_f32 v[158:159], v[158:159], v[236:237], v[236:237] op_sel:[0,1,0] op_sel_hi:[1,1,0]
    v_rcp_f32_e64 v148, v148
    v_pk_mul_f32 v[152:153], v[152:153], v[100:101]
    v_rcp_f32_e64 v149, v149
    v_pk_mul_f32 v[154:155], v[154:155], v[102:103]
    v_rcp_f32_e64 v150, v150
    v_pk_mul_f32 v[156:157], v[156:157], v[104:105]
    v_rcp_f32_e64 v151, v151
    v_pk_mul_f32 v[158:159], v[158:159], v[106:107]
    v_exp_f32_e64 v152, v152
    v_pk_mul_f32 v[144:145], v[144:145], v[72:73]
    v_exp_f32_e64 v153, v153
    v_exp_f32_e64 v154, v154
    v_pk_mul_f32 v[146:147], v[146:147], v[74:75]
    v_exp_f32_e64 v155, v155
    v_exp_f32_e64 v156, v156
    v_pk_mul_f32 v[148:149], v[148:149], v[76:77]
    v_exp_f32_e64 v157, v157
    v_exp_f32_e64 v158, v158
    v_pk_mul_f32 v[150:151], v[150:151], v[78:79]
    v_exp_f32_e64 v159, v159
    v_pk_fma_f32 v[152:153], v[152:153], v[238:239], v[238:239] op_sel_hi:[1,0,0]
    v_cvt_pk_bf16_f32 v72, v144, v145
    v_pk_fma_f32 v[154:155], v[154:155], v[238:239], v[238:239] op_sel_hi:[1,0,0]
    v_pk_fma_f32 v[156:157], v[156:157], v[238:239], v[238:239] op_sel_hi:[1,0,0]
    v_pk_fma_f32 v[158:159], v[158:159], v[238:239], v[238:239] op_sel_hi:[1,0,0]
    v_cvt_pk_bf16_f32 v73, v146, v147
    v_rcp_f32_e64 v152, v152
    v_rcp_f32_e64 v153, v153
    v_cvt_pk_bf16_f32 v74, v148, v149
    v_rcp_f32_e64 v154, v154
    v_rcp_f32_e64 v155, v155
    v_cvt_pk_bf16_f32 v75, v150, v151
    v_rcp_f32_e64 v156, v156
    v_rcp_f32_e64 v157, v157
    buffer_store_dwordx4 v[72:75], v251, s[36:39], s66 offen sc1
    v_rcp_f32_e64 v158, v158
    v_rcp_f32_e64 v159, v159
    v_pk_mul_f32 v[152:153], v[152:153], v[100:101]
    v_pk_mul_f32 v[154:155], v[154:155], v[102:103]
    v_pk_mul_f32 v[156:157], v[156:157], v[104:105]
    v_pk_mul_f32 v[158:159], v[158:159], v[106:107]
    v_cvt_pk_bf16_f32 v100, v152, v153
    v_cvt_pk_bf16_f32 v101, v154, v155
    v_cvt_pk_bf16_f32 v102, v156, v157
    v_cvt_pk_bf16_f32 v103, v158, v159
    buffer_store_dwordx4 v[100:103], v251, s[36:39], s67 offen sc1
    s_branch L_ep_done
L_ep_qx:
.p2align 3
    v_pk_mul_f32 v[144:145], v[0:1], v[216:217] op_sel:[0,1] op_sel_hi:[1,1]
    v_pk_mul_f32 v[146:147], v[2:3], v[216:217] op_sel:[0,1] op_sel_hi:[1,1]
    v_pk_mul_f32 v[148:149], v[4:5], v[216:217] op_sel:[0,1] op_sel_hi:[1,1]
    v_pk_mul_f32 v[150:151], v[6:7], v[216:217] op_sel:[0,1] op_sel_hi:[1,1]
    v_pk_fma_f32 v[0:1], v[0:1], v[216:217], v[220:221] op_sel:[0,0,1] op_sel_hi:[1,0,1]
    v_pk_fma_f32 v[2:3], v[2:3], v[216:217], v[220:221] op_sel:[0,0,1] op_sel_hi:[1,0,1]
    v_pk_fma_f32 v[4:5], v[4:5], v[216:217], v[220:221] op_sel:[0,0,1] op_sel_hi:[1,0,1]
    v_pk_fma_f32 v[6:7], v[6:7], v[216:217], v[220:221] op_sel:[0,0,1] op_sel_hi:[1,0,1]
    v_max_f32_e64 v0, v0, v221
    v_max_f32_e64 v1, v1, v221
    v_max_f32_e64 v2, v2, v221
    v_max_f32_e64 v3, v3, v221
    v_max_f32_e64 v4, v4, v221
    v_max_f32_e64 v5, v5, v221
    v_max_f32_e64 v6, v6, v221
    v_max_f32_e64 v7, v7, v221
    v_exp_f32_e64 v144, v144 clamp
    v_pk_mul_f32 v[152:153], v[28:29], v[222:223] op_sel:[0,1] op_sel_hi:[1,1]
    v_pk_mul_f32 v[154:155], v[30:31], v[222:223] op_sel:[0,1] op_sel_hi:[1,1]
    v_exp_f32_e64 v145, v145 clamp
    v_pk_mul_f32 v[156:157], v[32:33], v[222:223] op_sel:[0,1] op_sel_hi:[1,1]
    v_pk_mul_f32 v[158:159], v[34:35], v[222:223] op_sel:[0,1] op_sel_hi:[1,1]
    v_exp_f32_e64 v146, v146 clamp
    v_pk_fma_f32 v[28:29], v[28:29], v[222:223], v[226:227] op_sel:[0,0,1] op_sel_hi:[1,0,1]
    v_pk_fma_f32 v[30:31], v[30:31], v[222:223], v[226:227] op_sel:[0,0,1] op_sel_hi:[1,0,1]
    v_exp_f32_e64 v147, v147 clamp
    v_pk_fma_f32 v[32:33], v[32:33], v[222:223], v[226:227] op_sel:[0,0,1] op_sel_hi:[1,0,1]
    v_pk_fma_f32 v[34:35], v[34:35], v[222:223], v[226:227] op_sel:[0,0,1] op_sel_hi:[1,0,1]
    v_exp_f32_e64 v148, v148 clamp
    v_max_f32_e64 v28, v28, v227
    v_max_f32_e64 v29, v29, v227
    v_exp_f32_e64 v149, v149 clamp
    v_max_f32_e64 v30, v30, v227
    v_max_f32_e64 v31, v31, v227
    v_exp_f32_e64 v150, v150 clamp
    v_max_f32_e64 v32, v32, v227
    v_max_f32_e64 v33, v33, v227
    v_exp_f32_e64 v151, v151 clamp
    v_max_f32_e64 v34, v34, v227
    v_max_f32_e64 v35, v35, v227
    v_exp_f32_e64 v152, v152 clamp
    v_pk_add_f32 v[144:145], v[144:145], v[0:1]
    v_pk_add_f32 v[146:147], v[146:147], v[2:3]
    v_pk_add_f32 v[148:149], v[148:149], v[4:5]
    v_pk_add_f32 v[150:151], v[150:151], v[6:7]
    v_exp_f32_e64 v153, v153 clamp
    v_cvt_pk_bf16_f32 v0, v144, v145
    v_cvt_pk_bf16_f32 v1, v146, v147
    v_cvt_pk_bf16_f32 v2, v148, v149
    v_exp_f32_e64 v154, v154 clamp
    v_cvt_pk_bf16_f32 v3, v150, v151
    buffer_store_dwordx4 v[0:3], v249, s[36:39], s64 offen sc1
    v_pk_mul_f32 v[144:145], v[56:57], v[228:229] op_sel:[0,1] op_sel_hi:[1,1]
    v_exp_f32_e64 v155, v155 clamp
    v_pk_mul_f32 v[146:147], v[58:59], v[228:229] op_sel:[0,1] op_sel_hi:[1,1]
    v_pk_mul_f32 v[148:149], v[60:61], v[228:229] op_sel:[0,1] op_sel_hi:[1,1]
    v_pk_mul_f32 v[150:151], v[62:63], v[228:229] op_sel:[0,1] op_sel_hi:[1,1]
    v_exp_f32_e64 v156, v156 clamp
    v_pk_fma_f32 v[56:57], v[56:57], v[228:229], v[232:233] op_sel:[0,0,1] op_sel_hi:[1,0,1]
    v_pk_fma_f32 v[58:59], v[58:59], v[228:229], v[232:233] op_sel:[0,0,1] op_sel_hi:[1,0,1]
    v_pk_fma_f32 v[60:61], v[60:61], v[228:229], v[232:233] op_sel:[0,0,1] op_sel_hi:[1,0,1]
    v_exp_f32_e64 v157, v157 clamp
    v_pk_fma_f32 v[62:63], v[62:63], v[228:229], v[232:233] op_sel:[0,0,1] op_sel_hi:[1,0,1]
    v_max_f32_e64 v56, v56, v233
    v_max_f32_e64 v57, v57, v233
    v_exp_f32_e64 v158, v158 clamp
    v_max_f32_e64 v58, v58, v233
    v_max_f32_e64 v59, v59, v233
    v_max_f32_e64 v60, v60, v233
    v_exp_f32_e64 v159, v159 clamp
    v_max_f32_e64 v61, v61, v233
    v_max_f32_e64 v62, v62, v233
    v_max_f32_e64 v63, v63, v233
    v_exp_f32_e64 v144, v144 clamp
    v_pk_add_f32 v[152:153], v[152:153], v[28:29]
    v_pk_add_f32 v[154:155], v[154:155], v[30:31]
    v_pk_add_f32 v[156:157], v[156:157], v[32:33]
    v_pk_add_f32 v[158:159], v[158:159], v[34:35]
    v_exp_f32_e64 v145, v145 clamp
    v_cvt_pk_bf16_f32 v28, v152, v153
    v_cvt_pk_bf16_f32 v29, v154, v155
    v_cvt_pk_bf16_f32 v30, v156, v157
    v_exp_f32_e64 v146, v146 clamp
    v_cvt_pk_bf16_f32 v31, v158, v159
    buffer_store_dwordx4 v[28:31], v249, s[36:39], s65 offen sc1
    v_pk_mul_f32 v[152:153], v[84:85], v[234:235] op_sel:[0,1] op_sel_hi:[1,1]
    v_exp_f32_e64 v147, v147 clamp
    v_pk_mul_f32 v[154:155], v[86:87], v[234:235] op_sel:[0,1] op_sel_hi:[1,1]
    v_pk_mul_f32 v[156:157], v[88:89], v[234:235] op_sel:[0,1] op_sel_hi:[1,1]
    v_pk_mul_f32 v[158:159], v[90:91], v[234:235] op_sel:[0,1] op_sel_hi:[1,1]
    v_exp_f32_e64 v148, v148 clamp
    v_pk_fma_f32 v[84:85], v[84:85], v[234:235], v[238:239] op_sel:[0,0,1] op_sel_hi:[1,0,1]
    v_pk_fma_f32 v[86:87], v[86:87], v[234:235], v[238:239] op_sel:[0,0,1] op_sel_hi:[1,0,1]
    v_pk_fma_f32 v[88:89], v[88:89], v[234:235], v[238:239] op_sel:[0,0,1] op_sel_hi:[1,0,1]
    v_exp_f32_e64 v149, v149 clamp
    v_pk_fma_f32 v[90:91], v[90:91], v[234:235], v[238:239] op_sel:[0,0,1] op_sel_hi:[1,0,1]
    v_max_f32_e64 v84, v84, v239
    v_max_f32_e64 v85, v85, v239
    v_exp_f32_e64 v150, v150 clamp
    v_max_f32_e64 v86, v86, v239
    v_max_f32_e64 v87, v87, v239
    v_max_f32_e64 v88, v88, v239
    v_exp_f32_e64 v151, v151 clamp
    v_max_f32_e64 v89, v89, v239
    v_max_f32_e64 v90, v90, v239
    v_max_f32_e64 v91, v91, v239
    v_exp_f32_e64 v152, v152 clamp
    v_pk_add_f32 v[144:145], v[144:145], v[56:57]
    v_pk_add_f32 v[146:147], v[146:147], v[58:59]
    v_pk_add_f32 v[148:149], v[148:149], v[60:61]
    v_pk_add_f32 v[150:151], v[150:151], v[62:63]
    v_exp_f32_e64 v153, v153 clamp
    v_cvt_pk_bf16_f32 v56, v144, v145
    v_cvt_pk_bf16_f32 v57, v146, v147
    v_cvt_pk_bf16_f32 v58, v148, v149
    v_exp_f32_e64 v154, v154 clamp
    v_cvt_pk_bf16_f32 v59, v150, v151
    buffer_store_dwordx4 v[56:59], v249, s[36:39], s66 offen sc1
    v_pk_mul_f32 v[144:145], v[8:9], v[216:217] op_sel:[0,1] op_sel_hi:[1,1]
    v_exp_f32_e64 v155, v155 clamp
    v_pk_mul_f32 v[146:147], v[10:11], v[216:217] op_sel:[0,1] op_sel_hi:[1,1]
    v_pk_mul_f32 v[148:149], v[12:13], v[216:217] op_sel:[0,1] op_sel_hi:[1,1]
    v_pk_mul_f32 v[150:151], v[14:15], v[216:217] op_sel:[0,1] op_sel_hi:[1,1]
    v_exp_f32_e64 v156, v156 clamp
    v_pk_fma_f32 v[8:9], v[8:9], v[216:217], v[220:221] op_sel:[0,0,1] op_sel_hi:[1,0,1]
    v_pk_fma_f32 v[10:11], v[10:11], v[216:217], v[220:221] op_sel:[0,0,1] op_sel_hi:[1,0,1]
    v_pk_fma_f32 v[12:13], v[12:13], v[216:217], v[220:221] op_sel:[0,0,1] op_sel_hi:[1,0,1]
    v_exp_f32_e64 v157, v157 clamp
    v_pk_fma_f32 v[14:15], v[14:15], v[216:217], v[220:221] op_sel:[0,0,1] op_sel_hi:[1,0,1]
    v_max_f32_e64 v8, v8, v221
    v_max_f32_e64 v9, v9, v221
    v_exp_f32_e64 v158, v158 clamp
    v_max_f32_e64 v10, v10, v221
    v_max_f32_e64 v11, v11, v221
    v_max_f32_e64 v12, v12, v221
    v_exp_f32_e64 v159, v159 clamp
    v_max_f32_e64 v13, v13, v221
    v_max_f32_e64 v14, v14, v221
    v_max_f32_e64 v15, v15, v221
    v_exp_f32_e64 v144, v144 clamp
    v_pk_add_f32 v[152:153], v[152:153], v[84:85]
    v_pk_add_f32 v[154:155], v[154:155], v[86:87]
    v_pk_add_f32 v[156:157], v[156:157], v[88:89]
    v_pk_add_f32 v[158:159], v[158:159], v[90:91]
    v_exp_f32_e64 v145, v145 clamp
    v_cvt_pk_bf16_f32 v84, v152, v153
    v_cvt_pk_bf16_f32 v85, v154, v155
    v_cvt_pk_bf16_f32 v86, v156, v157
    v_exp_f32_e64 v146, v146 clamp
    v_cvt_pk_bf16_f32 v87, v158, v159
    buffer_store_dwordx4 v[84:87], v249, s[36:39], s67 offen sc1
    v_pk_mul_f32 v[152:153], v[36:37], v[222:223] op_sel:[0,1] op_sel_hi:[1,1]
    v_exp_f32_e64 v147, v147 clamp
    v_pk_mul_f32 v[154:155], v[38:39], v[222:223] op_sel:[0,1] op_sel_hi:[1,1]
    v_pk_mul_f32 v[156:157], v[40:41], v[222:223] op_sel:[0,1] op_sel_hi:[1,1]
    v_pk_mul_f32 v[158:159], v[42:43], v[222:223] op_sel:[0,1] op_sel_hi:[1,1]
    v_exp_f32_e64 v148, v148 clamp
    v_pk_fma_f32 v[36:37], v[36:37], v[222:223], v[226:227] op_sel:[0,0,1] op_sel_hi:[1,0,1]
    v_pk_fma_f32 v[38:39], v[38:39], v[222:223], v[226:227] op_sel:[0,0,1] op_sel_hi:[1,0,1]
    v_pk_fma_f32 v[40:41], v[40:41], v[222:223], v[226:227] op_sel:[0,0,1] op_sel_hi:[1,0,1]
    v_exp_f32_e64 v149, v149 clamp
    v_pk_fma_f32 v[42:43], v[42:43], v[222:223], v[226:227] op_sel:[0,0,1] op_sel_hi:[1,0,1]
    v_max_f32_e64 v36, v36, v227
    v_max_f32_e64 v37, v37, v227
    v_exp_f32_e64 v150, v150 clamp
    v_max_f32_e64 v38, v38, v227
    v_max_f32_e64 v39, v39, v227
    v_max_f32_e64 v40, v40, v227
    v_exp_f32_e64 v151, v151 clamp
    v_max_f32_e64 v41, v41, v227
    v_max_f32_e64 v42, v42, v227
    v_max_f32_e64 v43, v43, v227
    v_exp_f32_e64 v152, v152 clamp
    v_pk_add_f32 v[144:145], v[144:145], v[8:9]
    v_pk_add_f32 v[146:147], v[146:147], v[10:11]
    v_pk_add_f32 v[148:149], v[148:149], v[12:13]
    v_pk_add_f32 v[150:151], v[150:151], v[14:15]
    v_exp_f32_e64 v153, v153 clamp
    v_cvt_pk_bf16_f32 v8, v144, v145
    v_cvt_pk_bf16_f32 v9, v146, v147
    v_cvt_pk_bf16_f32 v10, v148, v149
    v_exp_f32_e64 v154, v154 clamp
    v_cvt_pk_bf16_f32 v11, v150, v151
    buffer_store_dwordx4 v[8:11], v250, s[36:39], s64 offen sc1
    v_pk_mul_f32 v[144:145], v[64:65], v[228:229] op_sel:[0,1] op_sel_hi:[1,1]
    v_exp_f32_e64 v155, v155 clamp
    v_pk_mul_f32 v[146:147], v[66:67], v[228:229] op_sel:[0,1] op_sel_hi:[1,1]
    v_pk_mul_f32 v[148:149], v[68:69], v[228:229] op_sel:[0,1] op_sel_hi:[1,1]
    v_pk_mul_f32 v[150:151], v[70:71], v[228:229] op_sel:[0,1] op_sel_hi:[1,1]
    v_exp_f32_e64 v156, v156 clamp
    v_pk_fma_f32 v[64:65], v[64:65], v[228:229], v[232:233] op_sel:[0,0,1] op_sel_hi:[1,0,1]
    v_pk_fma_f32 v[66:67], v[66:67], v[228:229], v[232:233] op_sel:[0,0,1] op_sel_hi:[1,0,1]
    v_pk_fma_f32 v[68:69], v[68:69], v[228:229], v[232:233] op_sel:[0,0,1] op_sel_hi:[1,0,1]
    v_exp_f32_e64 v157, v157 clamp
    v_pk_fma_f32 v[70:71], v[70:71], v[228:229], v[232:233] op_sel:[0,0,1] op_sel_hi:[1,0,1]
    v_max_f32_e64 v64, v64, v233
    v_max_f32_e64 v65, v65, v233
    v_exp_f32_e64 v158, v158 clamp
    v_max_f32_e64 v66, v66, v233
    v_max_f32_e64 v67, v67, v233
    v_max_f32_e64 v68, v68, v233
    v_exp_f32_e64 v159, v159 clamp
    v_max_f32_e64 v69, v69, v233
    v_max_f32_e64 v70, v70, v233
    v_max_f32_e64 v71, v71, v233
    v_exp_f32_e64 v144, v144 clamp
    v_pk_add_f32 v[152:153], v[152:153], v[36:37]
    v_pk_add_f32 v[154:155], v[154:155], v[38:39]
    v_pk_add_f32 v[156:157], v[156:157], v[40:41]
    v_pk_add_f32 v[158:159], v[158:159], v[42:43]
    v_exp_f32_e64 v145, v145 clamp
    v_cvt_pk_bf16_f32 v36, v152, v153
    v_cvt_pk_bf16_f32 v37, v154, v155
    v_cvt_pk_bf16_f32 v38, v156, v157
    v_exp_f32_e64 v146, v146 clamp
    v_cvt_pk_bf16_f32 v39, v158, v159
    buffer_store_dwordx4 v[36:39], v250, s[36:39], s65 offen sc1
    v_pk_mul_f32 v[152:153], v[92:93], v[234:235] op_sel:[0,1] op_sel_hi:[1,1]
    v_exp_f32_e64 v147, v147 clamp
    v_pk_mul_f32 v[154:155], v[94:95], v[234:235] op_sel:[0,1] op_sel_hi:[1,1]
    v_pk_mul_f32 v[156:157], v[96:97], v[234:235] op_sel:[0,1] op_sel_hi:[1,1]
    v_pk_mul_f32 v[158:159], v[98:99], v[234:235] op_sel:[0,1] op_sel_hi:[1,1]
    v_exp_f32_e64 v148, v148 clamp
    v_pk_fma_f32 v[92:93], v[92:93], v[234:235], v[238:239] op_sel:[0,0,1] op_sel_hi:[1,0,1]
    v_pk_fma_f32 v[94:95], v[94:95], v[234:235], v[238:239] op_sel:[0,0,1] op_sel_hi:[1,0,1]
    v_pk_fma_f32 v[96:97], v[96:97], v[234:235], v[238:239] op_sel:[0,0,1] op_sel_hi:[1,0,1]
    v_exp_f32_e64 v149, v149 clamp
    v_pk_fma_f32 v[98:99], v[98:99], v[234:235], v[238:239] op_sel:[0,0,1] op_sel_hi:[1,0,1]
    v_max_f32_e64 v92, v92, v239
    v_max_f32_e64 v93, v93, v239
    v_exp_f32_e64 v150, v150 clamp
    v_max_f32_e64 v94, v94, v239
    v_max_f32_e64 v95, v95, v239
    v_max_f32_e64 v96, v96, v239
    v_exp_f32_e64 v151, v151 clamp
    v_max_f32_e64 v97, v97, v239
    v_max_f32_e64 v98, v98, v239
    v_max_f32_e64 v99, v99, v239
    v_exp_f32_e64 v152, v152 clamp
    v_pk_add_f32 v[144:145], v[144:145], v[64:65]
    v_pk_add_f32 v[146:147], v[146:147], v[66:67]
    v_exp_f32_e64 v153, v153 clamp
    v_pk_add_f32 v[148:149], v[148:149], v[68:69]
    v_exp_f32_e64 v154, v154 clamp
    v_pk_add_f32 v[150:151], v[150:151], v[70:71]
    v_exp_f32_e64 v155, v155 clamp
    v_cvt_pk_bf16_f32 v64, v144, v145
    v_exp_f32_e64 v156, v156 clamp
    v_cvt_pk_bf16_f32 v65, v146, v147
    v_exp_f32_e64 v157, v157 clamp
    v_cvt_pk_bf16_f32 v66, v148, v149
    v_exp_f32_e64 v158, v158 clamp
    v_cvt_pk_bf16_f32 v67, v150, v151
    v_exp_f32_e64 v159, v159 clamp
    buffer_store_dwordx4 v[64:67], v250, s[36:39], s66 offen sc1
    v_pk_add_f32 v[152:153], v[152:153], v[92:93]
    v_pk_add_f32 v[154:155], v[154:155], v[94:95]
    v_pk_add_f32 v[156:157], v[156:157], v[96:97]
    v_pk_add_f32 v[158:159], v[158:159], v[98:99]
    v_cvt_pk_bf16_f32 v92, v152, v153
    v_cvt_pk_bf16_f32 v93, v154, v155
    v_cvt_pk_bf16_f32 v94, v156, v157
    v_cvt_pk_bf16_f32 v95, v158, v159
    buffer_store_dwordx4 v[92:95], v250, s[36:39], s67 offen sc1
    s_branch L_ep_done
L_ep_kvq:
    v_and_b32 v112, 15, v255
    s_and_b32 s60, s26, 1
    s_lshl_b32 s60, s60, 6
    v_add_u32 v112, s60, v112
    v_mul_u32_u24 v112, 344, v112
    v_add_u32 v112, 30720, v112
    v_lshrrev_b32 v113, 4, v255
    v_lshl_add_u32 v113, v113, 3, v112
    s_lshr_b32 s60, s26, 1
    s_mul_i32 s61, s60, 96
    s_mul_i32 s60, s60, 160
    v_add_u32 v246, s61, v113
    v_add_u32 v247, s60, v113
    v_mov_b32 v114, 0x3f803f80
    v_mov_b32 v115, 0x3f803f80
    ds_write_b64 v112, v[114:115] offset:320
    ds_write_b64 v112, v[114:115] offset:5824
    ds_write_b64 v112, v[114:115] offset:11328
    ds_write_b64 v112, v[114:115] offset:16832
.p2align 3
    v_pk_mul_f32 v[144:145], v[0:1], v[216:217] op_sel:[0,1] op_sel_hi:[1,1]
    v_pk_mul_f32 v[146:147], v[2:3], v[216:217] op_sel:[0,1] op_sel_hi:[1,1]
    v_pk_mul_f32 v[148:149], v[4:5], v[216:217] op_sel:[0,1] op_sel_hi:[1,1]
    v_pk_mul_f32 v[150:151], v[6:7], v[216:217] op_sel:[0,1] op_sel_hi:[1,1]
    v_pk_fma_f32 v[0:1], v[0:1], v[216:217], v[220:221] op_sel:[0,0,1] op_sel_hi:[1,0,1]
    v_pk_fma_f32 v[2:3], v[2:3], v[216:217], v[220:221] op_sel:[0,0,1] op_sel_hi:[1,0,1]
    v_pk_fma_f32 v[4:5], v[4:5], v[216:217], v[220:221] op_sel:[0,0,1] op_sel_hi:[1,0,1]
    v_pk_fma_f32 v[6:7], v[6:7], v[216:217], v[220:221] op_sel:[0,0,1] op_sel_hi:[1,0,1]
    v_max_f32_e64 v0, v0, v221
    v_max_f32_e64 v1, v1, v221
    v_max_f32_e64 v2, v2, v221
    v_max_f32_e64 v3, v3, v221
    v_max_f32_e64 v4, v4, v221
    v_max_f32_e64 v5, v5, v221
    v_max_f32_e64 v6, v6, v221
    v_max_f32_e64 v7, v7, v221
    v_exp_f32_e64 v144, v144 clamp
    v_pk_mul_f32 v[152:153], v[12:13], v[216:217] op_sel_hi:[1,0]
    v_exp_f32_e64 v145, v145 clamp
    v_exp_f32_e64 v146, v146 clamp
    v_pk_mul_f32 v[154:155], v[14:15], v[216:217] op_sel_hi:[1,0]
    v_exp_f32_e64 v147, v147 clamp
    v_exp_f32_e64 v148, v148 clamp
    v_pk_mul_f32 v[156:157], v[16:17], v[216:217] op_sel_hi:[1,0]
    v_exp_f32_e64 v149, v149 clamp
    v_exp_f32_e64 v150, v150 clamp
    v_pk_mul_f32 v[158:159], v[18:19], v[216:217] op_sel_hi:[1,0]
    v_exp_f32_e64 v151, v151 clamp
    v_pk_add_f32 v[144:145], v[144:145], v[0:1]
    v_pk_add_f32 v[146:147], v[146:147], v[2:3]
    v_pk_add_f32 v[148:149], v[148:149], v[4:5]
    v_pk_add_f32 v[150:151], v[150:151], v[6:7]
    v_cvt_pk_bf16_f32 v0, v144, v145
    v_cvt_pk_bf16_f32 v1, v146, v147
    v_cvt_pk_bf16_f32 v2, v148, v149
    v_cvt_pk_bf16_f32 v3, v150, v151
    ds_write_b64 v246, v[0:1] offset:0
    ds_write_b64 v246, v[2:3] offset:32
    v_pk_mul_f32 v[144:145], v[28:29], v[222:223] op_sel:[0,1] op_sel_hi:[1,1]
    v_pk_mul_f32 v[146:147], v[30:31], v[222:223] op_sel:[0,1] op_sel_hi:[1,1]
    v_pk_mul_f32 v[148:149], v[32:33], v[222:223] op_sel:[0,1] op_sel_hi:[1,1]
    v_pk_mul_f32 v[150:151], v[34:35], v[222:223] op_sel:[0,1] op_sel_hi:[1,1]
    v_pk_fma_f32 v[28:29], v[28:29], v[222:223], v[226:227] op_sel:[0,0,1] op_sel_hi:[1,0,1]
    v_pk_fma_f32 v[30:31], v[30:31], v[222:223], v[226:227] op_sel:[0,0,1] op_sel_hi:[1,0,1]
    v_pk_fma_f32 v[32:33], v[32:33], v[222:223], v[226:227] op_sel:[0,0,1] op_sel_hi:[1,0,1]
    v_pk_fma_f32 v[34:35], v[34:35], v[222:223], v[226:227] op_sel:[0,0,1] op_sel_hi:[1,0,1]
    v_max_f32_e64 v28, v28, v227
    v_max_f32_e64 v29, v29, v227
    v_max_f32_e64 v30, v30, v227
    v_max_f32_e64 v31, v31, v227
    v_max_f32_e64 v32, v32, v227
    v_max_f32_e64 v33, v33, v227
    v_max_f32_e64 v34, v34, v227
    v_max_f32_e64 v35, v35, v227
    v_exp_f32_e64 v144, v144 clamp
    v_cvt_pk_bf16_f32 v12, v152, v153
    v_cvt_pk_bf16_f32 v13, v154, v155
    v_exp_f32_e64 v145, v145 clamp
    v_cvt_pk_bf16_f32 v14, v156, v157
    v_exp_f32_e64 v146, v146 clamp
    v_cvt_pk_bf16_f32 v15, v158, v159
    v_exp_f32_e64 v147, v147 clamp
    ds_write_b64 v246, v[12:13] offset:160
    v_exp_f32_e64 v148, v148 clamp
    ds_write_b64 v246, v[14:15] offset:192
    v_pk_mul_f32 v[152:153], v[40:41], v[222:223] op_sel_hi:[1,0]
    v_exp_f32_e64 v149, v149 clamp
    v_pk_mul_f32 v[154:155], v[42:43], v[222:223] op_sel_hi:[1,0]
    v_exp_f32_e64 v150, v150 clamp
    v_pk_mul_f32 v[156:157], v[44:45], v[222:223] op_sel_hi:[1,0]
    v_exp_f32_e64 v151, v151 clamp
    v_pk_mul_f32 v[158:159], v[46:47], v[222:223] op_sel_hi:[1,0]
    v_pk_add_f32 v[144:145], v[144:145], v[28:29]
    v_pk_add_f32 v[146:147], v[146:147], v[30:31]
    v_pk_add_f32 v[148:149], v[148:149], v[32:33]
    v_pk_add_f32 v[150:151], v[150:151], v[34:35]
    v_cvt_pk_bf16_f32 v28, v144, v145
    v_cvt_pk_bf16_f32 v29, v146, v147
    v_cvt_pk_bf16_f32 v30, v148, v149
    v_cvt_pk_bf16_f32 v31, v150, v151
    ds_write_b64 v246, v[28:29] offset:5504
    ds_write_b64 v246, v[30:31] offset:5536
    v_pk_mul_f32 v[144:145], v[56:57], v[228:229] op_sel:[0,1] op_sel_hi:[1,1]
    v_pk_mul_f32 v[146:147], v[58:59], v[228:229] op_sel:[0,1] op_sel_hi:[1,1]
    v_pk_mul_f32 v[148:149], v[60:61], v[228:229] op_sel:[0,1] op_sel_hi:[1,1]
    v_pk_mul_f32 v[150:151], v[62:63], v[228:229] op_sel:[0,1] op_sel_hi:[1,1]
    v_pk_fma_f32 v[56:57], v[56:57], v[228:229], v[232:233] op_sel:[0,0,1] op_sel_hi:[1,0,1]
    v_pk_fma_f32 v[58:59], v[58:59], v[228:229], v[232:233] op_sel:[0,0,1] op_sel_hi:[1,0,1]
    v_pk_fma_f32 v[60:61], v[60:61], v[228:229], v[232:233] op_sel:[0,0,1] op_sel_hi:[1,0,1]
    v_pk_fma_f32 v[62:63], v[62:63], v[228:229], v[232:233] op_sel:[0,0,1] op_sel_hi:[1,0,1]
    v_max_f32_e64 v56, v56, v233
    v_max_f32_e64 v57, v57, v233
    v_max_f32_e64 v58, v58, v233
    v_max_f32_e64 v59, v59, v233
    v_max_f32_e64 v60, v60, v233
    v_max_f32_e64 v61, v61, v233
    v_max_f32_e64 v62, v62, v233
    v_max_f32_e64 v63, v63, v233
    v_exp_f32_e64 v144, v144 clamp
    v_cvt_pk_bf16_f32 v40, v152, v153
    v_cvt_pk_bf16_f32 v41, v154, v155
    v_exp_f32_e64 v145, v145 clamp
    v_cvt_pk_bf16_f32 v42, v156, v157
    v_exp_f32_e64 v146, v146 clamp
    v_cvt_pk_bf16_f32 v43, v158, v159
    ds_write_b64 v246, v[40:41] offset:5664
    v_exp_f32_e64 v147, v147 clamp
    ds_write_b64 v246, v[42:43] offset:5696
    v_exp_f32_e64 v148, v148 clamp
    s_waitcnt lgkmcnt(4)
.p2align 3
    v_exp_f32_e64 v149, v149 clamp
    v_pk_mul_f32 v[152:153], v[68:69], v[228:229] op_sel_hi:[1,0]
    v_pk_mul_f32 v[154:155], v[70:71], v[228:229] op_sel_hi:[1,0]
    v_exp_f32_e64 v150, v150 clamp
    v_pk_mul_f32 v[156:157], v[72:73], v[228:229] op_sel_hi:[1,0]
    v_exp_f32_e64 v151, v151 clamp
    v_pk_mul_f32 v[158:159], v[74:75], v[228:229] op_sel_hi:[1,0]
    v_pk_add_f32 v[144:145], v[144:145], v[56:57]
    v_pk_add_f32 v[146:147], v[146:147], v[58:59]
    v_pk_add_f32 v[148:149], v[148:149], v[60:61]
    v_pk_add_f32 v[150:151], v[150:151], v[62:63]
    v_cvt_pk_bf16_f32 v56, v144, v145
    v_cvt_pk_bf16_f32 v57, v146, v147
    v_cvt_pk_bf16_f32 v58, v148, v149
    v_cvt_pk_bf16_f32 v59, v150, v151
    ds_write_b64 v246, v[56:57] offset:11008
    ds_write_b64 v246, v[58:59] offset:11040
    v_pk_mul_f32 v[144:145], v[84:85], v[234:235] op_sel:[0,1] op_sel_hi:[1,1]
    v_pk_mul_f32 v[146:147], v[86:87], v[234:235] op_sel:[0,1] op_sel_hi:[1,1]
    v_pk_mul_f32 v[148:149], v[88:89], v[234:235] op_sel:[0,1] op_sel_hi:[1,1]
    v_pk_mul_f32 v[150:151], v[90:91], v[234:235] op_sel:[0,1] op_sel_hi:[1,1]
    v_pk_fma_f32 v[84:85], v[84:85], v[234:235], v[238:239] op_sel:[0,0,1] op_sel_hi:[1,0,1]
    v_pk_fma_f32 v[86:87], v[86:87], v[234:235], v[238:239] op_sel:[0,0,1] op_sel_hi:[1,0,1]
    v_pk_fma_f32 v[88:89], v[88:89], v[234:235], v[238:239] op_sel:[0,0,1] op_sel_hi:[1,0,1]
    v_pk_fma_f32 v[90:91], v[90:91], v[234:235], v[238:239] op_sel:[0,0,1] op_sel_hi:[1,0,1]
    v_max_f32_e64 v84, v84, v239
    v_max_f32_e64 v85, v85, v239
    v_max_f32_e64 v86, v86, v239
    v_max_f32_e64 v87, v87, v239
    v_max_f32_e64 v88, v88, v239
    v_max_f32_e64 v89, v89, v239
    v_max_f32_e64 v90, v90, v239
    v_max_f32_e64 v91, v91, v239
    v_exp_f32_e64 v144, v144 clamp
    v_cvt_pk_bf16_f32 v68, v152, v153
    v_cvt_pk_bf16_f32 v69, v154, v155
    v_exp_f32_e64 v145, v145 clamp
    v_cvt_pk_bf16_f32 v70, v156, v157
    v_exp_f32_e64 v146, v146 clamp
    v_cvt_pk_bf16_f32 v71, v158, v159
    v_exp_f32_e64 v147, v147 clamp
    ds_write_b64 v246, v[68:69] offset:11168
    v_exp_f32_e64 v148, v148 clamp
    ds_write_b64 v246, v[70:71] offset:11200
    v_pk_mul_f32 v[152:153], v[96:97], v[234:235] op_sel_hi:[1,0]
    v_exp_f32_e64 v149, v149 clamp
    v_pk_mul_f32 v[154:155], v[98:99], v[234:235] op_sel_hi:[1,0]
    v_exp_f32_e64 v150, v150 clamp
    v_pk_mul_f32 v[156:157], v[100:101], v[234:235] op_sel_hi:[1,0]
    v_exp_f32_e64 v151, v151 clamp
    v_pk_mul_f32 v[158:159], v[102:103], v[234:235] op_sel_hi:[1,0]
    v_pk_add_f32 v[144:145], v[144:145], v[84:85]
    v_pk_add_f32 v[146:147], v[146:147], v[86:87]
    v_pk_add_f32 v[148:149], v[148:149], v[88:89]
    v_pk_add_f32 v[150:151], v[150:151], v[90:91]
    v_cvt_pk_bf16_f32 v84, v144, v145
    v_cvt_pk_bf16_f32 v85, v146, v147
    v_cvt_pk_bf16_f32 v86, v148, v149
    v_cvt_pk_bf16_f32 v87, v150, v151
    ds_write_b64 v246, v[84:85] offset:16512
    ds_write_b64 v246, v[86:87] offset:16544
    v_cvt_pk_bf16_f32 v96, v152, v153
    v_cvt_pk_bf16_f32 v97, v154, v155
    v_cvt_pk_bf16_f32 v98, v156, v157
    v_cvt_pk_bf16_f32 v99, v158, v159
    ds_write_b64 v246, v[96:97] offset:16672
    ds_write_b64 v246, v[98:99] offset:16704
    s_waitcnt lgkmcnt(4)
    s_cmp_ge_u32 s26, 2
    s_cbranch_scc1 L_kv_lin
.p2align 3
    v_pk_mul_f32 v[144:145], v[8:9], v[216:217] op_sel:[0,1] op_sel_hi:[1,1]
    v_pk_mul_f32 v[146:147], v[10:11], v[216:217] op_sel:[0,1] op_sel_hi:[1,1]
    v_pk_mul_f32 v[148:149], v[36:37], v[222:223] op_sel:[0,1] op_sel_hi:[1,1]
    v_pk_mul_f32 v[150:151], v[38:39], v[222:223] op_sel:[0,1] op_sel_hi:[1,1]
    v_pk_fma_f32 v[8:9], v[8:9], v[216:217], v[220:221] op_sel:[0,0,1] op_sel_hi:[1,0,1]
    v_pk_fma_f32 v[10:11], v[10:11], v[216:217], v[220:221] op_sel:[0,0,1] op_sel_hi:[1,0,1]
    v_pk_fma_f32 v[36:37], v[36:37], v[222:223], v[226:227] op_sel:[0,0,1] op_sel_hi:[1,0,1]
    v_pk_fma_f32 v[38:39], v[38:39], v[222:223], v[226:227] op_sel:[0,0,1] op_sel_hi:[1,0,1]
    v_max_f32_e64 v8, v8, v221
    v_max_f32_e64 v9, v9, v221
    v_max_f32_e64 v10, v10, v221
    v_max_f32_e64 v11, v11, v221
    v_max_f32_e64 v36, v36, v227
    v_max_f32_e64 v37, v37, v227
    v_max_f32_e64 v38, v38, v227
    v_max_f32_e64 v39, v39, v227
    v_exp_f32_e64 v144, v144 clamp
    v_pk_mul_f32 v[152:153], v[64:65], v[228:229] op_sel:[0,1] op_sel_hi:[1,1]
    v_pk_mul_f32 v[154:155], v[66:67], v[228:229] op_sel:[0,1] op_sel_hi:[1,1]
    v_exp_f32_e64 v145, v145 clamp
    v_pk_mul_f32 v[156:157], v[92:93], v[234:235] op_sel:[0,1] op_sel_hi:[1,1]
    v_pk_mul_f32 v[158:159], v[94:95], v[234:235] op_sel:[0,1] op_sel_hi:[1,1]
    v_exp_f32_e64 v146, v146 clamp
    v_pk_fma_f32 v[64:65], v[64:65], v[228:229], v[232:233] op_sel:[0,0,1] op_sel_hi:[1,0,1]
    v_pk_fma_f32 v[66:67], v[66:67], v[228:229], v[232:233] op_sel:[0,0,1] op_sel_hi:[1,0,1]
    v_exp_f32_e64 v147, v147 clamp
    v_pk_fma_f32 v[92:93], v[92:93], v[234:235], v[238:239] op_sel:[0,0,1] op_sel_hi:[1,0,1]
    v_pk_fma_f32 v[94:95], v[94:95], v[234:235], v[238:239] op_sel:[0,0,1] op_sel_hi:[1,0,1]
    v_exp_f32_e64 v148, v148 clamp
    v_max_f32_e64 v64, v64, v233
    v_max_f32_e64 v65, v65, v233
    v_exp_f32_e64 v149, v149 clamp
    v_max_f32_e64 v66, v66, v233
    v_max_f32_e64 v67, v67, v233
    v_exp_f32_e64 v150, v150 clamp
    v_max_f32_e64 v92, v92, v239
    v_max_f32_e64 v93, v93, v239
    v_exp_f32_e64 v151, v151 clamp
    v_max_f32_e64 v94, v94, v239
    v_max_f32_e64 v95, v95, v239
    v_exp_f32_e64 v152, v152 clamp
    v_pk_add_f32 v[144:145], v[144:145], v[8:9]
    v_pk_add_f32 v[146:147], v[146:147], v[10:11]
    v_exp_f32_e64 v153, v153 clamp
    v_pk_add_f32 v[148:149], v[148:149], v[36:37]
    v_exp_f32_e64 v154, v154 clamp
    v_pk_add_f32 v[150:151], v[150:151], v[38:39]
    v_exp_f32_e64 v155, v155 clamp
    v_cvt_pk_bf16_f32 v8, v144, v145
    v_exp_f32_e64 v156, v156 clamp
    v_cvt_pk_bf16_f32 v9, v146, v147
    v_cvt_pk_bf16_f32 v36, v148, v149
    v_exp_f32_e64 v157, v157 clamp
    v_cvt_pk_bf16_f32 v37, v150, v151
    v_exp_f32_e64 v158, v158 clamp
    ds_write_b64 v247, v[8:9] offset:64
    v_exp_f32_e64 v159, v159 clamp
    ds_write_b64 v247, v[36:37] offset:5568
    v_pk_add_f32 v[152:153], v[152:153], v[64:65]
    v_pk_add_f32 v[154:155], v[154:155], v[66:67]
    v_pk_add_f32 v[156:157], v[156:157], v[92:93]
    v_pk_add_f32 v[158:159], v[158:159], v[94:95]
    v_cvt_pk_bf16_f32 v64, v152, v153
    v_cvt_pk_bf16_f32 v65, v154, v155
    v_cvt_pk_bf16_f32 v92, v156, v157
    v_cvt_pk_bf16_f32 v93, v158, v159
    ds_write_b64 v247, v[64:65] offset:11072
    ds_write_b64 v247, v[92:93] offset:16576
    s_branch L_kv_j
L_kv_lin:
.p2align 3
    v_pk_mul_f32 v[144:145], v[8:9], v[216:217] op_sel_hi:[1,0]
    v_pk_mul_f32 v[146:147], v[10:11], v[216:217] op_sel_hi:[1,0]
    v_pk_mul_f32 v[148:149], v[36:37], v[222:223] op_sel_hi:[1,0]
    v_pk_mul_f32 v[150:151], v[38:39], v[222:223] op_sel_hi:[1,0]
    v_pk_mul_f32 v[152:153], v[64:65], v[228:229] op_sel_hi:[1,0]
    v_pk_mul_f32 v[154:155], v[66:67], v[228:229] op_sel_hi:[1,0]
    v_pk_mul_f32 v[156:157], v[92:93], v[234:235] op_sel_hi:[1,0]
    v_pk_mul_f32 v[158:159], v[94:95], v[234:235] op_sel_hi:[1,0]
    v_cvt_pk_bf16_f32 v8, v144, v145
    v_cvt_pk_bf16_f32 v9, v146, v147
    v_cvt_pk_bf16_f32 v36, v148, v149
    v_cvt_pk_bf16_f32 v37, v150, v151
    ds_write_b64 v247, v[8:9] offset:64
    ds_write_b64 v247, v[36:37] offset:5568
    v_cvt_pk_bf16_f32 v64, v152, v153
    v_cvt_pk_bf16_f32 v65, v154, v155
    v_cvt_pk_bf16_f32 v92, v156, v157
    v_cvt_pk_bf16_f32 v93, v158, v159
    ds_write_b64 v247, v[64:65] offset:11072
    ds_write_b64 v247, v[92:93] offset:16576
L_kv_j:
    s_waitcnt lgkmcnt(0)
    v_mov_b32 v208, 163332
    v_mov_b32 v209, 1
    s_mov_b64 exec, 1
    ds_add_u32 v208, v209
    s_mov_b64 exec, -1
    v_lshrrev_b32 v210, 5, v255
    v_bfe_u32 v211, v255, 2, 2
    v_lshl_add_u32 v210, v210, 3, v211
    v_mul_u32_u24 v210, 344, v210
    v_add_u32 v210, 30720, v210
    v_bfe_u32 v212, v255, 4, 1
    v_and_b32 v211, 3, v255
    v_lshl_add_u32 v212, v212, 2, v211
    s_mul_i32 s60, s26, 40
    v_lshlrev_b32 v213, 3, v212
    v_add_u32 v213, s60, v213
    v_cmp_gt_u32 vcc, 5, v212
    v_add_u32 v214, 160, v213
    v_mov_b32 v215, 320
    v_cndmask_b32 v214, v215, v214, vcc
    v_add_u32 v211, v210, v214
    v_add_u32 v210, v210, v213
    v_lshrrev_b32 v212, 5, v255
    v_mul_u32_u24 v212, 320, v212
    v_and_b32 v213, 31, v255
    v_lshl_add_u32 v212, v213, 2, v212
.p2align 3
    v_pk_mul_f32 v[144:145], v[20:21], v[216:217] op_sel:[0,1] op_sel_hi:[1,1]
    v_pk_mul_f32 v[146:147], v[22:23], v[216:217] op_sel:[0,1] op_sel_hi:[1,1]
    v_pk_mul_f32 v[148:149], v[24:25], v[216:217] op_sel:[0,1] op_sel_hi:[1,1]
    v_pk_mul_f32 v[150:151], v[26:27], v[216:217] op_sel:[0,1] op_sel_hi:[1,1]
    v_pk_fma_f32 v[20:21], v[20:21], v[216:217], v[220:221] op_sel:[0,0,1] op_sel_hi:[1,0,1]
    v_pk_fma_f32 v[22:23], v[22:23], v[216:217], v[220:221] op_sel:[0,0,1] op_sel_hi:[1,0,1]
    v_pk_fma_f32 v[24:25], v[24:25], v[216:217], v[220:221] op_sel:[0,0,1] op_sel_hi:[1,0,1]
    v_pk_fma_f32 v[26:27], v[26:27], v[216:217], v[220:221] op_sel:[0,0,1] op_sel_hi:[1,0,1]
    v_max_f32_e64 v20, v20, v221
    v_max_f32_e64 v21, v21, v221
    v_max_f32_e64 v22, v22, v221
    v_max_f32_e64 v23, v23, v221
    v_max_f32_e64 v24, v24, v221
    v_max_f32_e64 v25, v25, v221
    v_max_f32_e64 v26, v26, v221
    v_max_f32_e64 v27, v27, v221
    v_exp_f32_e64 v144, v144 clamp
    v_pk_mul_f32 v[152:153], v[48:49], v[222:223] op_sel:[0,1] op_sel_hi:[1,1]
    v_pk_mul_f32 v[154:155], v[50:51], v[222:223] op_sel:[0,1] op_sel_hi:[1,1]
    v_exp_f32_e64 v145, v145 clamp
    v_pk_mul_f32 v[156:157], v[52:53], v[222:223] op_sel:[0,1] op_sel_hi:[1,1]
    v_pk_mul_f32 v[158:159], v[54:55], v[222:223] op_sel:[0,1] op_sel_hi:[1,1]
    v_exp_f32_e64 v146, v146 clamp
    v_pk_fma_f32 v[48:49], v[48:49], v[222:223], v[226:227] op_sel:[0,0,1] op_sel_hi:[1,0,1]
    v_pk_fma_f32 v[50:51], v[50:51], v[222:223], v[226:227] op_sel:[0,0,1] op_sel_hi:[1,0,1]
    v_exp_f32_e64 v147, v147 clamp
    v_pk_fma_f32 v[52:53], v[52:53], v[222:223], v[226:227] op_sel:[0,0,1] op_sel_hi:[1,0,1]
    v_pk_fma_f32 v[54:55], v[54:55], v[222:223], v[226:227] op_sel:[0,0,1] op_sel_hi:[1,0,1]
    v_exp_f32_e64 v148, v148 clamp
    v_max_f32_e64 v48, v48, v227
    v_max_f32_e64 v49, v49, v227
    v_exp_f32_e64 v149, v149 clamp
    v_max_f32_e64 v50, v50, v227
    v_max_f32_e64 v51, v51, v227
    v_exp_f32_e64 v150, v150 clamp
    v_max_f32_e64 v52, v52, v227
    v_max_f32_e64 v53, v53, v227
    v_exp_f32_e64 v151, v151 clamp
    v_max_f32_e64 v54, v54, v227
    v_max_f32_e64 v55, v55, v227
    v_exp_f32_e64 v152, v152 clamp
    v_pk_add_f32 v[144:145], v[144:145], v[20:21]
    v_pk_add_f32 v[146:147], v[146:147], v[22:23]
    v_exp_f32_e64 v153, v153 clamp
    v_pk_add_f32 v[148:149], v[148:149], v[24:25]
    v_exp_f32_e64 v154, v154 clamp
    v_pk_add_f32 v[150:151], v[150:151], v[26:27]
    v_exp_f32_e64 v155, v155 clamp
    v_cvt_pk_bf16_f32 v20, v144, v145
    v_exp_f32_e64 v156, v156 clamp
    v_cvt_pk_bf16_f32 v21, v146, v147
    v_exp_f32_e64 v157, v157 clamp
    v_cvt_pk_bf16_f32 v22, v148, v149
    v_exp_f32_e64 v158, v158 clamp
    v_cvt_pk_bf16_f32 v23, v150, v151
    v_exp_f32_e64 v159, v159 clamp
    buffer_store_dwordx4 v[20:23], v252, s[36:39], s64 offen sc1
    v_pk_add_f32 v[152:153], v[152:153], v[48:49]
    v_pk_add_f32 v[154:155], v[154:155], v[50:51]
    v_pk_add_f32 v[156:157], v[156:157], v[52:53]
    v_pk_add_f32 v[158:159], v[158:159], v[54:55]
    v_cvt_pk_bf16_f32 v48, v152, v153
    v_cvt_pk_bf16_f32 v49, v154, v155
    v_cvt_pk_bf16_f32 v50, v156, v157
    v_cvt_pk_bf16_f32 v51, v158, v159
    buffer_store_dwordx4 v[48:51], v252, s[36:39], s65 offen sc1
    s_mov_b32 s96, 800000
    v_mov_b32 v208, 163332
L_lw18:
    ds_read_b32 v209, v208
    s_waitcnt lgkmcnt(0)
    v_readfirstlane_b32 s60, v209
    s_nop 0
    s_cmp_ge_u32 s60, 4
    s_cbranch_scc1 L_lwe19
    s_sleep 0
    s_sub_u32 s96, s96, 1
    s_cmp_lg_u32 s96, 0
    s_cbranch_scc1 L_lw18
L_lwe19:
    ds_read_b64_tr_b16 v[112:113], v210 offset:0
    ds_read_b64_tr_b16 v[114:115], v210 offset:1376
    ds_read_b64_tr_b16 v[160:161], v211 offset:0
    ds_read_b64_tr_b16 v[162:163], v211 offset:1376
    ds_read_b64_tr_b16 v[116:117], v210 offset:5504
    ds_read_b64_tr_b16 v[118:119], v210 offset:6880
    ds_read_b64_tr_b16 v[164:165], v211 offset:5504
    ds_read_b64_tr_b16 v[166:167], v211 offset:6880
    ds_read_b64_tr_b16 v[120:121], v210 offset:11008
    ds_read_b64_tr_b16 v[122:123], v210 offset:12384
    ds_read_b64_tr_b16 v[168:169], v211 offset:11008
    ds_read_b64_tr_b16 v[170:171], v211 offset:12384
    s_waitcnt lgkmcnt(8)
    v_mfma_f32_32x32x16_bf16 v[192:207], v[160:163], v[112:115], 0
    ds_read_b64_tr_b16 v[124:125], v210 offset:16512
    ds_read_b64_tr_b16 v[126:127], v210 offset:17888
    ds_read_b64_tr_b16 v[172:173], v211 offset:16512
    ds_read_b64_tr_b16 v[174:175], v211 offset:17888
    s_waitcnt lgkmcnt(8)
    v_mfma_f32_32x32x16_bf16 v[192:207], v[164:167], v[116:119], v[192:207]
    ds_read_b64_tr_b16 v[128:129], v210 offset:22016
    ds_read_b64_tr_b16 v[130:131], v210 offset:23392
    ds_read_b64_tr_b16 v[176:177], v211 offset:22016
    ds_read_b64_tr_b16 v[178:179], v211 offset:23392
    s_waitcnt lgkmcnt(8)
    v_mfma_f32_32x32x16_bf16 v[192:207], v[168:171], v[120:123], v[192:207]
    ds_read_b64_tr_b16 v[132:133], v210 offset:27520
    ds_read_b64_tr_b16 v[134:135], v210 offset:28896
    ds_read_b64_tr_b16 v[180:181], v211 offset:27520
    ds_read_b64_tr_b16 v[182:183], v211 offset:28896
    s_waitcnt lgkmcnt(8)
    v_mfma_f32_32x32x16_bf16 v[192:207], v[172:175], v[124:127], v[192:207]
    ds_read_b64_tr_b16 v[136:137], v210 offset:33024
    ds_read_b64_tr_b16 v[138:139], v210 offset:34400
    ds_read_b64_tr_b16 v[184:185], v211 offset:33024
    ds_read_b64_tr_b16 v[186:187], v211 offset:34400
    s_waitcnt lgkmcnt(8)
    v_mfma_f32_32x32x16_bf16 v[192:207], v[176:179], v[128:131], v[192:207]
    ds_read_b64_tr_b16 v[140:141], v210 offset:38528
    ds_read_b64_tr_b16 v[142:143], v210 offset:39904
    ds_read_b64_tr_b16 v[188:189], v211 offset:38528
    ds_read_b64_tr_b16 v[190:191], v211 offset:39904
    s_waitcnt lgkmcnt(8)
    v_mfma_f32_32x32x16_bf16 v[192:207], v[180:183], v[132:135], v[192:207]
    s_waitcnt lgkmcnt(4)
    v_mfma_f32_32x32x16_bf16 v[192:207], v[184:187], v[136:139], v[192:207]
    s_waitcnt lgkmcnt(0)
    v_mfma_f32_32x32x16_bf16 v[192:207], v[188:191], v[140:143], v[192:207]
    v_mov_b32 v208, 163360
    v_mov_b32 v209, 1
    s_mov_b64 exec, 1
    ds_add_u32 v208, v209
    s_mov_b64 exec, -1
    s_lshl_b32 s62, s49, 2
    s_add_u32 s62, s62, s26
    s_mul_i32 s62, s62, 1728
    s_add_u32 s62, s62, 12845056
    s_lshl_b32 s60, s26, 11
    s_add_u32 s60, s60, 155136
    v_add_u32 v213, s60, v212
    v_lshlrev_b32 v214, 2, v255
    v_add_u32 v215, s60, v214
    s_mov_b32 exec_lo, 0xfffff
    s_mov_b32 exec_hi, 0xfffff
    ds_write_b32 v213, v192 offset:0
    ds_write_b32 v213, v193 offset:80
    ds_write_b32 v213, v194 offset:160
    ds_write_b32 v213, v195 offset:240
    ds_write_b32 v213, v196 offset:640
    ds_write_b32 v213, v197 offset:720
    ds_write_b32 v213, v198 offset:800
    ds_write_b32 v213, v199 offset:880
    ds_write_b32 v213, v200 offset:1280
    s_mov_b32 exec_hi, 0
    ds_write_b32 v213, v201 offset:1360
    ds_write_b32 v213, v202 offset:1440
    ds_write_b32 v213, v203 offset:1520
    s_mov_b64 exec, -1
    s_waitcnt lgkmcnt(0)
    ds_read_b32 v192, v215 offset:0
    ds_read_b32 v193, v215 offset:256
    ds_read_b32 v194, v215 offset:512
    ds_read_b32 v195, v215 offset:768
    ds_read_b32 v196, v215 offset:1024
    ds_read_b32 v197, v215 offset:1280
    ds_read_b32 v198, v215 offset:1536
    s_waitcnt lgkmcnt(6)
    buffer_atomic_add_f32 v192, v214, s[36:39], s62 offen offset:0
    s_waitcnt lgkmcnt(5)
    buffer_atomic_add_f32 v193, v214, s[36:39], s62 offen offset:256
    s_waitcnt lgkmcnt(4)
    buffer_atomic_add_f32 v194, v214, s[36:39], s62 offen offset:512
    s_waitcnt lgkmcnt(3)
    buffer_atomic_add_f32 v195, v214, s[36:39], s62 offen offset:768
    s_waitcnt lgkmcnt(2)
    buffer_atomic_add_f32 v196, v214, s[36:39], s62 offen offset:1024
    s_waitcnt lgkmcnt(1)
    buffer_atomic_add_f32 v197, v214, s[36:39], s62 offen offset:1280
    s_waitcnt lgkmcnt(0)
    s_mov_b32 exec_hi, 15
    buffer_atomic_add_f32 v198, v214, s[36:39], s62 offen offset:1536
    s_mov_b64 exec, -1
.p2align 3
    v_pk_mul_f32 v[144:145], v[76:77], v[228:229] op_sel:[0,1] op_sel_hi:[1,1]
    v_pk_mul_f32 v[146:147], v[78:79], v[228:229] op_sel:[0,1] op_sel_hi:[1,1]
    v_pk_mul_f32 v[148:149], v[80:81], v[228:229] op_sel:[0,1] op_sel_hi:[1,1]
    v_pk_mul_f32 v[150:151], v[82:83], v[228:229] op_sel:[0,1] op_sel_hi:[1,1]
    v_pk_fma_f32 v[76:77], v[76:77], v[228:229], v[232:233] op_sel:[0,0,1] op_sel_hi:[1,0,1]
    v_pk_fma_f32 v[78:79], v[78:79], v[228:229], v[232:233] op_sel:[0,0,1] op_sel_hi:[1,0,1]
    v_pk_fma_f32 v[80:81], v[80:81], v[228:229], v[232:233] op_sel:[0,0,1] op_sel_hi:[1,0,1]
    v_pk_fma_f32 v[82:83], v[82:83], v[228:229], v[232:233] op_sel:[0,0,1] op_sel_hi:[1,0,1]
    v_max_f32_e64 v76, v76, v233
    v_max_f32_e64 v77, v77, v233
    v_max_f32_e64 v78, v78, v233
    v_max_f32_e64 v79, v79, v233
    v_max_f32_e64 v80, v80, v233
    v_max_f32_e64 v81, v81, v233
    v_max_f32_e64 v82, v82, v233
    v_max_f32_e64 v83, v83, v233
    v_exp_f32_e64 v144, v144 clamp
    v_pk_mul_f32 v[152:153], v[104:105], v[234:235] op_sel:[0,1] op_sel_hi:[1,1]
    v_pk_mul_f32 v[154:155], v[106:107], v[234:235] op_sel:[0,1] op_sel_hi:[1,1]
    v_exp_f32_e64 v145, v145 clamp
    v_pk_mul_f32 v[156:157], v[108:109], v[234:235] op_sel:[0,1] op_sel_hi:[1,1]
    v_pk_mul_f32 v[158:159], v[110:111], v[234:235] op_sel:[0,1] op_sel_hi:[1,1]
    v_exp_f32_e64 v146, v146 clamp
    v_pk_fma_f32 v[104:105], v[104:105], v[234:235], v[238:239] op_sel:[0,0,1] op_sel_hi:[1,0,1]
    v_pk_fma_f32 v[106:107], v[106:107], v[234:235], v[238:239] op_sel:[0,0,1] op_sel_hi:[1,0,1]
    v_exp_f32_e64 v147, v147 clamp
    v_pk_fma_f32 v[108:109], v[108:109], v[234:235], v[238:239] op_sel:[0,0,1] op_sel_hi:[1,0,1]
    v_pk_fma_f32 v[110:111], v[110:111], v[234:235], v[238:239] op_sel:[0,0,1] op_sel_hi:[1,0,1]
    v_exp_f32_e64 v148, v148 clamp
    v_max_f32_e64 v104, v104, v239
    v_max_f32_e64 v105, v105, v239
    v_exp_f32_e64 v149, v149 clamp
    v_max_f32_e64 v106, v106, v239
    v_max_f32_e64 v107, v107, v239
    v_exp_f32_e64 v150, v150 clamp
    v_max_f32_e64 v108, v108, v239
    v_max_f32_e64 v109, v109, v239
    v_exp_f32_e64 v151, v151 clamp
    v_max_f32_e64 v110, v110, v239
    v_max_f32_e64 v111, v111, v239
    v_exp_f32_e64 v152, v152 clamp
    v_pk_add_f32 v[144:145], v[144:145], v[76:77]
    v_pk_add_f32 v[146:147], v[146:147], v[78:79]
    v_exp_f32_e64 v153, v153 clamp
    v_pk_add_f32 v[148:149], v[148:149], v[80:81]
    v_exp_f32_e64 v154, v154 clamp
    v_pk_add_f32 v[150:151], v[150:151], v[82:83]
    v_exp_f32_e64 v155, v155 clamp
    v_cvt_pk_bf16_f32 v76, v144, v145
    v_exp_f32_e64 v156, v156 clamp
    v_cvt_pk_bf16_f32 v77, v146, v147
    v_exp_f32_e64 v157, v157 clamp
    v_cvt_pk_bf16_f32 v78, v148, v149
    v_exp_f32_e64 v158, v158 clamp
    v_cvt_pk_bf16_f32 v79, v150, v151
    v_exp_f32_e64 v159, v159 clamp
    buffer_store_dwordx4 v[76:79], v252, s[36:39], s66 offen sc1
    v_pk_add_f32 v[152:153], v[152:153], v[104:105]
    v_pk_add_f32 v[154:155], v[154:155], v[106:107]
    v_pk_add_f32 v[156:157], v[156:157], v[108:109]
    v_pk_add_f32 v[158:159], v[158:159], v[110:111]
    v_cvt_pk_bf16_f32 v104, v152, v153
    v_cvt_pk_bf16_f32 v105, v154, v155
    v_cvt_pk_bf16_f32 v106, v156, v157
    v_cvt_pk_bf16_f32 v107, v158, v159
    buffer_store_dwordx4 v[104:107], v252, s[36:39], s67 offen sc1
L_ep_done:
    v_mov_b32 v112, 163356
    v_mov_b32 v113, 1
    s_mov_b64 exec, 1
    ds_add_u32 v112, v113
    s_mov_b64 exec, -1
    v_add_u32 v249, s84, v254
    v_mul_u32_u24 v240, 205, v255
    v_lshrrev_b32 v240, 10, v240
    v_mul_u32_u24 v241, 5, v240
    v_sub_u32 v241, v255, v241
    v_mul_u32_u24 v240, 72, v240
    v_lshl_add_u32 v240, v241, 3, v240
    s_mul_i32 s75, s26, 1584
    s_add_u32 s75, s75, 51200
    v_add_u32 v250, s75, v240
    v_add_u32 v118, s75, v254
    s_mov_b32 s75, 51200
    v_and_b32 v240, 15, v255
    v_lshrrev_b32 v241, 4, v255
    v_lshlrev_b32 v241, 3, v241
    v_add_u32 v241, s75, v241
    v_mul_u32_u24 v251, 72, v240
    v_add_u32 v251, v251, v241
    v_and_b32 v242, 3, v255
    v_cmp_eq_u32 vcc, 0, v242
    v_lshrrev_b32 v240, 2, v240
    v_add_u32 v240, 16, v240
    v_mov_b32 v242, 20
    v_cndmask_b32 v240, v242, v240, vcc
    v_mul_u32_u24 v252, 72, v240
    v_add_u32 v252, v252, v241
    s_waitcnt vmcnt(0)
L_drained:
    v_mov_b32 v112, 163336
    v_mov_b32 v113, 1
    s_mov_b64 exec, 1
    ds_add_rtn_u32 v113, v112, v113
    s_mov_b64 exec, -1
    s_waitcnt lgkmcnt(0)
    v_readfirstlane_b32 s60, v113
    s_nop 0
    s_cmp_lg_u32 s60, 3
    s_cbranch_scc1 L_nosig
    s_cmp_eq_u32 s50, 1
    s_cbranch_scc0 L_sig_att
    s_mov_b32 s68, 1
    s_lshl_b32 s60, s48, 12
    s_add_u32 s60, s60, 12900352
    s_add_u32 s76, s24, s60
    s_addc_u32 s77, s25, 0
    s_atomic_add s68, s[76:77], 0
    s_atomic_add s68, s[76:77], 256
    s_atomic_add s68, s[76:77], 512
    s_atomic_add s68, s[76:77], 768
    s_atomic_add s68, s[76:77], 1024
    s_atomic_add s68, s[76:77], 1280
    s_atomic_add s68, s[76:77], 1536
    s_atomic_add s68, s[76:77], 1792
    s_atomic_add s68, s[76:77], 2048
    s_atomic_add s68, s[76:77], 2304
    s_atomic_add s68, s[76:77], 2560
    s_atomic_add s68, s[76:77], 2816
    s_atomic_add s68, s[76:77], 3072
    s_atomic_add s68, s[76:77], 3328
    s_atomic_add s68, s[76:77], 3584
    s_atomic_add s68, s[76:77], 3840
    s_branch L_nosig
L_sig_att:
    s_cmp_eq_u32 s50, 2
    s_cbranch_scc1 L_sig_q
    s_setprio 3
    s_lshl_b32 s60, s49, 8
    s_add_u32 s60, s60, 12900480
    v_lshlrev_b32 v122, 11, v255
    v_mov_b32 v123, 1
    s_mov_b32 exec_lo, 0xffffffff
    s_mov_b32 exec_hi, 0
    buffer_atomic_add v123, v122, s[36:39], s60 offen
    s_mov_b64 exec, -1
    s_lshl_b32 s60, s48, 12
    s_add_u32 s60, s60, 12900480
    v_lshlrev_b32 v120, 8, v255
    v_mov_b32 v121, 1
    s_mov_b64 exec, 0xffff
    buffer_atomic_add v121, v120, s[36:39], s60 offen
    s_mov_b64 exec, -1
    s_branch L_nosig
L_sig_q:
    s_mov_b32 s68, 1
    s_lshl_b32 s60, s48, 12
    s_add_u32 s60, s60, 12900480
    s_add_u32 s76, s24, s60
    s_addc_u32 s77, s25, 0
    s_atomic_add s68, s[76:77], 0
    s_atomic_add s68, s[76:77], 256
    s_atomic_add s68, s[76:77], 512
    s_atomic_add s68, s[76:77], 768
    s_atomic_add s68, s[76:77], 1024
    s_atomic_add s68, s[76:77], 1280
    s_atomic_add s68, s[76:77], 1536
    s_atomic_add s68, s[76:77], 1792
    s_atomic_add s68, s[76:77], 2048
    s_atomic_add s68, s[76:77], 2304
    s_atomic_add s68, s[76:77], 2560
    s_atomic_add s68, s[76:77], 2816
    s_atomic_add s68, s[76:77], 3072
    s_atomic_add s68, s[76:77], 3328
    s_atomic_add s68, s[76:77], 3584
    s_atomic_add s68, s[76:77], 3840
L_nosig:
    s_mov_b32 s96, 800000
    v_mov_b32 v242, 163356
L_lw20:
    ds_read_b32 v243, v242
    s_waitcnt lgkmcnt(0)
    v_readfirstlane_b32 s60, v243
    s_nop 0
    s_cmp_ge_u32 s60, 4
    s_cbranch_scc1 L_lwe21
    s_sleep 1
    s_sub_u32 s96, s96, 1
    s_cmp_lg_u32 s96, 0
    s_cbranch_scc1 L_lw20
L_lwe21:
    v_mov_b32 v244, 0
    v_mov_b32 v245, 0
    v_mov_b32 v246, 0
    v_mov_b32 v247, 0
    ds_write_b128 v118, v[244:247]
    s_mov_b32 exec_hi, 7
    ds_write_b128 v118, v[244:247] offset:1024
    s_mov_b64 exec, -1
    v_and_b32 v242, 15, v255
    v_mul_u32_u24 v242, 1280, v242
    v_lshrrev_b32 v248, 4, v255
    v_lshlrev_b32 v248, 3, v248
    v_add_u32 v243, v242, v248
    v_and_b32 v248, 15, v255
    v_mul_u32_u24 v248, 1280, v248
    v_bfe_u32 v242, v255, 4, 1
    v_lshl_add_u32 v248, v242, 5, v248
    v_lshrrev_b32 v242, 5, v255
    v_lshl_add_u32 v248, v242, 4, v248
    v_mov_b32 v245, 0x358637bd
    v_lshlrev_b32 v242, 3, v255
    s_setprio 3
    s_mov_b32 s69, 0
    s_add_u32 s60, s100, 65536
    s_add_u32 s61, s60, 4096
    buffer_load_dwordx4 v[160:163], v254, s[36:39], s60 offen offset:0 sc1
    buffer_load_dwordx4 v[164:167], v254, s[36:39], s60 offen offset:1024 sc1
    buffer_load_dwordx4 v[168:171], v254, s[36:39], s60 offen offset:2048 sc1
    buffer_load_dwordx4 v[172:175], v254, s[36:39], s60 offen offset:3072 sc1
    buffer_load_dwordx4 v[176:179], v254, s[36:39], s61 offen offset:0 sc1
    s_mov_b32 s69, 1
    s_add_u32 s60, s100, 70656
    s_add_u32 s61, s60, 4096
    buffer_load_dwordx4 v[180:183], v254, s[36:39], s60 offen offset:0 sc1
    buffer_load_dwordx4 v[184:187], v254, s[36:39], s60 offen offset:1024 sc1
    buffer_load_dwordx4 v[188:191], v254, s[36:39], s60 offen offset:2048 sc1
    buffer_load_dwordx4 v[192:195], v254, s[36:39], s60 offen offset:3072 sc1
    buffer_load_dwordx4 v[196:199], v254, s[36:39], s61 offen offset:0 sc1
    s_mov_b32 s69, 2
    s_add_u32 s60, s100, 75776
    s_add_u32 s61, s60, 4096
    buffer_load_dwordx4 v[200:203], v254, s[36:39], s60 offen offset:0 sc1
    buffer_load_dwordx4 v[204:207], v254, s[36:39], s60 offen offset:1024 sc1
    buffer_load_dwordx4 v[208:211], v254, s[36:39], s60 offen offset:2048 sc1
    buffer_load_dwordx4 v[212:215], v254, s[36:39], s60 offen offset:3072 sc1
    buffer_load_dwordx4 v[216:219], v254, s[36:39], s61 offen offset:0 sc1
    s_mov_b32 s69, 3
    s_add_u32 s60, s100, 80896
    s_add_u32 s61, s60, 4096
    buffer_load_dwordx4 v[220:223], v254, s[36:39], s60 offen offset:0 sc1
    buffer_load_dwordx4 v[224:227], v254, s[36:39], s60 offen offset:1024 sc1
    buffer_load_dwordx4 v[228:231], v254, s[36:39], s60 offen offset:2048 sc1
    buffer_load_dwordx4 v[232:235], v254, s[36:39], s60 offen offset:3072 sc1
    buffer_load_dwordx4 v[236:239], v254, s[36:39], s61 offen offset:0 sc1
    s_mov_b32 s69, 4
    s_buffer_load_dword s70, s[36:39], s80 glc
    s_add_u32 s60, s100, 86016
    s_add_u32 s61, s60, 4096
    buffer_load_dwordx4 v[140:143], v254, s[36:39], s60 offen offset:0 sc1
    buffer_load_dwordx4 v[144:147], v254, s[36:39], s60 offen offset:1024 sc1
    buffer_load_dwordx4 v[148:151], v254, s[36:39], s60 offen offset:2048 sc1
    buffer_load_dwordx4 v[152:155], v254, s[36:39], s60 offen offset:3072 sc1
    buffer_load_dwordx4 v[156:159], v254, s[36:39], s61 offen offset:0 sc1
    s_mov_b32 s69, 5
    s_setprio 3
    s_waitcnt lgkmcnt(0)
    s_cmp_ge_u32 s70, 25
    s_cbranch_scc1 L_att_go
    s_mov_b32 s96, 100000
    s_add_u32 s64, s24, s80
    s_addc_u32 s65, s25, 0
L_cp22:
    s_load_dword s66, s[64:65], 0 glc
    s_waitcnt lgkmcnt(0)
    s_cmp_ge_u32 s66, 25
    s_cbranch_scc1 L_cpe23
    s_sleep 1
    s_sub_u32 s96, s96, 1
    s_cmp_lg_u32 s96, 0
    s_cbranch_scc1 L_cp22
L_cpe23:
L_att_go:
    s_setprio 3
    buffer_load_dwordx4 v[0:3], v254, s[36:39], s14 offen offset:0 sc1
    s_mov_b32 exec_hi, 0x1fff
    buffer_load_dwordx4 v[4:7], v254, s[36:39], s14 offen offset:960 sc1
    s_mov_b64 exec, -1
    buffer_load_dwordx4 v[28:31], v254, s[36:39], s4 offen offset:0 sc1
    buffer_load_dwordx4 v[32:35], v254, s[36:39], s4 offen offset:1024 sc1
    buffer_load_dwordx4 v[36:39], v254, s[36:39], s4 offen offset:2048 sc1
    s_waitcnt vmcnt(4)
    v_cvt_pk_bf16_f32 v0, v0, v1
    v_cvt_pk_bf16_f32 v1, v2, v3
    ds_write_b64 v250, v[0:1] offset:24
    s_waitcnt vmcnt(3)
    v_cvt_pk_bf16_f32 v4, v4, v5
    v_cvt_pk_bf16_f32 v5, v6, v7
    s_mov_b32 exec_hi, 0x1fff
    ds_write_b64 v250, v[4:5] offset:888
    s_mov_b64 exec, -1
    s_waitcnt lgkmcnt(0)
    v_mov_b32 v240, 163352
    v_mov_b32 v241, 1
    s_mov_b64 exec, 1
    ds_add_u32 v240, v241
    s_mov_b64 exec, -1
    s_mov_b32 s96, 800000
    v_mov_b32 v240, 163352
L_lw24:
    ds_read_b32 v241, v240
    s_waitcnt lgkmcnt(0)
    v_readfirstlane_b32 s60, v241
    s_nop 0
    s_cmp_ge_u32 s60, 4
    s_cbranch_scc1 L_lwe25
    s_sleep 0
    s_sub_u32 s96, s96, 1
    s_cmp_lg_u32 s96, 0
    s_cbranch_scc1 L_lw24
L_lwe25:
    ds_read_b64 v[44:45], v252 offset:24
    ds_read_b64 v[46:47], v252 offset:56
    ds_read_b64 v[40:41], v251 offset:24
    ds_read_b64 v[42:43], v251 offset:56
    ds_read_b64 v[52:53], v252 offset:1600
    ds_read_b64 v[54:55], v252 offset:1632
    ds_read_b64 v[48:49], v251 offset:1600
    ds_read_b64 v[50:51], v251 offset:1632
    ds_read_b64 v[60:61], v252 offset:3176
    ds_read_b64 v[62:63], v252 offset:3208
    ds_read_b64 v[56:57], v251 offset:3176
    ds_read_b64 v[58:59], v251 offset:3208
    s_waitcnt lgkmcnt(8)
    ds_read_b64 v[68:69], v252 offset:4752
    ds_read_b64 v[70:71], v252 offset:4784
    ds_read_b64 v[64:65], v251 offset:4752
    ds_read_b64 v[66:67], v251 offset:4784
    s_waitcnt vmcnt(0)
    s_bitcmp1_b32 s59, 0
    s_cbranch_scc1 L_num_odd
    s_waitcnt lgkmcnt(12)
    v_mfma_f32_16x16x32_bf16 v[84:87], v[44:47], v[28:31], v[244:247]
    v_mfma_f32_16x16x32_bf16 v[80:83], v[40:43], v[28:31], 0
    s_waitcnt lgkmcnt(8)
    v_mfma_f32_16x16x32_bf16 v[92:95], v[52:55], v[30:33], v[244:247]
    v_mfma_f32_16x16x32_bf16 v[88:91], v[48:51], v[30:33], 0
    s_waitcnt lgkmcnt(4)
    v_mfma_f32_16x16x32_bf16 v[100:103], v[60:63], v[32:35], v[244:247]
    v_mfma_f32_16x16x32_bf16 v[96:99], v[56:59], v[32:35], 0
    s_waitcnt lgkmcnt(0)
    v_mfma_f32_16x16x32_bf16 v[108:111], v[68:71], v[34:37], v[244:247]
    v_mfma_f32_16x16x32_bf16 v[104:107], v[64:67], v[34:37], 0
    s_branch L_num_done
L_num_odd:
    s_waitcnt lgkmcnt(12)
    v_mfma_f32_16x16x32_bf16 v[84:87], v[44:47], v[30:33], v[244:247]
    v_mfma_f32_16x16x32_bf16 v[80:83], v[40:43], v[30:33], 0
    s_waitcnt lgkmcnt(8)
    v_mfma_f32_16x16x32_bf16 v[92:95], v[52:55], v[32:35], v[244:247]
    v_mfma_f32_16x16x32_bf16 v[88:91], v[48:51], v[32:35], 0
    s_waitcnt lgkmcnt(4)
    v_mfma_f32_16x16x32_bf16 v[100:103], v[60:63], v[34:37], v[244:247]
    v_mfma_f32_16x16x32_bf16 v[96:99], v[56:59], v[34:37], 0
    s_waitcnt lgkmcnt(0)
    v_mfma_f32_16x16x32_bf16 v[108:111], v[68:71], v[36:39], v[244:247]
    v_mfma_f32_16x16x32_bf16 v[104:107], v[64:67], v[36:39], 0
L_num_done:
    v_rcp_f32 v86, v85
    v_rcp_f32 v94, v93
    s_nop 1
    v_rcp_f32 v102, v101
    s_nop 1
    v_rcp_f32 v110, v109
    v_mul_f32 v80, v80, v86
    v_mul_f32 v81, v81, v86
    v_mul_f32 v82, v82, v86
    v_mul_f32 v83, v83, v86
    v_mul_f32 v84, v84, v86
    v_mul_f32 v88, v88, v94
    v_mul_f32 v89, v89, v94
    v_mul_f32 v90, v90, v94
    v_mul_f32 v91, v91, v94
    v_mul_f32 v92, v92, v94
    v_mul_f32 v96, v96, v102
    v_mul_f32 v97, v97, v102
    v_mul_f32 v98, v98, v102
    v_mul_f32 v99, v99, v102
    v_mul_f32 v100, v100, v102
    v_mul_f32 v104, v104, v110
    v_mul_f32 v105, v105, v110
    v_mul_f32 v106, v106, v110
    v_mul_f32 v107, v107, v110
    v_mul_f32 v108, v108, v110
    v_cvt_pk_bf16_f32 v112, v80, v81
    v_cvt_pk_bf16_f32 v113, v82, v83
    v_cvt_pk_bf16_f32 v114, v84, v88
    v_cvt_pk_bf16_f32 v115, v89, v90
    buffer_store_dwordx4 v[112:115], v254, s[36:39], s15 offen sc1
    v_cvt_pk_bf16_f32 v116, v91, v92
    v_cvt_pk_bf16_f32 v117, v96, v97
    v_cvt_pk_bf16_f32 v118, v98, v99
    v_cvt_pk_bf16_f32 v119, v100, v104
    buffer_store_dwordx4 v[116:119], v254, s[36:39], s15 offen offset:1024 sc1
    v_cvt_pk_bf16_f32 v120, v105, v106
    v_cvt_pk_bf16_f32 v121, v107, v108
    buffer_store_dwordx2 v[120:121], v242, s[36:39], s15 offen offset:2048 sc1
    s_mov_b32 s68, 1
    v_lshlrev_b32 v40, 8, v255
    v_mov_b32 v41, 1
    s_waitcnt vmcnt(0)
    v_mov_b32 v240, 163368
    v_mov_b32 v241, 1
    s_mov_b64 exec, 1
    ds_add_rtn_u32 v241, v240, v241
    s_mov_b64 exec, -1
    s_waitcnt lgkmcnt(0)
    v_readfirstlane_b32 s60, v241
    s_nop 0
    s_cmp_lg_u32 s60, 3
    s_cbranch_scc1 L_noosig
    s_atomic_add s68, s[82:83], 0
    s_atomic_add s68, s[82:83], 256
    s_atomic_add s68, s[82:83], 512
    s_atomic_add s68, s[82:83], 768
    s_atomic_add s68, s[82:83], 1024
    s_atomic_add s68, s[82:83], 1280
    s_atomic_add s68, s[82:83], 1536
    s_atomic_add s68, s[82:83], 1792
L_noosig:
    s_setprio 0
    s_setprio 1
    s_mov_b32 s96, 100000
    s_add_u32 s64, s24, s81
    s_addc_u32 s65, s25, 0
L_cp26:
    s_load_dword s66, s[64:65], 0 glc
    s_waitcnt lgkmcnt(0)
    s_cmp_ge_u32 s66, 2
    s_cbranch_scc1 L_cpe27
    s_sleep 1
    s_sub_u32 s96, s96, 1
    s_cmp_lg_u32 s96, 0
    s_cbranch_scc1 L_cp26
L_cpe27:
    buffer_load_dwordx4 v[20:23], v254, s[36:39], s89 offen sc1
    buffer_load_dwordx4 v[24:27], v254, s[36:39], s89 offen offset:1024 sc1
    buffer_load_dwordx2 v[28:29], v242, s[36:39], s89 offen offset:2048 sc1
    s_add_u32 s89, s89, 2560
    buffer_load_dwordx4 v[30:33], v254, s[36:39], s89 offen sc1
    buffer_load_dwordx4 v[34:37], v254, s[36:39], s89 offen offset:1024 sc1
    buffer_load_dwordx2 v[38:39], v242, s[36:39], s89 offen offset:2048 sc1
    buffer_load_dwordx4 v[40:43], v254, s[36:39], s90 offen sc1
    buffer_load_dwordx4 v[44:47], v254, s[36:39], s90 offen offset:1024 sc1
    buffer_load_dwordx2 v[48:49], v242, s[36:39], s90 offen offset:2048 sc1
    s_add_u32 s90, s90, 2560
    buffer_load_dwordx4 v[50:53], v254, s[36:39], s90 offen sc1
    s_setprio 3
    s_waitcnt vmcnt(9)
    buffer_load_dwordx4 v[54:57], v254, s[36:39], s90 offen offset:1024 sc1
    v_mfma_f32_16x16x32_bf16 v[80:83], v[160:163], v[20:23], 0
    v_mfma_f32_16x16x32_bf16 v[84:87], v[164:167], v[20:23], 0
    v_mfma_f32_16x16x32_bf16 v[88:91], v[168:171], v[20:23], 0
    v_mfma_f32_16x16x32_bf16 v[92:95], v[172:175], v[20:23], 0
    v_mfma_f32_16x16x32_bf16 v[96:99], v[176:179], v[20:23], 0
    v_add_u32 v244, s32, v254
    v_add_u32 v245, s33, v254
    s_waitcnt vmcnt(9)
    buffer_load_dwordx2 v[58:59], v242, s[36:39], s90 offen offset:2048 sc1
    v_mfma_f32_16x16x32_bf16 v[80:83], v[180:183], v[24:27], v[80:83]
    v_add_u32 v246, s34, v254
    v_add_u32 v247, s35, v254
    v_mfma_f32_16x16x32_bf16 v[84:87], v[184:187], v[24:27], v[84:87]
    s_lshl_b32 s63, s27, 2
    s_add_u32 s63, s63, 163376
    v_mov_b32 v250, s63
    ds_read_b32 v251, v250
    v_mfma_f32_16x16x32_bf16 v[88:91], v[188:191], v[24:27], v[88:91]
    v_mfma_f32_16x16x32_bf16 v[92:95], v[192:195], v[24:27], v[92:95]
    v_mfma_f32_16x16x32_bf16 v[96:99], v[196:199], v[24:27], v[96:99]
    s_waitcnt vmcnt(8)
    buffer_load_dwordx4 v[60:63], v254, s[36:39], s91 offen sc1
    buffer_load_dwordx4 v[64:67], v254, s[36:39], s91 offen offset:1024 sc1
    v_mfma_f32_16x16x32_bf16 v[80:83], v[200:203], v[28:31], v[80:83]
    v_mfma_f32_16x16x32_bf16 v[84:87], v[204:207], v[28:31], v[84:87]
    v_mfma_f32_16x16x32_bf16 v[88:91], v[208:211], v[28:31], v[88:91]
    v_mfma_f32_16x16x32_bf16 v[92:95], v[212:215], v[28:31], v[92:95]
    v_mfma_f32_16x16x32_bf16 v[96:99], v[216:219], v[28:31], v[96:99]
    s_waitcnt vmcnt(9)
    buffer_load_dwordx2 v[68:69], v242, s[36:39], s91 offen offset:2048 sc1
    v_mfma_f32_16x16x32_bf16 v[80:83], v[220:223], v[32:35], v[80:83]
    v_mfma_f32_16x16x32_bf16 v[84:87], v[224:227], v[32:35], v[84:87]
    v_mfma_f32_16x16x32_bf16 v[88:91], v[228:231], v[32:35], v[88:91]
    v_mfma_f32_16x16x32_bf16 v[92:95], v[232:235], v[32:35], v[92:95]
    v_mfma_f32_16x16x32_bf16 v[96:99], v[236:239], v[32:35], v[96:99]
    s_waitcnt vmcnt(9)
    s_add_u32 s91, s91, 2560
    buffer_load_dwordx4 v[70:73], v254, s[36:39], s91 offen sc1
    v_mfma_f32_16x16x32_bf16 v[80:83], v[140:143], v[36:39], v[80:83]
    v_mfma_f32_16x16x32_bf16 v[84:87], v[144:147], v[36:39], v[84:87]
    v_mfma_f32_16x16x32_bf16 v[88:91], v[148:151], v[36:39], v[88:91]
    v_mfma_f32_16x16x32_bf16 v[92:95], v[152:155], v[36:39], v[92:95]
    v_mfma_f32_16x16x32_bf16 v[96:99], v[156:159], v[36:39], v[96:99]
    s_mov_b32 s96, 800000
L_zw28:
    s_waitcnt lgkmcnt(0)
    v_readfirstlane_b32 s60, v251
    s_nop 0
    s_cmp_lg_u32 s60, 0
    s_cbranch_scc1 L_zwe29
    s_sleep 1
    ds_read_b32 v251, v250
    s_sub_u32 s96, s96, 1
    s_cmp_lg_u32 s96, 0
    s_cbranch_scc1 L_zw28
L_zwe29:
    s_waitcnt vmcnt(9)
    buffer_load_dwordx4 v[74:77], v254, s[36:39], s91 offen offset:1024 sc1
    v_mfma_f32_16x16x32_bf16 v[100:103], v[160:163], v[40:43], 0
    v_mfma_f32_16x16x32_bf16 v[104:107], v[164:167], v[40:43], 0
    v_mfma_f32_16x16x32_bf16 v[108:111], v[168:171], v[40:43], 0
    v_mfma_f32_16x16x32_bf16 v[112:115], v[172:175], v[40:43], 0
    v_mfma_f32_16x16x32_bf16 v[116:119], v[176:179], v[40:43], 0
    s_waitcnt vmcnt(9)
    buffer_load_dwordx2 v[78:79], v242, s[36:39], s91 offen offset:2048 sc1
    v_mfma_f32_16x16x32_bf16 v[100:103], v[180:183], v[44:47], v[100:103]
    v_mfma_f32_16x16x32_bf16 v[104:107], v[184:187], v[44:47], v[104:107]
    v_mfma_f32_16x16x32_bf16 v[108:111], v[188:191], v[44:47], v[108:111]
    v_mfma_f32_16x16x32_bf16 v[112:115], v[192:195], v[44:47], v[112:115]
    ds_write_b128 v249, v[80:83] offset:0
    v_mfma_f32_16x16x32_bf16 v[116:119], v[196:199], v[44:47], v[116:119]
    s_waitcnt vmcnt(8)
    buffer_load_dwordx4 v[0:3], v254, s[36:39], s88 offen sc1
    buffer_load_dwordx4 v[4:7], v254, s[36:39], s88 offen offset:1024 sc1
    v_mfma_f32_16x16x32_bf16 v[100:103], v[200:203], v[48:51], v[100:103]
    v_mfma_f32_16x16x32_bf16 v[104:107], v[204:207], v[48:51], v[104:107]
    ds_write_b128 v249, v[84:87] offset:1024
    v_mfma_f32_16x16x32_bf16 v[108:111], v[208:211], v[48:51], v[108:111]
    v_mfma_f32_16x16x32_bf16 v[112:115], v[212:215], v[48:51], v[112:115]
    v_mfma_f32_16x16x32_bf16 v[116:119], v[216:219], v[48:51], v[116:119]
    ds_write_b128 v249, v[88:91] offset:2048
    s_waitcnt vmcnt(9)
    buffer_load_dwordx2 v[8:9], v242, s[36:39], s88 offen offset:2048 sc1
    v_mfma_f32_16x16x32_bf16 v[100:103], v[220:223], v[52:55], v[100:103]
    v_mfma_f32_16x16x32_bf16 v[104:107], v[224:227], v[52:55], v[104:107]
    v_mfma_f32_16x16x32_bf16 v[108:111], v[228:231], v[52:55], v[108:111]
    ds_write_b128 v249, v[92:95] offset:3072
    v_mfma_f32_16x16x32_bf16 v[112:115], v[232:235], v[52:55], v[112:115]
    v_mfma_f32_16x16x32_bf16 v[116:119], v[236:239], v[52:55], v[116:119]
    s_waitcnt vmcnt(9)
    s_add_u32 s88, s88, 2560
    buffer_load_dwordx4 v[10:13], v254, s[36:39], s88 offen sc1
    v_mfma_f32_16x16x32_bf16 v[100:103], v[140:143], v[56:59], v[100:103]
    ds_write_b128 v249, v[96:99] offset:4096
    v_mfma_f32_16x16x32_bf16 v[104:107], v[144:147], v[56:59], v[104:107]
    v_mfma_f32_16x16x32_bf16 v[108:111], v[148:151], v[56:59], v[108:111]
    v_mfma_f32_16x16x32_bf16 v[112:115], v[152:155], v[56:59], v[112:115]
    v_mfma_f32_16x16x32_bf16 v[116:119], v[156:159], v[56:59], v[116:119]
    s_waitcnt vmcnt(9)
    buffer_load_dwordx4 v[14:17], v254, s[36:39], s88 offen offset:1024 sc1
    v_mfma_f32_16x16x32_bf16 v[120:123], v[160:163], v[60:63], 0
    v_mfma_f32_16x16x32_bf16 v[124:127], v[164:167], v[60:63], 0
    v_mfma_f32_16x16x32_bf16 v[128:131], v[168:171], v[60:63], 0
    v_mfma_f32_16x16x32_bf16 v[132:135], v[172:175], v[60:63], 0
    v_mfma_f32_16x16x32_bf16 v[136:139], v[176:179], v[60:63], 0
    s_waitcnt vmcnt(9)
    buffer_load_dwordx2 v[18:19], v242, s[36:39], s88 offen offset:2048 sc1
    v_mfma_f32_16x16x32_bf16 v[120:123], v[180:183], v[64:67], v[120:123]
    v_mfma_f32_16x16x32_bf16 v[124:127], v[184:187], v[64:67], v[124:127]
    v_mfma_f32_16x16x32_bf16 v[128:131], v[188:191], v[64:67], v[128:131]
    v_mfma_f32_16x16x32_bf16 v[132:135], v[192:195], v[64:67], v[132:135]
    ds_write_b128 v249, v[100:103] offset:5120
    v_mfma_f32_16x16x32_bf16 v[136:139], v[196:199], v[64:67], v[136:139]
    s_waitcnt vmcnt(8)
    v_mfma_f32_16x16x32_bf16 v[120:123], v[200:203], v[68:71], v[120:123]
    v_mfma_f32_16x16x32_bf16 v[124:127], v[204:207], v[68:71], v[124:127]
    ds_write_b128 v249, v[104:107] offset:6144
    v_mfma_f32_16x16x32_bf16 v[128:131], v[208:211], v[68:71], v[128:131]
    v_mfma_f32_16x16x32_bf16 v[132:135], v[212:215], v[68:71], v[132:135]
    v_mfma_f32_16x16x32_bf16 v[136:139], v[216:219], v[68:71], v[136:139]
    ds_write_b128 v249, v[108:111] offset:7168
    s_waitcnt vmcnt(7)
    v_mfma_f32_16x16x32_bf16 v[120:123], v[220:223], v[72:75], v[120:123]
    v_mfma_f32_16x16x32_bf16 v[124:127], v[224:227], v[72:75], v[124:127]
    v_mfma_f32_16x16x32_bf16 v[128:131], v[228:231], v[72:75], v[128:131]
    ds_write_b128 v249, v[112:115] offset:8192
    v_mfma_f32_16x16x32_bf16 v[132:135], v[232:235], v[72:75], v[132:135]
    v_mfma_f32_16x16x32_bf16 v[136:139], v[236:239], v[72:75], v[136:139]
    s_waitcnt vmcnt(6)
    v_mfma_f32_16x16x32_bf16 v[120:123], v[140:143], v[76:79], v[120:123]
    ds_write_b128 v249, v[116:119] offset:9216
    v_mfma_f32_16x16x32_bf16 v[124:127], v[144:147], v[76:79], v[124:127]
    v_mfma_f32_16x16x32_bf16 v[128:131], v[148:151], v[76:79], v[128:131]
    v_mfma_f32_16x16x32_bf16 v[132:135], v[152:155], v[76:79], v[132:135]
    v_mfma_f32_16x16x32_bf16 v[136:139], v[156:159], v[76:79], v[136:139]
    s_waitcnt vmcnt(5)
    v_mfma_f32_16x16x32_bf16 v[92:95], v[172:175], v[0:3], 0
    v_mfma_f32_16x16x32_bf16 v[96:99], v[176:179], v[0:3], 0
    v_mfma_f32_16x16x32_bf16 v[80:83], v[160:163], v[0:3], 0
    v_mfma_f32_16x16x32_bf16 v[84:87], v[164:167], v[0:3], 0
    v_mfma_f32_16x16x32_bf16 v[88:91], v[168:171], v[0:3], 0
    s_waitcnt vmcnt(4)
    v_mfma_f32_16x16x32_bf16 v[92:95], v[192:195], v[4:7], v[92:95]
    ds_write_b128 v249, v[120:123] offset:10240
    v_mfma_f32_16x16x32_bf16 v[96:99], v[196:199], v[4:7], v[96:99]
    v_mfma_f32_16x16x32_bf16 v[80:83], v[180:183], v[4:7], v[80:83]
    v_mfma_f32_16x16x32_bf16 v[84:87], v[184:187], v[4:7], v[84:87]
    v_mfma_f32_16x16x32_bf16 v[88:91], v[188:191], v[4:7], v[88:91]
    s_waitcnt vmcnt(2)
    v_mfma_f32_16x16x32_bf16 v[92:95], v[212:215], v[8:11], v[92:95]
    v_mfma_f32_16x16x32_bf16 v[96:99], v[216:219], v[8:11], v[96:99]
    ds_write_b128 v249, v[128:131] offset:12288
    v_mfma_f32_16x16x32_bf16 v[80:83], v[200:203], v[8:11], v[80:83]
    v_mfma_f32_16x16x32_bf16 v[84:87], v[204:207], v[8:11], v[84:87]
    ds_write_b128 v249, v[124:127] offset:11264
    v_mfma_f32_16x16x32_bf16 v[88:91], v[208:211], v[8:11], v[88:91]
    s_waitcnt vmcnt(1)
    v_mfma_f32_16x16x32_bf16 v[92:95], v[232:235], v[12:15], v[92:95]
    v_mfma_f32_16x16x32_bf16 v[96:99], v[236:239], v[12:15], v[96:99]
    v_mfma_f32_16x16x32_bf16 v[80:83], v[220:223], v[12:15], v[80:83]
    v_mfma_f32_16x16x32_bf16 v[84:87], v[224:227], v[12:15], v[84:87]
    v_mfma_f32_16x16x32_bf16 v[88:91], v[228:231], v[12:15], v[88:91]
    ds_write_b128 v249, v[132:135] offset:13312
    s_waitcnt vmcnt(0)
    v_mfma_f32_16x16x32_bf16 v[92:95], v[152:155], v[16:19], v[92:95]
    v_mfma_f32_16x16x32_bf16 v[96:99], v[156:159], v[16:19], v[96:99]
    v_mfma_f32_16x16x32_bf16 v[80:83], v[140:143], v[16:19], v[80:83]
    ds_write_b128 v249, v[136:139] offset:14336
    v_mfma_f32_16x16x32_bf16 v[84:87], v[144:147], v[16:19], v[84:87]
    v_mfma_f32_16x16x32_bf16 v[88:91], v[148:151], v[16:19], v[88:91]
    s_nop 2
    ds_write_b128 v244, v[92:95] offset:3072
    ds_write_b128 v244, v[96:99] offset:4096
    s_waitcnt lgkmcnt(0)
    s_barrier
    ds_read_b128 v[100:103], v244 offset:0
    ds_read_b128 v[104:107], v244 offset:1024
    ds_read_b128 v[108:111], v244 offset:2048
    ds_read_b128 v[112:115], v245 offset:0
    ds_read_b128 v[116:119], v245 offset:1024
    ds_read_b128 v[120:123], v245 offset:2048
    ds_read_b128 v[124:127], v245 offset:15360
    ds_read_b128 v[128:131], v245 offset:16384
    ds_read_b128 v[132:135], v245 offset:17408
    ds_read_b128 v[136:139], v246 offset:5120
    ds_read_b128 v[140:143], v246 offset:6144
    ds_read_b128 v[144:147], v246 offset:7168
    ds_read_b128 v[148:151], v246 offset:20480
    ds_read_b128 v[152:155], v246 offset:21504
    ds_read_b128 v[156:159], v246 offset:22528
    s_waitcnt lgkmcnt(12)
    ds_read_b128 v[160:163], v247 offset:10240
    ds_read_b128 v[164:167], v247 offset:11264
    ds_read_b128 v[168:171], v247 offset:12288
    v_pk_add_f32 v[80:81], v[80:81], v[100:101]
    v_pk_add_f32 v[82:83], v[82:83], v[102:103]
    v_pk_add_f32 v[84:85], v[84:85], v[104:105]
    v_pk_add_f32 v[86:87], v[86:87], v[106:107]
    v_pk_add_f32 v[88:89], v[88:89], v[108:109]
    v_pk_add_f32 v[90:91], v[90:91], v[110:111]
    s_waitcnt lgkmcnt(12)
    ds_read_b128 v[172:175], v247 offset:25600
    ds_read_b128 v[176:179], v247 offset:26624
    ds_read_b128 v[180:183], v247 offset:27648
    v_pk_add_f32 v[80:81], v[80:81], v[112:113]
    v_pk_add_f32 v[82:83], v[82:83], v[114:115]
    v_pk_add_f32 v[84:85], v[84:85], v[116:117]
    v_pk_add_f32 v[86:87], v[86:87], v[118:119]
    v_pk_add_f32 v[88:89], v[88:89], v[120:121]
    v_pk_add_f32 v[90:91], v[90:91], v[122:123]
    s_waitcnt lgkmcnt(12)
    v_pk_add_f32 v[80:81], v[80:81], v[124:125]
    v_pk_add_f32 v[82:83], v[82:83], v[126:127]
    v_pk_add_f32 v[84:85], v[84:85], v[128:129]
    v_pk_add_f32 v[86:87], v[86:87], v[130:131]
    v_pk_add_f32 v[88:89], v[88:89], v[132:133]
    v_pk_add_f32 v[90:91], v[90:91], v[134:135]
    s_waitcnt lgkmcnt(9)
    v_pk_add_f32 v[80:81], v[80:81], v[136:137]
    v_pk_add_f32 v[82:83], v[82:83], v[138:139]
    v_pk_add_f32 v[84:85], v[84:85], v[140:141]
    v_pk_add_f32 v[86:87], v[86:87], v[142:143]
    v_pk_add_f32 v[88:89], v[88:89], v[144:145]
    v_pk_add_f32 v[90:91], v[90:91], v[146:147]
    s_waitcnt lgkmcnt(6)
    v_pk_add_f32 v[80:81], v[80:81], v[148:149]
    v_pk_add_f32 v[82:83], v[82:83], v[150:151]
    v_pk_add_f32 v[84:85], v[84:85], v[152:153]
    v_pk_add_f32 v[86:87], v[86:87], v[154:155]
    v_pk_add_f32 v[88:89], v[88:89], v[156:157]
    v_pk_add_f32 v[90:91], v[90:91], v[158:159]
    s_waitcnt lgkmcnt(3)
    v_pk_add_f32 v[80:81], v[80:81], v[160:161]
    v_pk_add_f32 v[82:83], v[82:83], v[162:163]
    v_pk_add_f32 v[84:85], v[84:85], v[164:165]
    v_pk_add_f32 v[86:87], v[86:87], v[166:167]
    v_pk_add_f32 v[88:89], v[88:89], v[168:169]
    v_pk_add_f32 v[90:91], v[90:91], v[170:171]
    s_waitcnt lgkmcnt(0)
    v_pk_add_f32 v[80:81], v[80:81], v[172:173]
    v_pk_add_f32 v[82:83], v[82:83], v[174:175]
    v_pk_add_f32 v[84:85], v[84:85], v[176:177]
    v_pk_add_f32 v[86:87], v[86:87], v[178:179]
    v_pk_add_f32 v[88:89], v[88:89], v[180:181]
    v_pk_add_f32 v[90:91], v[90:91], v[182:183]
    v_cvt_pk_bf16_f32 v80, v80, v81
    v_cvt_pk_bf16_f32 v81, v82, v83
    v_cvt_pk_bf16_f32 v82, v84, v85
    v_cvt_pk_bf16_f32 v83, v86, v87
    v_cvt_pk_bf16_f32 v88, v88, v89
    v_cvt_pk_bf16_f32 v89, v90, v91
    v_permlane16_swap_b32 v80, v82
    v_permlane16_swap_b32 v81, v83
    buffer_store_dwordx4 v[80:83], v248, s[44:47], s98 offen offset:0
    buffer_store_dwordx2 v[88:89], v243, s[44:47], s98 offen offset:64
    s_or_b32 s60, s2, s26
    s_cmp_eq_u32 s60, 0
    s_cselect_b32 s60, 0, 16777216
    s_add_u32 s60, s60, 12976128
    v_mov_b32 v0, s60
    v_mov_b32 v1, s101
    s_mov_b64 exec, 1
    buffer_store_dword v1, v0, s[36:39], 0 offen sc1
    s_mov_b64 exec, -1
L_end:
    s_endpgm
.p2align 8
.fill 4096, 4, 0xbf800000
.section .rodata,"a"
.p2align 6
.amdhsa_kernel parallel_sum__linear_attn_block__dense_activation_gelu__prompt_kernel
  .amdhsa_next_free_vgpr 256
  .amdhsa_next_free_sgpr 102
  .amdhsa_accum_offset 256
  .amdhsa_group_segment_fixed_size 0
  .amdhsa_kernarg_size 88
  .amdhsa_user_sgpr_count 2
  .amdhsa_user_sgpr_kernarg_segment_ptr 1
  .amdhsa_system_sgpr_workgroup_id_x 1
.end_amdhsa_kernel
```
